```python
import torch

def _softmax(x, axis=-1):
    return torch.softmax(x, dim=axis)
def _gelu(x):
    return torch.nn.functional.gelu(x, approximate="tanh")
def _silu(x):
    return torch.nn.functional.silu(x)
def _sigmoid(x):
    return torch.sigmoid(x)
def _layernorm(x, axis=-1, eps=1e-5):
    m = x.mean(dim=axis, keepdim=True)
    v = x.var(dim=axis, keepdim=True, unbiased=False)
    return (x - m) / torch.sqrt(v + eps)
def _scatter_add(tgt, idx, src, axis=0):
    return tgt.clone().index_add_(axis, idx, src)
def _segment_sum(src, seg, n):
    out = torch.zeros((n,) + src.shape[1:], dtype=src.dtype)
    return out.index_add_(0, seg, src)
def _pad(x, pw):
    flat = tuple(v for pair in reversed(pw) for v in pair)
    return torch.nn.functional.pad(x, flat)

kernel_name = 'interleave_layers__sliding_block__dense_activation_squared_relu__prompt'

def setup_inputs():

    _w = (lambda a: (lambda t: t.to(torch.bfloat16) if t.is_floating_point() else t)(torch.as_tensor(a)))
    def _A_setup():
        B, S, D = 1, 2048, 640
        return {
            "x": _w((lambda *s: torch.randn(*s, dtype=torch.bfloat16) * 0.05)(B, S, D)),
            "wqkv": _w((lambda *s: torch.randn(*s, dtype=torch.bfloat16) * 0.05)(D, 3 * D)),
            "wo": _w((lambda *s: torch.randn(*s, dtype=torch.bfloat16) * 0.05)(D, D)),
        }
    _A_in = _A_setup()

    def _B_setup():
        B, S, D, F = 1, 2048, 640, 1536
        return {
            "x": _w((lambda *s: torch.randn(*s, dtype=torch.bfloat16) * 0.05)(B, S, D)),
            "w1": _w((lambda *s: torch.randn(*s, dtype=torch.bfloat16) * 0.05)(D, F)),
            "b1": _w((lambda *s: torch.randn(*s, dtype=torch.bfloat16) * 0.2)(F)),
            "w2": _w((lambda *s: torch.randn(*s, dtype=torch.bfloat16) * 0.05)(F, D)),
            "b2": _w((lambda *s: torch.randn(*s, dtype=torch.bfloat16) * 0.8)(D)),
        }
    _B_in = _B_setup()

    return {
        "A_x": _A_in["x"],
        "A_wqkv": _A_in["wqkv"],
        "A_wo": _A_in["wo"],
        "B_x": _B_in["x"],
        "B_w1": _B_in["w1"],
        "B_b1": _B_in["b1"],
        "B_w2": _B_in["w2"],
        "B_b2": _B_in["b2"],
    }

def reference(A_x, A_wqkv, A_wo, B_x, B_w1, B_b1, B_w2, B_b2):
    def _A_ref(x, wqkv, wo):
        B, S, D = x.shape
        H = 32; Dh = D // H; W = 256
        qkv = (lambda x, *d: x.permute(*d))((x @ wqkv).reshape(B, S, 3, H, Dh), 2, 0, 3, 1, 4)
        q, k, v = qkv[0], qkv[1], qkv[2]
        scores = torch.einsum("bhqd,bhkd->bhqk", q, k) * (Dh ** -0.5)
        idx = torch.arange(S)
        mask = (idx[:, None] - idx[None, :] >= 0) & (idx[:, None] - idx[None, :] < W)
        scores = torch.where(mask[None, None], scores, -1e9)
        p = _softmax(scores, axis=-1)
        o = torch.einsum("bhqk,bhkd->bhqd", p, v)
        return (lambda x, *d: x.permute(*d))(o, 0, 2, 1, 3).reshape(B, S, D) @ wo

    def _B_ref(x, w1, b1, w2, b2):
        h = torch.einsum("bsd,df->bsf", x, w1) + b1
        zero = torch.zeros_like(h)
        r = torch.where(h > zero, h, zero)
        h = r * r
        out = torch.einsum("bsf,fd->bsd", h, w2) + b2
        return out

    x = A_x
    x = x + _A_ref(_layernorm(x, axis=-1), A_wqkv, A_wo)
    x = x + _B_ref(_layernorm(x, axis=-1), B_w1, B_b1, B_w2, B_b2)
    x = x + _A_ref(_layernorm(x, axis=-1), A_wqkv, A_wo)
    x = x + _B_ref(_layernorm(x, axis=-1), B_w1, B_b1, B_w2, B_b2)
    return x
```

```asm
; @launch grid=(256,1,1) block=(512,1,1) lds=163840
.amdgcn_target "amdgcn-amd-amdhsa--gfx950"
.text
.p2align 8
L_code_begin:
.globl interleave_layers__sliding_block__dense_activation_squared_relu__prompt_kernel
.p2align 8
.type interleave_layers__sliding_block__dense_activation_squared_relu__prompt_kernel,@function
interleave_layers__sliding_block__dense_activation_squared_relu__prompt_kernel:
    s_load_dwordx16 s[24:39], s[0:1], 0
    s_load_dwordx2 s[60:61], s[0:1], 64
    s_load_dwordx2 s[62:63], s[0:1], 80
    s_cmp_ge_u32 s2, 256
    s_cbranch_scc1 L_mega_end
    v_lshrrev_b32 v10, 6, v0
    v_and_b32 v1, 63, v0
    v_readfirstlane_b32 s18, v10
    s_and_b32 s3, s2, 7
    s_lshr_b32 s99, s2, 3
    s_getpc_b64 s[40:41]
L_pc:
    s_sub_u32 s40, s40, L_pc-L_code_begin
    s_subb_u32 s41, s41, 0
    s_mov_b32 s42, L_code_end-L_code_begin
    s_mov_b32 s43, 0x00020000
    s_and_b32 s44, s99, 1
    s_lshl_b32 s44, s44, 3
    s_add_u32 s44, s44, s18
    s_lshl_b32 s44, s44, 12
    v_lshlrev_b32 v4, 6, v1
    v_add_u32 v5, s44, v4
    buffer_load_dword v254, v5, s[40:43], 0 offen
    s_and_b32 s17, s99, 15
    s_lshl_b32 s16, s3, 1
    s_lshr_b32 s83, s99, 4
    s_add_u32 s16, s16, s83
    s_and_b32 s20, s99, 7
    s_lshl_b32 s19, s3, 2
    s_lshr_b32 s84, s99, 3
    s_add_u32 s19, s19, s84
    v_lshlrev_b32 v2, 4, v1
    v_mov_b32 v3, 0
    s_mov_b32 s21, 0
    s_mov_b32 s22, 0
    s_mov_b32 s23, 0
    s_mov_b32 s95, 0
    s_and_b32 s73, s18, 3
    v_and_b32 v248, 3, v1
    v_add_u32 v248, 163648, v248
    v_mov_b32 v249, 0x7fff0000
    s_add_u32 s44, s73, 163648
    v_writelane_b32 v249, s44, 0
    v_and_b32 v12, 31, v1
    v_lshlrev_b32 v12, 2, v12
    v_mov_b32 v13, 0
    v_add_u32 v12, 163712, v12
    ds_write_b32 v12, v13
    s_lshl_b32 s74, s2, 13
    s_add_u32 s74, s74, 29589504
    s_mul_i32 s75, s20, 102400
    s_add_u32 s75, s75, 26738688
    s_mul_i32 s76, s17, 122880
    s_add_u32 s76, s76, 24772608
    s_mul_i32 s77, s20, 245760
    s_add_u32 s77, s77, 27557888
    s_getreg_b32 s79, hwreg(HW_REG_XCC_ID)
    s_and_b32 s79, s79, 7
    v_mov_b32 v6, 0
    s_mov_b32 s44, 32931840
    s_waitcnt lgkmcnt(0)
    s_mov_b32 s4, s62
    s_mov_b32 s5, s63
    s_mov_b32 s6, 32931968
    s_mov_b32 s7, 0x00020000
    buffer_load_dword v255, v6, s[4:7], s44 offen sc1
    s_mov_b32 s8, s60
    s_mov_b32 s9, s61
    s_mov_b32 s10, 2621440
    s_mov_b32 s11, 0x00020000
    s_mov_b32 s12, s38
    s_mov_b32 s13, s39
    s_mov_b32 s14, 1280
    s_mov_b32 s15, 0x00020000
    s_cmp_lg_u32 s18, 7
    s_cbranch_scc1 L_notlb
    v_lshlrev_b32 v6, 19, v1
    buffer_load_dword v8, v6, s[4:7], 0 offen
    buffer_load_dword v9, v6, s[8:11], 0 offen
    buffer_load_dword v10, v6, s[12:15], 0 offen
    s_mov_b32 s40, s28
    s_mov_b32 s41, s29
    s_mov_b32 s42, 819200
    s_mov_b32 s43, 0x00020000
    buffer_load_dword v11, v6, s[40:43], 0 offen
    s_mov_b32 s40, s32
    s_mov_b32 s41, s33
    s_mov_b32 s42, 1966080
    s_mov_b32 s43, 0x00020000
    buffer_load_dword v12, v6, s[40:43], 0 offen
    s_mov_b32 s40, s36
    s_mov_b32 s41, s37
    s_mov_b32 s42, 1966080
    s_mov_b32 s43, 0x00020000
    buffer_load_dword v13, v6, s[40:43], 0 offen
    s_mov_b32 s40, s34
    s_mov_b32 s41, s35
    s_mov_b32 s42, 3072
    s_mov_b32 s43, 0x00020000
    buffer_load_dword v14, v6, s[40:43], 0 offen
    s_mov_b32 s40, s26
    s_mov_b32 s41, s27
    s_mov_b32 s42, 2457600
    s_mov_b32 s43, 0x00020000
    buffer_load_dword v15, v6, s[40:43], 0 offen
L_notlb:
    s_barrier
    v_lshrrev_b32 v5, 5, v1
    v_lshrrev_b32 v24, 4, v1
    v_and_b32 v25, 3, v1
    v_lshl_add_u32 v24, v24, 2, v25
    v_bfe_u32 v25, v1, 2, 2
    v_mov_b32 v40, 0x3f803f80
    s_lshl_b32 s70, s73, 3
    s_add_u32 s70, s70, s3
    s_lshl_b32 s70, s70, 5
    s_add_u32 s70, s70, s99
    s_cmp_ge_u32 s18, 4
    s_cbranch_scc1 L_hw_start
    s_setprio 1
    s_mov_b32 s40, s24
    s_mov_b32 s41, s25
    s_mov_b32 s42, 2621440
    s_mov_b32 s43, 0x00020000
    s_lshl_b32 s64, s16, 4
    s_add_u32 s64, s64, s17
    s_mul_i32 s66, s64, 10240
    s_mul_i32 s65, s18, 320
    s_add_u32 s66, s66, s65
    v_and_b32 v6, 7, v1
    v_lshrrev_b32 v20, 3, v1
    v_mul_u32_u24 v21, 1280, v6
    v_lshl_add_u32 v21, v20, 4, v21
    v_mov_b32 v16, 0
    v_mov_b32 v17, 0
    v_mov_b32 v18, 0
    v_mov_b32 v19, 0
    buffer_load_dwordx4 v[8:11], v21, s[40:43], s66 offen
    buffer_load_dwordx4 v[12:15], v21, s[40:43], s66 offen offset:128
    s_mov_b32 exec_hi, 0
    buffer_load_dwordx4 v[16:19], v21, s[40:43], s66 offen offset:256
    s_mov_b32 exec_hi, -1
    v_bfe_u32 v26, v1, 4, 1
    v_and_b32 v27, 15, v1
    v_lshlrev_b32 v7, 11, v26
    v_lshl_add_u32 v7, v27, 4, v7
    v_lshl_add_u32 v7, v5, 3, v7
    v_lshlrev_b32 v47, 10, v5
    v_lshl_add_u32 v47, v26, 8, v47
    v_lshl_add_u32 v47, v27, 4, v47
    s_cmp_ge_u32 s70, 320
    s_cbranch_scc1 L_job_o
    s_and_b32 s58, s70, 15
    s_lshr_b32 s59, s70, 4
    s_mov_b32 s54, 3072
    s_mul_i32 s56, s59, 98304
    s_mul_i32 s60, s58, 192
    s_add_u32 s56, s56, s60
    s_mul_i32 s55, s58, 122880
    s_lshl_b32 s60, s59, 12
    s_add_u32 s55, s55, s60
    s_add_u32 s55, s55, 24772608
    s_lshl_b32 s60, s59, 11
    s_sub_u32 s60, 81920, s60
    s_mov_b32 s57, 12
    s_mul_i32 s62, s58, 160
    s_add_u32 s62, s62, s59
    s_lshl_b32 s62, s62, 7
    s_add_u32 s62, s62, 32014336
    s_mov_b32 s44, s32
    s_mov_b32 s45, s33
    s_mov_b32 s46, 1966080
    s_mov_b32 s47, 0x00020000
    v_add_u32 v34, s60, v47
    v_mov_b32 v33, v7
    s_branch L_job_go
L_job_o:
    s_cmp_ge_u32 s70, 480
    s_cbranch_scc1 L_job_2
    s_sub_u32 s59, s70, 320
    s_mov_b32 s52, 10
    s_mov_b32 s60, 102400
    s_mov_b32 s61, 26738688
    s_mov_b32 s44, s28
    s_mov_b32 s45, s29
    s_mov_b32 s46, 819200
    s_mov_b32 s47, 0x00020000
    s_branch L_job_g2
L_job_2:
    s_sub_u32 s59, s70, 480
    s_mov_b32 s52, 24
    s_mov_b32 s60, 245760
    s_mov_b32 s61, 27557888
    s_mov_b32 s44, s36
    s_mov_b32 s45, s37
    s_mov_b32 s46, 1966080
    s_mov_b32 s47, 0x00020000
L_job_g2:
    s_and_b32 s58, s59, 7
    s_lshr_b32 s59, s59, 3
    s_mov_b32 s54, 1280
    s_mul_i32 s56, s59, 40960
    s_mul_i32 s55, s58, 160
    s_add_u32 s56, s56, s55
    s_mul_i32 s55, s58, s60
    s_add_u32 s55, s55, s61
    s_cmp_ge_u32 s59, s52
    s_cselect_b32 s60, s52, 0
    s_cselect_b32 s61, 5120, 0
    s_sub_u32 s59, s59, s60
    s_mul_i32 s60, s59, 86
    s_lshr_b32 s60, s60, 8
    s_sub_u32 s53, s59, s60
    s_mul_i32 s63, s60, 3
    s_sub_u32 s63, s59, s63
    s_add_u32 s60, s60, 16
    s_cmp_eq_u32 s63, 2
    s_cselect_b32 s53, s60, s53
    s_cmp_eq_u32 s52, 24
    s_cselect_b32 s59, s53, s59
    s_mul_i32 s60, s59, 10240
    s_add_u32 s55, s55, s60
    s_add_u32 s55, s55, s61
    s_mov_b32 s57, 10
    v_add_u32 v34, 4096, v47
    v_mov_b32 v35, 0x7ffffff0
    v_cmp_eq_u32 vcc, 0, v5
    v_and_b32 v33, 3, v1
    v_lshlrev_b32 v33, 3, v33
    v_cndmask_b32 v34, v35, v34, vcc
    v_lshl_add_u32 v33, v25, 6, v33
    v_lshl_add_u32 v33, v26, 11, v33
L_job_go:
    v_mul_lo_u32 v31, v25, s54
    v_lshl_add_u32 v31, v24, 4, v31
    v_cmp_gt_u32 vcc, s57, v24
    v_mov_b32 v35, 0x7ffffff0
    s_lshl_b32 s57, s54, 2
    v_cndmask_b32 v31, v35, v31, vcc
    s_lshl_b32 s58, s18, 13
    s_add_u32 s58, s58, 130944
    v_add_u32 v7, s58, v7
    v_add_u32 v48, s58, v33
    s_lshr_b32 s65, s64, 2
    s_and_b32 s69, s64, 3
    s_mul_i32 s66, s65, 40960
    s_mul_i32 s67, s18, 10240
    s_add_u32 s66, s66, s67
    s_lshl_b32 s67, s69, 7
    s_add_u32 s66, s66, s67
    s_add_u32 s63, s66, 4096
    s_add_u32 s61, s66, 8192
    v_lshlrev_b32 v22, 4, v6
    v_lshl_add_u32 v22, v20, 9, v22
    s_lshl_b32 s68, s65, 11
    s_add_u32 s67, s67, s68
    s_lshl_b32 s68, s18, 9
    s_add_u32 s67, s67, s68
    s_add_u32 s67, s67, 11534336
    v_lshlrev_b32 v23, 4, v6
    v_lshl_add_u32 v23, v20, 3, v23
    s_lshl_b32 s68, s64, 2
    s_add_u32 s68, s68, s18
    s_lshl_b32 s68, s68, 7
    s_add_u32 s68, s68, 32505856
    v_mov_b32 v44, 0
    v_mov_b32 v45, 0
    s_cmp_ge_u32 s70, 864
    s_cbranch_scc1 L_job_nodma
    s_mov_b32 exec_hi, 0xffff
    s_add_u32 m0, s58, 0
    s_nop 0
    buffer_load_dwordx4 v31, s[44:47], s56 offen lds
    s_add_u32 s56, s56, s57
    s_add_u32 m0, s58, 1024
    s_nop 0
    buffer_load_dwordx4 v31, s[44:47], s56 offen lds
    s_add_u32 s56, s56, s57
    s_add_u32 m0, s58, 2048
    s_nop 0
    buffer_load_dwordx4 v31, s[44:47], s56 offen lds
    s_add_u32 s56, s56, s57
    s_add_u32 m0, s58, 3072
    s_nop 0
    buffer_load_dwordx4 v31, s[44:47], s56 offen lds
    s_add_u32 s56, s56, s57
    s_add_u32 m0, s58, 4096
    s_nop 0
    buffer_load_dwordx4 v31, s[44:47], s56 offen lds
    s_add_u32 s56, s56, s57
    s_add_u32 m0, s58, 5120
    s_nop 0
    buffer_load_dwordx4 v31, s[44:47], s56 offen lds
    s_add_u32 s56, s56, s57
    s_add_u32 m0, s58, 6144
    s_nop 0
    buffer_load_dwordx4 v31, s[44:47], s56 offen lds
    s_add_u32 s56, s56, s57
    s_add_u32 m0, s58, 7168
    s_nop 0
    buffer_load_dwordx4 v31, s[44:47], s56 offen lds
    s_add_u32 s56, s56, s57
    s_mov_b32 exec_hi, -1
    s_waitcnt vmcnt(8)
    s_branch L_job_dmad
L_job_nodma:
    s_waitcnt vmcnt(0)
L_job_dmad:
    buffer_store_dwordx4 v[8:11], v22, s[4:7], s66 offen sc1
    buffer_store_dwordx4 v[12:15], v22, s[4:7], s63 offen sc1
    s_mov_b32 exec_hi, 0
    buffer_store_dwordx4 v[16:19], v22, s[4:7], s61 offen sc1
    s_mov_b32 exec_hi, -1
    v_dot2_f32_bf16 v44, v8, v40, v44
    v_dot2_f32_bf16 v45, v8, v8, v45
    v_dot2_f32_bf16 v44, v9, v40, v44
    v_dot2_f32_bf16 v45, v9, v9, v45
    v_dot2_f32_bf16 v44, v10, v40, v44
    v_dot2_f32_bf16 v45, v10, v10, v45
    v_dot2_f32_bf16 v44, v11, v40, v44
    v_dot2_f32_bf16 v45, v11, v11, v45
    v_dot2_f32_bf16 v44, v12, v40, v44
    v_dot2_f32_bf16 v45, v12, v12, v45
    v_dot2_f32_bf16 v44, v13, v40, v44
    v_dot2_f32_bf16 v45, v13, v13, v45
    v_dot2_f32_bf16 v44, v14, v40, v44
    v_dot2_f32_bf16 v45, v14, v14, v45
    v_dot2_f32_bf16 v44, v15, v40, v44
    v_dot2_f32_bf16 v45, v15, v15, v45
    v_dot2_f32_bf16 v44, v16, v40, v44
    v_dot2_f32_bf16 v45, v16, v16, v45
    v_dot2_f32_bf16 v44, v17, v40, v44
    v_dot2_f32_bf16 v45, v17, v17, v45
    v_dot2_f32_bf16 v44, v18, v40, v44
    v_dot2_f32_bf16 v45, v18, v18, v45
    v_dot2_f32_bf16 v44, v19, v40, v44
    v_dot2_f32_bf16 v45, v19, v19, v45
    v_readfirstlane_b32 s96, v255
    s_mul_i32 s97, s96, 0x9e3779b1
    s_add_u32 s97, s97, 0x7f4a7c15
    s_add_u32 s85, s97, 1
    s_add_u32 s86, s97, 1
    s_add_u32 s87, s97, 2
    s_add_u32 s98, s97, 3
    s_xor_b32 s72, s96, 0x5bd1e995
    s_mul_i32 s72, s72, 0x85ebca6b
    v_mov_b32 v42, v44
    v_mov_b32 v43, v45
    s_nop 1
    v_permlane32_swap_b32 v44, v42
    v_permlane32_swap_b32 v45, v43
    s_nop 1
    v_add_f32 v44, v44, v42
    v_add_f32 v45, v45, v43
    v_mov_b32 v42, v44
    v_mov_b32 v43, v45
    s_nop 1
    v_permlane16_swap_b32 v44, v42
    v_permlane16_swap_b32 v45, v43
    s_nop 1
    v_add_f32 v44, v44, v42
    v_add_f32 v45, v45, v43
    s_mov_b64 exec, 0xffff
    buffer_store_dwordx2 v[44:45], v23, s[4:7], s67 offen sc1
    s_mov_b64 exec, -1
    s_waitcnt vmcnt(0)
    v_mov_b32 v42, s86
    v_mov_b32 v43, s72
    s_waitcnt vmcnt(63)
    s_mov_b64 exec, 1
    buffer_store_dwordx2 v[42:43], off, s[4:7], s68 sc1
    s_mov_b64 exec, -1
    s_cmp_ge_u32 s70, 864
    s_cbranch_scc1 L_pro_done
    s_waitcnt vmcnt(1)
    v_mov_b32 v15, v34
    ds_read_b64_tr_b16 v[16:17], v7 offset:0
    ds_read_b64_tr_b16 v[18:19], v7 offset:1024
    ds_read_b64_tr_b16 v[20:21], v7 offset:256
    ds_read_b64_tr_b16 v[22:23], v7 offset:1280
    ds_read_b64_tr_b16 v[24:25], v48 offset:512
    ds_read_b64_tr_b16 v[26:27], v48 offset:1536
    ds_read_b64_tr_b16 v[28:29], v7 offset:4096
    ds_read_b64_tr_b16 v[30:31], v7 offset:5120
    ds_read_b64_tr_b16 v[32:33], v7 offset:4352
    ds_read_b64_tr_b16 v[34:35], v7 offset:5376
    ds_read_b64_tr_b16 v[36:37], v48 offset:4608
    ds_read_b64_tr_b16 v[38:39], v48 offset:5632
    s_waitcnt lgkmcnt(0)
    v_mov_b32 v64, 0
    v_mov_b32 v65, 0
    v_mov_b32 v66, 0
    v_mov_b32 v67, 0
    v_dot2_f32_bf16 v64, v16, v40, v64
    v_dot2_f32_bf16 v65, v20, v40, v65
    v_dot2_f32_bf16 v66, v24, v40, v66
    v_dot2_f32_bf16 v64, v28, v40, v64
    v_dot2_f32_bf16 v65, v32, v40, v65
    v_dot2_f32_bf16 v66, v36, v40, v66
    v_dot2_f32_bf16 v64, v17, v40, v64
    v_dot2_f32_bf16 v65, v21, v40, v65
    v_dot2_f32_bf16 v66, v25, v40, v66
    v_dot2_f32_bf16 v64, v29, v40, v64
    v_dot2_f32_bf16 v65, v33, v40, v65
    v_dot2_f32_bf16 v66, v37, v40, v66
    v_dot2_f32_bf16 v64, v18, v40, v64
    v_dot2_f32_bf16 v65, v22, v40, v65
    v_dot2_f32_bf16 v66, v26, v40, v66
    v_dot2_f32_bf16 v64, v30, v40, v64
    v_dot2_f32_bf16 v65, v34, v40, v65
    v_dot2_f32_bf16 v66, v38, v40, v66
    v_dot2_f32_bf16 v64, v19, v40, v64
    v_dot2_f32_bf16 v65, v23, v40, v65
    v_dot2_f32_bf16 v66, v27, v40, v66
    v_dot2_f32_bf16 v64, v31, v40, v64
    v_dot2_f32_bf16 v65, v35, v40, v65
    v_dot2_f32_bf16 v66, v39, v40, v66
    s_nop 2
    v_mov_b32 v68, v64
    v_mov_b32 v69, v65
    v_mov_b32 v70, v66
    v_mov_b32 v71, v67
    s_nop 1
    v_permlane16_swap_b32 v64, v68
    v_permlane16_swap_b32 v65, v69
    v_permlane16_swap_b32 v66, v70
    v_permlane16_swap_b32 v67, v71
    s_nop 1
    v_add_f32 v64, v64, v68
    v_add_f32 v65, v65, v69
    v_add_f32 v66, v66, v70
    v_add_f32 v67, v67, v71
    s_mov_b32 s60, 0xffff
    s_mov_b32 s61, 0xffff
    v_cndmask_b32 v12, v65, v64, s[60:61]
    v_cndmask_b32 v13, v67, v66, s[60:61]
    v_and_b32 v14, 15, v1
    v_lshl_add_u32 v14, v5, 4, v14
    v_lshlrev_b32 v14, 2, v14
    v_bfe_u32 v68, v1, 4, 1
    v_mul_u32_u24 v68, 5120, v68
    v_add_u32 v14, v14, v68
    v_mov_b32 v251, 1
    ds_write_b8 v249, v251 offset:76
    s_mov_b32 s90, 0
L_spin_top_1:
    ds_read_u8 v250, v248 offset:72
    s_add_u32 s90, s90, 1
    s_cmp_gt_u32 s90, 1600000
    s_cbranch_scc1 L_spin_top_1_out
    s_sleep 1
    s_waitcnt lgkmcnt(0)
    v_cmp_gt_u32 vcc, 1, v250
    s_cbranch_vccnz L_spin_top_1
L_spin_top_1_out:
    s_waitcnt lgkmcnt(0)
    buffer_store_dwordx4 v[16:19], v47, s[4:7], s55 offen offset:0 sc1
    buffer_store_dwordx4 v[20:23], v47, s[4:7], s55 offen offset:2048 sc1
    buffer_store_dwordx4 v[24:27], v15, s[4:7], s55 offen offset:0 sc1
    buffer_store_dwordx4 v[28:31], v47, s[4:7], s55 offen offset:512 sc1
    buffer_store_dwordx4 v[32:35], v47, s[4:7], s55 offen offset:2560 sc1
    buffer_store_dwordx4 v[36:39], v15, s[4:7], s55 offen offset:512 sc1
    s_cmp_ge_u32 s70, 320
    s_cbranch_scc1 L_pro_done
    buffer_store_dword v12, v14, s[4:7], s62 offen sc1
    s_add_u32 s62, s62, 10240
    buffer_store_dword v13, v14, s[4:7], s62 offen sc1
L_pro_done:
    v_mov_b32 v251, 1
    ds_write_b8 v249, v251 offset:76
    v_lshrrev_b32 v0, 4, v1
    v_lshlrev_b32 v0, 9, v0
    v_and_b32 v48, 15, v1
    v_lshl_add_u32 v0, v48, 4, v0
    s_mov_b32 s101, s70
    s_lshl_b32 s100, s70, 7
    s_add_u32 s100, s100, 32768000
    s_branch L_cw_l0
L_cw_layer:
L_cw_l0:
    s_lshl_b32 s24, s16, 2
    s_add_u32 s24, s24, s18
    s_mul_i32 s25, s24, 40960
    s_lshl_b32 s26, s24, 11
    s_add_u32 s26, s26, 11534336
    s_lshl_b32 s27, s24, 9
    s_add_u32 s27, s27, 32342144
    s_add_u32 s40, s25, 0
    s_add_u32 s41, s25, 4096
    s_add_u32 s42, s25, 8192
    s_add_u32 s43, s25, 12288
    s_add_u32 s44, s25, 16384
    s_add_u32 s45, s25, 20480
    s_add_u32 s46, s25, 24576
    s_add_u32 s47, s25, 28672
    s_add_u32 s48, s25, 32768
    s_add_u32 s49, s25, 36864
    s_mov_b32 s34, 0xffff0000
    s_mov_b32 s35, 0
    s_mov_b32 s36, 0xffff
    s_mov_b32 s37, 0
    s_mov_b32 s38, -1
    s_mov_b32 s39, 0
    v_add_u32 v4, 0xf000, v2
    v_add_u32 v7, 112640, v2
    v_and_b32 v6, 15, v1
    v_subrev_u32 v5, 4, v6
    v_cmp_gt_u32 vcc, 12, v6
    v_lshrrev_b32 v8, 4, v1
    v_mul_u32_u24 v9, 192, v8
    v_cndmask_b32 v5, v5, v6, vcc
    v_lshl_add_u32 v5, v5, 4, v9
    v_add_u32 v5, 81920, v5
    v_lshlrev_b32 v6, 4, v6
    v_add_u32 v6, 153600, v6
    v_lshlrev_b32 v8, 6, v8
    v_xor_b32 v8, v8, v0
    s_add_u32 s31, s18, 8
    s_mul_i32 s32, s31, 2576
    s_add_u32 s32, s32, 34176
    s_mul_i32 s33, s31, 2848
    v_add_u32 v9, s32, v8
    s_sub_u32 s31, s33, 2560
    v_add_u32 v240, s31, v8
    v_cndmask_b32 v241, v240, v9, s[36:37]
    s_lshl_b32 s52, s24, 4
    s_add_u32 s52, s52, s17
    s_lshl_b32 s30, s52, 7
    s_add_u32 s30, s30, 32374784
    s_mul_i32 s52, s52, 5120
    s_add_u32 s52, s52, s21
    s_add_u32 s52, s52, 11796480
    s_add_u32 s53, s52, 4096
    s_getpc_b64 s[56:57]
L_pc2:
    s_add_u32 s56, s56, L_att_tab-L_pc2
    s_addc_u32 s57, s57, 0
    s_mov_b32 s58, 5120
    s_mov_b32 s59, 0x00020000
    s_mov_b32 s60, 4096
    s_mul_i32 s61, s18, 2576
    s_mul_i32 s62, s18, 2848
    s_lshl_b32 s31, s24, 9
    s_lshl_b32 s29, s17, 3
    s_add_u32 s31, s31, s29
    s_add_u32 s31, s31, 32342016
    s_mul_i32 s29, s17, 2560
    s_add_u32 s25, s25, s29
    s_add_u32 s25, s25, 2621440
    s_lshl_b32 s28, s24, 11
    s_add_u32 s28, s28, 32505856
    s_cmp_eq_u32 s23, 0
    s_cselect_b32 s27, s28, s27
    s_cselect_b32 s28, 7, 3
    s_cbranch_scc1 L_q_nopub
    s_cmp_lg_u32 s22, 0
    s_cbranch_scc1 L_slow_cw_1
    v_mov_b32 v10, s81
    v_mov_b32 v11, s72
    s_waitcnt vmcnt(0)
    s_mov_b64 exec, 1
    buffer_store_dwordx2 v[10:11], off, s[4:7], s80
    s_mov_b64 exec, -1
L_back_cw_2:
L_q_nopub:
    v_lshlrev_b32 v250, s28, v1
    s_mov_b64 exec, 0xffff
    s_mov_b32 s90, 0
L_poll_cw_3:
    buffer_load_dwordx2 v[10:11], v250, s[4:7], s27 offen sc1
    s_add_u32 s90, s90, 1
    s_cmp_gt_u32 s90, 200000
    s_cbranch_scc1 L_poll_cw_3_out
    s_waitcnt vmcnt(0)
    v_subrev_u32 v10, s86, v10
    v_xor_b32 v11, s72, v11
    v_or_b32 v11, v10, v11
    v_cmp_lt_u32 vcc, 7, v11
    s_cbranch_vccnz L_poll_cw_3
L_poll_cw_3_out:
    s_mov_b64 exec, -1
    s_cmp_lt_u32 s101, 864
    s_cbranch_scc1 L_js
L_js_b:
    ds_read_u8 v252, v248 offset:64
    buffer_load_dwordx4 v[80:83], v0, s[4:7], s40 offen offset:0 sc1
    buffer_load_dwordx4 v[84:87], v0, s[4:7], s40 offen offset:256 sc1
    buffer_load_dwordx4 v[88:91], v0, s[4:7], s40 offen offset:2048 sc1
    buffer_load_dwordx4 v[92:95], v0, s[4:7], s40 offen offset:2304 sc1
    buffer_load_dwordx4 v[232:235], v2, s[4:7], s26 offen offset:0 sc1
    buffer_load_dwordx4 v[236:239], v2, s[4:7], s26 offen offset:1024 sc1
    buffer_load_dwordx4 v[96:99], v0, s[4:7], s41 offen offset:0 sc1
    buffer_load_dwordx4 v[100:103], v0, s[4:7], s41 offen offset:256 sc1
    buffer_load_dwordx4 v[104:107], v0, s[4:7], s41 offen offset:2048 sc1
    buffer_load_dwordx4 v[108:111], v0, s[4:7], s41 offen offset:2304 sc1
    buffer_load_dwordx4 v[112:115], v0, s[4:7], s42 offen offset:0 sc1
    buffer_load_dwordx4 v[116:119], v0, s[4:7], s42 offen offset:256 sc1
    buffer_load_dwordx4 v[120:123], v0, s[4:7], s42 offen offset:2048 sc1
    buffer_load_dwordx4 v[124:127], v0, s[4:7], s42 offen offset:2304 sc1
    buffer_load_dwordx4 v[128:131], v0, s[4:7], s43 offen offset:0 sc1
    buffer_load_dwordx4 v[132:135], v0, s[4:7], s43 offen offset:256 sc1
    s_waitcnt lgkmcnt(0)
    v_cmp_gt_u32 vcc, 1, v252
    s_cbranch_vccnz L_q_c0
L_q_c0_b:
    ds_read_b128 v[20:23], v2 offset:0
    ds_read_b128 v[24:27], v2 offset:1024
    ds_read_b128 v[28:31], v2 offset:2048
    ds_read_b128 v[32:35], v2 offset:3072
    ds_read_b128 v[36:39], v2 offset:4096
    ds_read_b128 v[40:43], v2 offset:5120
    s_waitcnt vmcnt(14) lgkmcnt(4)
    v_mfma_f32_16x16x32_bf16 v[48:51], v[20:23], v[80:83], 0
    ds_read_b128 v[44:47], v2 offset:6144
    v_mfma_f32_16x16x32_bf16 v[52:55], v[20:23], v[84:87], 0
    buffer_load_dwordx4 v[136:139], v0, s[4:7], s43 offen offset:2048 sc1
    v_mfma_f32_16x16x32_bf16 v[56:59], v[24:27], v[80:83], 0
    ds_read_b128 v[20:23], v2 offset:7168
    v_mfma_f32_16x16x32_bf16 v[60:63], v[24:27], v[84:87], 0
    s_waitcnt lgkmcnt(4)
    v_mfma_f32_16x16x32_bf16 v[64:67], v[28:31], v[80:83], 0
    ds_read_b128 v[24:27], v2 offset:8192
    v_mfma_f32_16x16x32_bf16 v[68:71], v[28:31], v[84:87], 0
    ds_read_u8 v252, v248 offset:64
    buffer_load_dwordx4 v[140:143], v0, s[4:7], s43 offen offset:2304 sc1
    v_mfma_f32_16x16x32_bf16 v[72:75], v[32:35], v[80:83], 0
    ds_read_b128 v[28:31], v2 offset:9216
    v_mfma_f32_16x16x32_bf16 v[76:79], v[32:35], v[84:87], 0
    s_waitcnt vmcnt(14) lgkmcnt(5)
    v_mfma_f32_16x16x32_bf16 v[48:51], v[36:39], v[88:91], v[48:51]
    ds_read_b128 v[32:35], v2 offset:10240
    v_mfma_f32_16x16x32_bf16 v[52:55], v[36:39], v[92:95], v[52:55]
    buffer_load_dwordx4 v[144:147], v0, s[4:7], s44 offen offset:0 sc1
    v_mfma_f32_16x16x32_bf16 v[56:59], v[40:43], v[88:91], v[56:59]
    ds_read_b128 v[36:39], v2 offset:11264
    v_mfma_f32_16x16x32_bf16 v[60:63], v[40:43], v[92:95], v[60:63]
    s_waitcnt lgkmcnt(5)
    v_mfma_f32_16x16x32_bf16 v[64:67], v[44:47], v[88:91], v[64:67]
    ds_read_b128 v[40:43], v2 offset:12288
    v_mfma_f32_16x16x32_bf16 v[68:71], v[44:47], v[92:95], v[68:71]
    buffer_load_dwordx4 v[148:151], v0, s[4:7], s44 offen offset:256 sc1
    v_mfma_f32_16x16x32_bf16 v[72:75], v[20:23], v[88:91], v[72:75]
    ds_read_b128 v[44:47], v2 offset:13312
    v_mfma_f32_16x16x32_bf16 v[76:79], v[20:23], v[92:95], v[76:79]
    s_waitcnt vmcnt(12) lgkmcnt(4)
    v_mfma_f32_16x16x32_bf16 v[48:51], v[24:27], v[96:99], v[48:51]
    ds_read_b128 v[20:23], v2 offset:14336
    v_mfma_f32_16x16x32_bf16 v[52:55], v[24:27], v[100:103], v[52:55]
    v_cmp_gt_u32 vcc, 2, v252
    s_cbranch_vccnz L_g_cw_4
L_g_cw_4_b:
    buffer_load_dwordx4 v[152:155], v0, s[4:7], s44 offen offset:2048 sc1
    v_mfma_f32_16x16x32_bf16 v[56:59], v[28:31], v[96:99], v[56:59]
    ds_read_b128 v[24:27], v2 offset:15360
    v_mfma_f32_16x16x32_bf16 v[60:63], v[28:31], v[100:103], v[60:63]
    s_waitcnt lgkmcnt(4)
    v_mfma_f32_16x16x32_bf16 v[64:67], v[32:35], v[96:99], v[64:67]
    ds_read_b128 v[28:31], v2 offset:16384
    v_mfma_f32_16x16x32_bf16 v[68:71], v[32:35], v[100:103], v[68:71]
    buffer_load_dwordx4 v[156:159], v0, s[4:7], s44 offen offset:2304 sc1
    v_mfma_f32_16x16x32_bf16 v[72:75], v[36:39], v[96:99], v[72:75]
    ds_read_b128 v[32:35], v2 offset:17408
    v_mfma_f32_16x16x32_bf16 v[76:79], v[36:39], v[100:103], v[76:79]
    s_waitcnt vmcnt(12) lgkmcnt(4)
    v_mfma_f32_16x16x32_bf16 v[48:51], v[40:43], v[104:107], v[48:51]
    ds_read_b128 v[36:39], v2 offset:18432
    v_mfma_f32_16x16x32_bf16 v[52:55], v[40:43], v[108:111], v[52:55]
    buffer_load_dwordx4 v[160:163], v0, s[4:7], s45 offen offset:0 sc1
    v_mfma_f32_16x16x32_bf16 v[56:59], v[44:47], v[104:107], v[56:59]
    ds_read_b128 v[40:43], v2 offset:19456
    v_mfma_f32_16x16x32_bf16 v[60:63], v[44:47], v[108:111], v[60:63]
    s_waitcnt lgkmcnt(4)
    v_mfma_f32_16x16x32_bf16 v[64:67], v[20:23], v[104:107], v[64:67]
    ds_read_b128 v[44:47], v2 offset:20480
    v_mfma_f32_16x16x32_bf16 v[68:71], v[20:23], v[108:111], v[68:71]
    buffer_load_dwordx4 v[164:167], v0, s[4:7], s45 offen offset:256 sc1
    v_mfma_f32_16x16x32_bf16 v[72:75], v[24:27], v[104:107], v[72:75]
    ds_read_b128 v[20:23], v2 offset:21504
    v_mfma_f32_16x16x32_bf16 v[76:79], v[24:27], v[108:111], v[76:79]
    s_waitcnt vmcnt(12) lgkmcnt(4)
    v_mfma_f32_16x16x32_bf16 v[48:51], v[28:31], v[112:115], v[48:51]
    ds_read_b128 v[24:27], v2 offset:22528
    v_mfma_f32_16x16x32_bf16 v[52:55], v[28:31], v[116:119], v[52:55]
    buffer_load_dwordx4 v[168:171], v0, s[4:7], s45 offen offset:2048 sc1
    s_waitcnt vmcnt(19)
    v_mfma_f32_16x16x32_bf16 v[56:59], v[32:35], v[112:115], v[56:59]
    ds_read_b128 v[28:31], v2 offset:23552
    v_mfma_f32_16x16x32_bf16 v[60:63], v[32:35], v[116:119], v[60:63]
    ds_read_u8 v252, v248 offset:64
    v_pk_add_f32 v[232:233], v[232:233], v[234:235]
    s_waitcnt lgkmcnt(5)
    v_mfma_f32_16x16x32_bf16 v[64:67], v[36:39], v[112:115], v[64:67]
    ds_read_b128 v[32:35], v2 offset:24576
    v_mfma_f32_16x16x32_bf16 v[68:71], v[36:39], v[116:119], v[68:71]
    buffer_load_dwordx4 v[172:175], v0, s[4:7], s45 offen offset:2304 sc1
    v_pk_add_f32 v[236:237], v[236:237], v[238:239]
    v_mfma_f32_16x16x32_bf16 v[72:75], v[40:43], v[112:115], v[72:75]
    ds_read_b128 v[36:39], v2 offset:25600
    v_mfma_f32_16x16x32_bf16 v[76:79], v[40:43], v[116:119], v[76:79]
    v_pk_add_f32 v[234:235], v[232:233], v[236:237]
    s_waitcnt vmcnt(12) lgkmcnt(5)
    v_mfma_f32_16x16x32_bf16 v[48:51], v[44:47], v[120:123], v[48:51]
    ds_read_b128 v[40:43], v2 offset:26624
    v_mfma_f32_16x16x32_bf16 v[52:55], v[44:47], v[124:127], v[52:55]
    buffer_load_dwordx4 v[176:179], v0, s[4:7], s46 offen offset:0 sc1
    v_pk_add_f32 v[232:233], v[232:233], v[236:237]
    v_mfma_f32_16x16x32_bf16 v[56:59], v[20:23], v[120:123], v[56:59]
    ds_read_b128 v[44:47], v2 offset:27648
    v_mfma_f32_16x16x32_bf16 v[60:63], v[20:23], v[124:127], v[60:63]
    v_permlane32_swap_b32 v232, v234
    s_waitcnt lgkmcnt(5)
    v_mfma_f32_16x16x32_bf16 v[64:67], v[24:27], v[120:123], v[64:67]
    ds_read_b128 v[20:23], v2 offset:28672
    v_mfma_f32_16x16x32_bf16 v[68:71], v[24:27], v[124:127], v[68:71]
    buffer_load_dwordx4 v[180:183], v0, s[4:7], s46 offen offset:256 sc1
    v_permlane32_swap_b32 v233, v235
    v_mfma_f32_16x16x32_bf16 v[72:75], v[28:31], v[120:123], v[72:75]
    ds_read_b128 v[24:27], v2 offset:29696
    v_mfma_f32_16x16x32_bf16 v[76:79], v[28:31], v[124:127], v[76:79]
    s_waitcnt lgkmcnt(6)
    v_cmp_gt_u32 vcc, 3, v252
    s_cbranch_vccnz L_g_cw_5
L_g_cw_5_b:
    v_pk_add_f32 v[232:233], v[232:233], v[234:235]
    s_waitcnt vmcnt(12) lgkmcnt(4)
    v_mfma_f32_16x16x32_bf16 v[48:51], v[32:35], v[128:131], v[48:51]
    ds_read_b128 v[28:31], v2 offset:30720
    v_mfma_f32_16x16x32_bf16 v[52:55], v[32:35], v[132:135], v[52:55]
    buffer_load_dwordx4 v[184:187], v0, s[4:7], s46 offen offset:2048 sc1
    v_mul_f32 v232, 0xbacccccd, v232
    v_mfma_f32_16x16x32_bf16 v[56:59], v[36:39], v[128:131], v[56:59]
    ds_read_b128 v[32:35], v2 offset:31744
    v_mfma_f32_16x16x32_bf16 v[60:63], v[36:39], v[132:135], v[60:63]
    v_mul_f32 v233, 0x3acccccd, v233
    s_waitcnt lgkmcnt(4)
    v_mfma_f32_16x16x32_bf16 v[64:67], v[40:43], v[128:131], v[64:67]
    ds_read_b128 v[36:39], v2 offset:32768
    v_mfma_f32_16x16x32_bf16 v[68:71], v[40:43], v[132:135], v[68:71]
    buffer_load_dwordx4 v[188:191], v0, s[4:7], s46 offen offset:2304 sc1
    v_fma_f32 v233, -v232, v232, v233
    v_mfma_f32_16x16x32_bf16 v[72:75], v[44:47], v[128:131], v[72:75]
    ds_read_b128 v[40:43], v2 offset:33792
    v_mfma_f32_16x16x32_bf16 v[76:79], v[44:47], v[132:135], v[76:79]
    v_max_f32 v233, 0, v233
    s_waitcnt vmcnt(12) lgkmcnt(4)
    v_mfma_f32_16x16x32_bf16 v[48:51], v[20:23], v[136:139], v[48:51]
    ds_read_b128 v[44:47], v2 offset:34816
    v_mfma_f32_16x16x32_bf16 v[52:55], v[20:23], v[140:143], v[52:55]
    buffer_load_dwordx4 v[192:195], v0, s[4:7], s47 offen offset:0 sc1
    v_add_f32 v233, 0x3727c5ac, v233
    v_mfma_f32_16x16x32_bf16 v[56:59], v[24:27], v[136:139], v[56:59]
    ds_read_b128 v[20:23], v2 offset:35840
    v_mfma_f32_16x16x32_bf16 v[60:63], v[24:27], v[140:143], v[60:63]
    v_rsq_f32 v242, v233
    s_waitcnt lgkmcnt(4)
    v_mfma_f32_16x16x32_bf16 v[64:67], v[28:31], v[136:139], v[64:67]
    ds_read_b128 v[24:27], v2 offset:36864
    v_mfma_f32_16x16x32_bf16 v[68:71], v[28:31], v[140:143], v[68:71]
    buffer_load_dwordx4 v[196:199], v0, s[4:7], s47 offen offset:256 sc1
    v_cvt_pk_bf16_f32 v236, v232, v232
    v_mfma_f32_16x16x32_bf16 v[72:75], v[32:35], v[136:139], v[72:75]
    ds_read_b128 v[28:31], v2 offset:37888
    v_mfma_f32_16x16x32_bf16 v[76:79], v[32:35], v[140:143], v[76:79]
    v_mul_f32 v233, v233, v242
    s_waitcnt vmcnt(12) lgkmcnt(4)
    v_mfma_f32_16x16x32_bf16 v[48:51], v[36:39], v[144:147], v[48:51]
    ds_read_b128 v[32:35], v2 offset:38912
    v_mfma_f32_16x16x32_bf16 v[52:55], v[36:39], v[148:151], v[52:55]
    ds_read_u8 v252, v248 offset:64
    buffer_load_dwordx4 v[200:203], v0, s[4:7], s47 offen offset:2048 sc1
    v_mov_b32 v243, v242
    v_mfma_f32_16x16x32_bf16 v[56:59], v[40:43], v[144:147], v[56:59]
    ds_read_b128 v[36:39], v2 offset:39936
    v_mfma_f32_16x16x32_bf16 v[60:63], v[40:43], v[148:151], v[60:63]
    v_and_b32 v234, 0xffff0000, v236
    s_waitcnt lgkmcnt(5)
    v_mfma_f32_16x16x32_bf16 v[64:67], v[44:47], v[144:147], v[64:67]
    ds_read_b128 v[40:43], v2 offset:40960
    v_mfma_f32_16x16x32_bf16 v[68:71], v[44:47], v[148:151], v[68:71]
    buffer_load_dwordx4 v[204:207], v0, s[4:7], s47 offen offset:2304 sc1
    v_permlane16_swap_b32 v242, v243
    v_mfma_f32_16x16x32_bf16 v[72:75], v[20:23], v[144:147], v[72:75]
    ds_read_b128 v[44:47], v2 offset:41984
    v_mfma_f32_16x16x32_bf16 v[76:79], v[20:23], v[148:151], v[76:79]
    v_sub_f32 v234, v232, v234
    s_waitcnt vmcnt(12) lgkmcnt(5)
    v_mfma_f32_16x16x32_bf16 v[48:51], v[24:27], v[152:155], v[48:51]
    ds_read_b128 v[20:23], v2 offset:43008
    v_mfma_f32_16x16x32_bf16 v[52:55], v[24:27], v[156:159], v[52:55]
    buffer_load_dwordx4 v[208:211], v0, s[4:7], s48 offen offset:0 sc1
    v_cvt_pk_bf16_f32 v237, v234, v233
    v_mfma_f32_16x16x32_bf16 v[56:59], v[28:31], v[152:155], v[56:59]
    ds_read_b128 v[24:27], v2 offset:44032
    v_mfma_f32_16x16x32_bf16 v[60:63], v[28:31], v[156:159], v[60:63]
    v_and_b32 v235, 0xffff0000, v237
    s_waitcnt lgkmcnt(4)
    v_mfma_f32_16x16x32_bf16 v[64:67], v[32:35], v[152:155], v[64:67]
    ds_read_b128 v[28:31], v2 offset:45056
    v_mfma_f32_16x16x32_bf16 v[68:71], v[32:35], v[156:159], v[68:71]
    v_cmp_gt_u32 vcc, 4, v252
    s_cbranch_vccnz L_g_cw_6
L_g_cw_6_b:
    buffer_load_dwordx4 v[212:215], v0, s[4:7], s48 offen offset:256 sc1
    v_sub_f32 v235, v233, v235
    v_mfma_f32_16x16x32_bf16 v[72:75], v[36:39], v[152:155], v[72:75]
    ds_read_b128 v[32:35], v2 offset:46080
    v_mfma_f32_16x16x32_bf16 v[76:79], v[36:39], v[156:159], v[76:79]
    v_lshrrev_b32 v238, 16, v235
    s_waitcnt vmcnt(12) lgkmcnt(4)
    v_mfma_f32_16x16x32_bf16 v[48:51], v[40:43], v[160:163], v[48:51]
    ds_read_b128 v[36:39], v2 offset:47104
    v_mfma_f32_16x16x32_bf16 v[52:55], v[40:43], v[164:167], v[52:55]
    buffer_load_dwordx4 v[216:219], v0, s[4:7], s48 offen offset:2048 sc1
    v_cndmask_b32 v12, 0, v236, s[36:37]
    v_mfma_f32_16x16x32_bf16 v[56:59], v[44:47], v[160:163], v[56:59]
    ds_read_b128 v[40:43], v2 offset:48128
    v_mfma_f32_16x16x32_bf16 v[60:63], v[44:47], v[164:167], v[60:63]
    v_cndmask_b32 v13, 0, v237, s[36:37]
    s_waitcnt lgkmcnt(4)
    v_mfma_f32_16x16x32_bf16 v[64:67], v[20:23], v[160:163], v[64:67]
    ds_read_b128 v[44:47], v2 offset:49152
    v_mfma_f32_16x16x32_bf16 v[68:71], v[20:23], v[164:167], v[68:71]
    buffer_load_dwordx4 v[220:223], v0, s[4:7], s48 offen offset:2304 sc1
    v_cndmask_b32 v14, 0, v238, s[36:37]
    v_mfma_f32_16x16x32_bf16 v[72:75], v[24:27], v[160:163], v[72:75]
    ds_read_b128 v[20:23], v2 offset:50176
    v_mfma_f32_16x16x32_bf16 v[76:79], v[24:27], v[164:167], v[76:79]
    v_mov_b32 v15, 0
    s_waitcnt vmcnt(12) lgkmcnt(4)
    v_mfma_f32_16x16x32_bf16 v[48:51], v[28:31], v[168:171], v[48:51]
    ds_read_b128 v[24:27], v2 offset:51200
    v_mfma_f32_16x16x32_bf16 v[52:55], v[28:31], v[172:175], v[52:55]
    buffer_load_dwordx4 v[224:227], v0, s[4:7], s49 offen offset:0 sc1
    v_cndmask_b32 v16, 0, v236, s[34:35]
    v_mfma_f32_16x16x32_bf16 v[56:59], v[32:35], v[168:171], v[56:59]
    ds_read_b128 v[28:31], v2 offset:52224
    v_mfma_f32_16x16x32_bf16 v[60:63], v[32:35], v[172:175], v[60:63]
    v_cndmask_b32 v17, 0, v237, s[34:35]
    s_waitcnt lgkmcnt(4)
    v_mfma_f32_16x16x32_bf16 v[64:67], v[36:39], v[168:171], v[64:67]
    ds_read_b128 v[32:35], v2 offset:53248
    v_mfma_f32_16x16x32_bf16 v[68:71], v[36:39], v[172:175], v[68:71]
    buffer_load_dwordx4 v[228:231], v0, s[4:7], s49 offen offset:256 sc1
    v_cndmask_b32 v18, 0, v238, s[34:35]
    v_mfma_f32_16x16x32_bf16 v[72:75], v[40:43], v[168:171], v[72:75]
    ds_read_b128 v[36:39], v2 offset:54272
    v_mfma_f32_16x16x32_bf16 v[76:79], v[40:43], v[172:175], v[76:79]
    ds_read_u8 v252, v248 offset:64
    v_mov_b32 v19, 0
    s_waitcnt vmcnt(12) lgkmcnt(5)
    v_mfma_f32_16x16x32_bf16 v[48:51], v[44:47], v[176:179], v[48:51]
    ds_read_b128 v[40:43], v2 offset:55296
    v_mfma_f32_16x16x32_bf16 v[52:55], v[44:47], v[180:183], v[52:55]
    v_mul_f32 v244, 0x3ea52b5c, v242
    v_mfma_f32_16x16x32_bf16 v[56:59], v[20:23], v[176:179], v[56:59]
    ds_read_b128 v[44:47], v2 offset:56320
    v_mfma_f32_16x16x32_bf16 v[60:63], v[20:23], v[180:183], v[60:63]
    v_mul_f32 v245, 0x3ea52b5c, v243
    s_waitcnt lgkmcnt(5)
    v_mfma_f32_16x16x32_bf16 v[64:67], v[24:27], v[176:179], v[64:67]
    ds_read_b128 v[20:23], v2 offset:57344
    v_mfma_f32_16x16x32_bf16 v[68:71], v[24:27], v[180:183], v[68:71]
    v_cndmask_b32 v246, v244, v242, s[38:39]
    v_mfma_f32_16x16x32_bf16 v[72:75], v[28:31], v[176:179], v[72:75]
    ds_read_b128 v[24:27], v2 offset:58368
    v_mfma_f32_16x16x32_bf16 v[76:79], v[28:31], v[180:183], v[76:79]
    v_cndmask_b32 v247, v245, v243, s[38:39]
    s_waitcnt vmcnt(10) lgkmcnt(5)
    v_mfma_f32_16x16x32_bf16 v[48:51], v[32:35], v[184:187], v[48:51]
    ds_read_b128 v[28:31], v2 offset:59392
    v_mfma_f32_16x16x32_bf16 v[52:55], v[32:35], v[188:191], v[52:55]
    v_mfma_f32_16x16x32_bf16 v[56:59], v[36:39], v[184:187], v[56:59]
    ds_read_b128 v[32:35], v2 offset:60416
    v_mfma_f32_16x16x32_bf16 v[60:63], v[36:39], v[188:191], v[60:63]
    s_waitcnt lgkmcnt(6)
    v_cmp_gt_u32 vcc, 5, v252
    s_cbranch_vccnz L_g_cw_7
L_g_cw_7_b:
    s_waitcnt lgkmcnt(4)
    v_mfma_f32_16x16x32_bf16 v[64:67], v[40:43], v[184:187], v[64:67]
    ds_read_b128 v[36:39], v4 offset:0
    v_mfma_f32_16x16x32_bf16 v[68:71], v[40:43], v[188:191], v[68:71]
    v_mfma_f32_16x16x32_bf16 v[72:75], v[44:47], v[184:187], v[72:75]
    ds_read_b128 v[40:43], v4 offset:1024
    v_mfma_f32_16x16x32_bf16 v[76:79], v[44:47], v[188:191], v[76:79]
    s_waitcnt vmcnt(8) lgkmcnt(4)
    v_mfma_f32_16x16x32_bf16 v[48:51], v[20:23], v[192:195], v[48:51]
    ds_read_b128 v[44:47], v4 offset:2048
    v_mfma_f32_16x16x32_bf16 v[52:55], v[20:23], v[196:199], v[52:55]
    v_mfma_f32_16x16x32_bf16 v[56:59], v[24:27], v[192:195], v[56:59]
    ds_read_b128 v[20:23], v4 offset:3072
    v_mfma_f32_16x16x32_bf16 v[60:63], v[24:27], v[196:199], v[60:63]
    s_waitcnt lgkmcnt(4)
    v_mfma_f32_16x16x32_bf16 v[64:67], v[28:31], v[192:195], v[64:67]
    ds_read_b128 v[24:27], v4 offset:4096
    v_mfma_f32_16x16x32_bf16 v[68:71], v[28:31], v[196:199], v[68:71]
    v_mfma_f32_16x16x32_bf16 v[72:75], v[32:35], v[192:195], v[72:75]
    ds_read_b128 v[28:31], v4 offset:5120
    v_mfma_f32_16x16x32_bf16 v[76:79], v[32:35], v[196:199], v[76:79]
    s_waitcnt vmcnt(6) lgkmcnt(4)
    v_mfma_f32_16x16x32_bf16 v[48:51], v[36:39], v[200:203], v[48:51]
    ds_read_b128 v[32:35], v4 offset:6144
    v_mfma_f32_16x16x32_bf16 v[52:55], v[36:39], v[204:207], v[52:55]
    buffer_load_dwordx4 v[232:235], v0, s[4:7], s49 offen offset:2048 sc1
    v_mfma_f32_16x16x32_bf16 v[56:59], v[40:43], v[200:203], v[56:59]
    ds_read_b128 v[36:39], v4 offset:7168
    v_mfma_f32_16x16x32_bf16 v[60:63], v[40:43], v[204:207], v[60:63]
    s_waitcnt lgkmcnt(4)
    v_mfma_f32_16x16x32_bf16 v[64:67], v[44:47], v[200:203], v[64:67]
    ds_read_b128 v[40:43], v4 offset:8192
    v_mfma_f32_16x16x32_bf16 v[68:71], v[44:47], v[204:207], v[68:71]
    ds_read_u8 v252, v248 offset:64
    buffer_load_dwordx4 v[236:239], v0, s[4:7], s49 offen offset:2304 sc1
    v_mfma_f32_16x16x32_bf16 v[72:75], v[20:23], v[200:203], v[72:75]
    ds_read_b128 v[44:47], v4 offset:9216
    v_mfma_f32_16x16x32_bf16 v[76:79], v[20:23], v[204:207], v[76:79]
    s_waitcnt vmcnt(6) lgkmcnt(5)
    v_mfma_f32_16x16x32_bf16 v[48:51], v[24:27], v[208:211], v[48:51]
    ds_read_b128 v[20:23], v4 offset:10240
    v_mfma_f32_16x16x32_bf16 v[52:55], v[24:27], v[212:215], v[52:55]
    v_mfma_f32_16x16x32_bf16 v[56:59], v[28:31], v[208:211], v[56:59]
    ds_read_b128 v[24:27], v4 offset:11264
    v_mfma_f32_16x16x32_bf16 v[60:63], v[28:31], v[212:215], v[60:63]
    s_waitcnt lgkmcnt(5)
    v_mfma_f32_16x16x32_bf16 v[64:67], v[32:35], v[208:211], v[64:67]
    ds_read_b128 v[28:31], v4 offset:12288
    v_mfma_f32_16x16x32_bf16 v[68:71], v[32:35], v[212:215], v[68:71]
    v_mfma_f32_16x16x32_bf16 v[72:75], v[36:39], v[208:211], v[72:75]
    ds_read_b128 v[32:35], v4 offset:13312
    v_mfma_f32_16x16x32_bf16 v[76:79], v[36:39], v[212:215], v[76:79]
    s_waitcnt vmcnt(4) lgkmcnt(4)
    v_mfma_f32_16x16x32_bf16 v[48:51], v[40:43], v[216:219], v[48:51]
    ds_read_b128 v[36:39], v4 offset:14336
    v_mfma_f32_16x16x32_bf16 v[52:55], v[40:43], v[220:223], v[52:55]
    v_cmp_gt_u32 vcc, 6, v252
    s_cbranch_vccnz L_g_cw_8
L_g_cw_8_b:
    v_mfma_f32_16x16x32_bf16 v[56:59], v[44:47], v[216:219], v[56:59]
    ds_read_b128 v[40:43], v4 offset:15360
    v_mfma_f32_16x16x32_bf16 v[60:63], v[44:47], v[220:223], v[60:63]
    s_waitcnt lgkmcnt(4)
    v_mfma_f32_16x16x32_bf16 v[64:67], v[20:23], v[216:219], v[64:67]
    ds_read_b128 v[44:47], v4 offset:16384
    v_mfma_f32_16x16x32_bf16 v[68:71], v[20:23], v[220:223], v[68:71]
    v_mfma_f32_16x16x32_bf16 v[72:75], v[24:27], v[216:219], v[72:75]
    ds_read_b128 v[20:23], v4 offset:17408
    v_mfma_f32_16x16x32_bf16 v[76:79], v[24:27], v[220:223], v[76:79]
    s_waitcnt vmcnt(2) lgkmcnt(4)
    v_mfma_f32_16x16x32_bf16 v[48:51], v[28:31], v[224:227], v[48:51]
    ds_read_b128 v[24:27], v4 offset:18432
    v_mfma_f32_16x16x32_bf16 v[52:55], v[28:31], v[228:231], v[52:55]
    v_mfma_f32_16x16x32_bf16 v[56:59], v[32:35], v[224:227], v[56:59]
    ds_read_b128 v[28:31], v4 offset:19456
    v_mfma_f32_16x16x32_bf16 v[60:63], v[32:35], v[228:231], v[60:63]
    v_mov_b32 v251, 6
    s_waitcnt lgkmcnt(4)
    v_mfma_f32_16x16x32_bf16 v[64:67], v[36:39], v[224:227], v[64:67]
    ds_read_b128 v[32:35], v6 offset:0
    v_mfma_f32_16x16x32_bf16 v[68:71], v[36:39], v[228:231], v[68:71]
    ds_write_b8 v249, v251 offset:68
    v_mfma_f32_16x16x32_bf16 v[72:75], v[40:43], v[224:227], v[72:75]
    ds_read_b128 v[36:39], v6 offset:256
    v_mfma_f32_16x16x32_bf16 v[76:79], v[40:43], v[228:231], v[76:79]
    s_waitcnt vmcnt(0) lgkmcnt(5)
    v_mfma_f32_16x16x32_bf16 v[48:51], v[44:47], v[232:235], v[48:51]
    ds_read_b128 v[40:43], v6 offset:512
    v_mfma_f32_16x16x32_bf16 v[52:55], v[44:47], v[236:239], v[52:55]
    v_mfma_f32_16x16x32_bf16 v[56:59], v[20:23], v[232:235], v[56:59]
    ds_read_b128 v[44:47], v6 offset:768
    v_mfma_f32_16x16x32_bf16 v[60:63], v[20:23], v[236:239], v[60:63]
    s_waitcnt lgkmcnt(5)
    v_mfma_f32_16x16x32_bf16 v[64:67], v[24:27], v[232:235], v[64:67]
    ds_read_b128 v[20:23], v5 offset:0
    v_mfma_f32_16x16x32_bf16 v[68:71], v[24:27], v[236:239], v[68:71]
    v_mfma_f32_16x16x32_bf16 v[72:75], v[28:31], v[232:235], v[72:75]
    ds_read_b128 v[24:27], v5 offset:768
    v_mfma_f32_16x16x32_bf16 v[76:79], v[28:31], v[236:239], v[76:79]
    s_waitcnt lgkmcnt(4)
    v_mfma_f32_16x16x32_bf16 v[48:51], v[32:35], v[12:15], v[48:51]
    ds_read_b128 v[28:31], v5 offset:1536
    v_mfma_f32_16x16x32_bf16 v[52:55], v[32:35], v[16:19], v[52:55]
    v_mfma_f32_16x16x32_bf16 v[56:59], v[36:39], v[12:15], v[56:59]
    ds_read_b128 v[32:35], v5 offset:2304
    v_mfma_f32_16x16x32_bf16 v[60:63], v[36:39], v[16:19], v[60:63]
    s_waitcnt lgkmcnt(4)
    v_mfma_f32_16x16x32_bf16 v[64:67], v[40:43], v[12:15], v[64:67]
    ds_read_b128 v[36:39], v5 offset:3072
    v_mfma_f32_16x16x32_bf16 v[68:71], v[40:43], v[16:19], v[68:71]
    v_mfma_f32_16x16x32_bf16 v[72:75], v[44:47], v[12:15], v[72:75]
    ds_read_b128 v[40:43], v5 offset:3840
    v_mfma_f32_16x16x32_bf16 v[76:79], v[44:47], v[16:19], v[76:79]
    s_nop 3
    v_pk_mul_f32 v[48:49], v[48:49], v[242:243] op_sel_hi:[1,0]
    v_pk_mul_f32 v[50:51], v[50:51], v[242:243] op_sel_hi:[1,0]
    v_pk_mul_f32 v[56:57], v[56:57], v[242:243] op_sel_hi:[1,0]
    v_pk_mul_f32 v[58:59], v[58:59], v[242:243] op_sel_hi:[1,0]
    v_cvt_pk_bf16_f32 v48, v48, v49
    v_cvt_pk_bf16_f32 v49, v50, v51
    v_cvt_pk_bf16_f32 v50, v56, v57
    v_cvt_pk_bf16_f32 v51, v58, v59
    buffer_store_dwordx4 v[48:51], v8, s[4:7], s52 offen offset:0 sc1
    v_pk_mul_f32 v[52:53], v[52:53], v[242:243] op_sel:[0,1] op_sel_hi:[1,1]
    v_pk_mul_f32 v[54:55], v[54:55], v[242:243] op_sel:[0,1] op_sel_hi:[1,1]
    v_pk_mul_f32 v[60:61], v[60:61], v[242:243] op_sel:[0,1] op_sel_hi:[1,1]
    v_pk_mul_f32 v[62:63], v[62:63], v[242:243] op_sel:[0,1] op_sel_hi:[1,1]
    v_cvt_pk_bf16_f32 v52, v52, v53
    v_cvt_pk_bf16_f32 v53, v54, v55
    v_cvt_pk_bf16_f32 v54, v60, v61
    v_cvt_pk_bf16_f32 v55, v62, v63
    buffer_store_dwordx4 v[52:55], v8, s[4:7], s52 offen offset:256 sc1
    v_pk_mul_f32 v[64:65], v[64:65], v[242:243] op_sel_hi:[1,0]
    v_pk_mul_f32 v[66:67], v[66:67], v[242:243] op_sel_hi:[1,0]
    v_pk_mul_f32 v[72:73], v[72:73], v[242:243] op_sel_hi:[1,0]
    v_pk_mul_f32 v[74:75], v[74:75], v[242:243] op_sel_hi:[1,0]
    v_cvt_pk_bf16_f32 v64, v64, v65
    v_cvt_pk_bf16_f32 v65, v66, v67
    v_cvt_pk_bf16_f32 v66, v72, v73
    v_cvt_pk_bf16_f32 v67, v74, v75
    buffer_store_dwordx4 v[64:67], v8, s[4:7], s52 offen offset:2048 sc1
    v_pk_mul_f32 v[68:69], v[68:69], v[242:243] op_sel:[0,1] op_sel_hi:[1,1]
    v_pk_mul_f32 v[70:71], v[70:71], v[242:243] op_sel:[0,1] op_sel_hi:[1,1]
    v_pk_mul_f32 v[76:77], v[76:77], v[242:243] op_sel:[0,1] op_sel_hi:[1,1]
    v_pk_mul_f32 v[78:79], v[78:79], v[242:243] op_sel:[0,1] op_sel_hi:[1,1]
    v_cvt_pk_bf16_f32 v68, v68, v69
    v_cvt_pk_bf16_f32 v69, v70, v71
    v_cvt_pk_bf16_f32 v70, v76, v77
    v_cvt_pk_bf16_f32 v71, v78, v79
    buffer_store_dwordx4 v[68:71], v8, s[4:7], s52 offen offset:2304 sc1
    s_waitcnt lgkmcnt(3)
    v_mfma_f32_16x16x32_bf16 v[56:59], v[20:23], v[80:83], 0
    ds_read_b128 v[44:47], v5 offset:4608
    v_mfma_f32_16x16x32_bf16 v[60:63], v[20:23], v[84:87], 0
    ds_read_u8 v252, v248 offset:64
    v_mfma_f32_16x16x32_bf16 v[72:75], v[24:27], v[80:83], 0
    ds_read_b128 v[20:23], v5 offset:5376
    v_mfma_f32_16x16x32_bf16 v[76:79], v[24:27], v[84:87], 0
    v_mfma_f32_16x16x32_bf16 v[56:59], v[28:31], v[88:91], v[56:59]
    ds_read_b128 v[24:27], v5 offset:6144
    v_mfma_f32_16x16x32_bf16 v[60:63], v[28:31], v[92:95], v[60:63]
    s_waitcnt lgkmcnt(4)
    v_mfma_f32_16x16x32_bf16 v[72:75], v[32:35], v[88:91], v[72:75]
    ds_read_b128 v[28:31], v5 offset:6912
    v_mfma_f32_16x16x32_bf16 v[76:79], v[32:35], v[92:95], v[76:79]
    v_mfma_f32_16x16x32_bf16 v[56:59], v[36:39], v[96:99], v[56:59]
    ds_read_b128 v[32:35], v5 offset:7680
    v_mfma_f32_16x16x32_bf16 v[60:63], v[36:39], v[100:103], v[60:63]
    v_mfma_f32_16x16x32_bf16 v[72:75], v[40:43], v[96:99], v[72:75]
    ds_read_b128 v[36:39], v5 offset:8448
    v_mfma_f32_16x16x32_bf16 v[76:79], v[40:43], v[100:103], v[76:79]
    s_waitcnt lgkmcnt(3)
    v_mfma_f32_16x16x32_bf16 v[56:59], v[44:47], v[104:107], v[56:59]
    ds_read_b128 v[40:43], v5 offset:9216
    v_mfma_f32_16x16x32_bf16 v[60:63], v[44:47], v[108:111], v[60:63]
    v_cmp_gt_u32 vcc, 7, v252
    s_cbranch_vccnz L_g_cw_9
L_g_cw_9_b:
    v_mfma_f32_16x16x32_bf16 v[72:75], v[20:23], v[104:107], v[72:75]
    ds_read_b128 v[44:47], v5 offset:9984
    v_mfma_f32_16x16x32_bf16 v[76:79], v[20:23], v[108:111], v[76:79]
    v_mfma_f32_16x16x32_bf16 v[56:59], v[24:27], v[112:115], v[56:59]
    ds_read_b128 v[20:23], v5 offset:10752
    v_mfma_f32_16x16x32_bf16 v[60:63], v[24:27], v[116:119], v[60:63]
    s_waitcnt lgkmcnt(3)
    v_mfma_f32_16x16x32_bf16 v[72:75], v[28:31], v[112:115], v[72:75]
    ds_read_b128 v[24:27], v5 offset:11520
    v_mfma_f32_16x16x32_bf16 v[76:79], v[28:31], v[116:119], v[76:79]
    v_mfma_f32_16x16x32_bf16 v[56:59], v[32:35], v[120:123], v[56:59]
    ds_read_b128 v[28:31], v5 offset:12288
    v_mfma_f32_16x16x32_bf16 v[60:63], v[32:35], v[124:127], v[60:63]
    v_mfma_f32_16x16x32_bf16 v[72:75], v[36:39], v[120:123], v[72:75]
    ds_read_b128 v[32:35], v5 offset:13056
    v_mfma_f32_16x16x32_bf16 v[76:79], v[36:39], v[124:127], v[76:79]
    s_waitcnt lgkmcnt(3)
    v_mfma_f32_16x16x32_bf16 v[56:59], v[40:43], v[128:131], v[56:59]
    ds_read_b128 v[36:39], v5 offset:13824
    v_mfma_f32_16x16x32_bf16 v[60:63], v[40:43], v[132:135], v[60:63]
    v_mfma_f32_16x16x32_bf16 v[72:75], v[44:47], v[128:131], v[72:75]
    ds_read_b128 v[40:43], v5 offset:14592
    v_mfma_f32_16x16x32_bf16 v[76:79], v[44:47], v[132:135], v[76:79]
    v_mfma_f32_16x16x32_bf16 v[56:59], v[20:23], v[136:139], v[56:59]
    ds_read_b128 v[44:47], v5 offset:15360
    v_mfma_f32_16x16x32_bf16 v[60:63], v[20:23], v[140:143], v[60:63]
    s_waitcnt lgkmcnt(3)
    v_mfma_f32_16x16x32_bf16 v[72:75], v[24:27], v[136:139], v[72:75]
    ds_read_b128 v[20:23], v5 offset:16128
    v_mfma_f32_16x16x32_bf16 v[76:79], v[24:27], v[140:143], v[76:79]
    v_mfma_f32_16x16x32_bf16 v[56:59], v[28:31], v[144:147], v[56:59]
    ds_read_b128 v[24:27], v5 offset:16896
    v_mfma_f32_16x16x32_bf16 v[60:63], v[28:31], v[148:151], v[60:63]
    v_mfma_f32_16x16x32_bf16 v[72:75], v[32:35], v[144:147], v[72:75]
    ds_read_b128 v[28:31], v5 offset:17664
    v_mfma_f32_16x16x32_bf16 v[76:79], v[32:35], v[148:151], v[76:79]
    s_waitcnt lgkmcnt(3)
    v_mfma_f32_16x16x32_bf16 v[56:59], v[36:39], v[152:155], v[56:59]
    ds_read_b128 v[32:35], v5 offset:18432
    v_mfma_f32_16x16x32_bf16 v[60:63], v[36:39], v[156:159], v[60:63]
    v_mfma_f32_16x16x32_bf16 v[72:75], v[40:43], v[152:155], v[72:75]
    ds_read_b128 v[36:39], v5 offset:19200
    v_mfma_f32_16x16x32_bf16 v[76:79], v[40:43], v[156:159], v[76:79]
    v_mfma_f32_16x16x32_bf16 v[56:59], v[44:47], v[160:163], v[56:59]
    ds_read_b128 v[40:43], v5 offset:19968
    v_mfma_f32_16x16x32_bf16 v[60:63], v[44:47], v[164:167], v[60:63]
    ds_read_u8 v252, v248 offset:64
    s_waitcnt lgkmcnt(4)
    v_mfma_f32_16x16x32_bf16 v[72:75], v[20:23], v[160:163], v[72:75]
    ds_read_b128 v[44:47], v5 offset:20736
    v_mfma_f32_16x16x32_bf16 v[76:79], v[20:23], v[164:167], v[76:79]
    v_mfma_f32_16x16x32_bf16 v[56:59], v[24:27], v[168:171], v[56:59]
    ds_read_b128 v[20:23], v5 offset:21504
    v_mfma_f32_16x16x32_bf16 v[60:63], v[24:27], v[172:175], v[60:63]
    v_mfma_f32_16x16x32_bf16 v[72:75], v[28:31], v[168:171], v[72:75]
    ds_read_b128 v[24:27], v5 offset:22272
    v_mfma_f32_16x16x32_bf16 v[76:79], v[28:31], v[172:175], v[76:79]
    s_waitcnt lgkmcnt(4)
    v_mfma_f32_16x16x32_bf16 v[56:59], v[32:35], v[176:179], v[56:59]
    ds_read_b128 v[28:31], v5 offset:23040
    v_mfma_f32_16x16x32_bf16 v[60:63], v[32:35], v[180:183], v[60:63]
    ds_read_u8 v253, v248 offset:68
    v_mfma_f32_16x16x32_bf16 v[72:75], v[36:39], v[176:179], v[72:75]
    ds_read_b128 v[32:35], v5 offset:23808
    v_mfma_f32_16x16x32_bf16 v[76:79], v[36:39], v[180:183], v[76:79]
    v_mfma_f32_16x16x32_bf16 v[56:59], v[40:43], v[184:187], v[56:59]
    ds_read_b128 v[36:39], v5 offset:24576
    v_mfma_f32_16x16x32_bf16 v[60:63], v[40:43], v[188:191], v[60:63]
    s_waitcnt lgkmcnt(7)
    v_cmp_gt_u32 vcc, 8, v252
    s_cbranch_vccnz L_g_cw_10
L_g_cw_10_b:
    s_waitcnt lgkmcnt(4)
    v_mfma_f32_16x16x32_bf16 v[72:75], v[44:47], v[184:187], v[72:75]
    ds_read_b128 v[40:43], v5 offset:25344
    v_mfma_f32_16x16x32_bf16 v[76:79], v[44:47], v[188:191], v[76:79]
    v_mfma_f32_16x16x32_bf16 v[56:59], v[20:23], v[192:195], v[56:59]
    ds_read_b128 v[44:47], v5 offset:26112
    v_mfma_f32_16x16x32_bf16 v[60:63], v[20:23], v[196:199], v[60:63]
    v_mfma_f32_16x16x32_bf16 v[72:75], v[24:27], v[192:195], v[72:75]
    ds_read_b128 v[20:23], v5 offset:26880
    v_mfma_f32_16x16x32_bf16 v[76:79], v[24:27], v[196:199], v[76:79]
    s_waitcnt lgkmcnt(3)
    v_mfma_f32_16x16x32_bf16 v[56:59], v[28:31], v[200:203], v[56:59]
    ds_read_b128 v[24:27], v5 offset:27648
    v_mfma_f32_16x16x32_bf16 v[60:63], v[28:31], v[204:207], v[60:63]
    v_mfma_f32_16x16x32_bf16 v[72:75], v[32:35], v[200:203], v[72:75]
    ds_read_b128 v[28:31], v5 offset:28416
    v_mfma_f32_16x16x32_bf16 v[76:79], v[32:35], v[204:207], v[76:79]
    v_cmp_gt_u32 vcc, 6, v253
    s_cbranch_vccnz L_g_cw_11
L_g_cw_11_b:
    v_mfma_f32_16x16x32_bf16 v[56:59], v[36:39], v[208:211], v[56:59]
    ds_read_b128 v[32:35], v5 offset:29184
    v_mfma_f32_16x16x32_bf16 v[60:63], v[36:39], v[212:215], v[60:63]
    s_waitcnt lgkmcnt(3)
    v_mfma_f32_16x16x32_bf16 v[72:75], v[40:43], v[208:211], v[72:75]
    ds_read_b128 v[36:39], v5 offset:29952
    v_mfma_f32_16x16x32_bf16 v[76:79], v[40:43], v[212:215], v[76:79]
    ds_write_b128 v9, v[48:51] offset:0
    v_mfma_f32_16x16x32_bf16 v[56:59], v[44:47], v[216:219], v[56:59]
    ds_read_b128 v[40:43], v6 offset:1024
    v_mfma_f32_16x16x32_bf16 v[60:63], v[44:47], v[220:223], v[60:63]
    v_mov_b32 v10, s86
    v_mov_b32 v11, s72
    s_waitcnt vmcnt(0)
    s_mov_b64 exec, 1
    buffer_store_dwordx2 v[10:11], off, s[4:7], s30 sc1
    s_mov_b64 exec, -1
    ds_write_b128 v9, v[52:55] offset:256
    v_mfma_f32_16x16x32_bf16 v[72:75], v[20:23], v[216:219], v[72:75]
    ds_read_b128 v[44:47], v6 offset:1280
    v_mfma_f32_16x16x32_bf16 v[76:79], v[20:23], v[220:223], v[76:79]
    ds_write_b128 v241, v[64:67] offset:2048
    s_waitcnt lgkmcnt(6)
    v_mfma_f32_16x16x32_bf16 v[56:59], v[24:27], v[224:227], v[56:59]
    ds_read_b128 v[20:23], v7 offset:0
    v_mfma_f32_16x16x32_bf16 v[60:63], v[24:27], v[228:231], v[60:63]
    ds_write_b128 v241, v[68:71] offset:2304
    v_mfma_f32_16x16x32_bf16 v[72:75], v[28:31], v[224:227], v[72:75]
    ds_read_b128 v[24:27], v7 offset:1024
    v_mfma_f32_16x16x32_bf16 v[76:79], v[28:31], v[228:231], v[76:79]
    v_mfma_f32_16x16x32_bf16 v[56:59], v[32:35], v[232:235], v[56:59]
    ds_read_b128 v[28:31], v7 offset:2048
    v_mfma_f32_16x16x32_bf16 v[60:63], v[32:35], v[236:239], v[60:63]
    s_waitcnt lgkmcnt(5)
    v_mfma_f32_16x16x32_bf16 v[72:75], v[36:39], v[232:235], v[72:75]
    ds_read_b128 v[32:35], v7 offset:3072
    v_mfma_f32_16x16x32_bf16 v[76:79], v[36:39], v[236:239], v[76:79]
    ds_read_u8 v252, v248 offset:64
    v_mfma_f32_16x16x32_bf16 v[56:59], v[40:43], v[12:15], v[56:59]
    ds_read_b128 v[36:39], v7 offset:4096
    v_mfma_f32_16x16x32_bf16 v[60:63], v[40:43], v[16:19], v[60:63]
    v_mfma_f32_16x16x32_bf16 v[72:75], v[44:47], v[12:15], v[72:75]
    ds_read_b128 v[40:43], v7 offset:5120
    v_mfma_f32_16x16x32_bf16 v[76:79], v[44:47], v[16:19], v[76:79]
    s_waitcnt lgkmcnt(4)
    v_mfma_f32_16x16x32_bf16 v[48:51], v[20:23], v[80:83], 0
    ds_read_b128 v[44:47], v7 offset:6144
    v_mfma_f32_16x16x32_bf16 v[52:55], v[20:23], v[84:87], 0
    v_mfma_f32_16x16x32_bf16 v[64:67], v[24:27], v[80:83], 0
    ds_read_b128 v[20:23], v7 offset:7168
    v_mfma_f32_16x16x32_bf16 v[68:71], v[24:27], v[84:87], 0
    buffer_load_dwordx4 v[80:83], v2, s[56:59], 0 offen offset:0
    v_mfma_f32_16x16x32_bf16 v[48:51], v[28:31], v[88:91], v[48:51]
    ds_read_b128 v[24:27], v7 offset:8192
    v_mfma_f32_16x16x32_bf16 v[52:55], v[28:31], v[92:95], v[52:55]
    buffer_load_dwordx4 v[84:87], v2, s[56:59], 0 offen offset:1024
    s_waitcnt lgkmcnt(3)
    v_mfma_f32_16x16x32_bf16 v[64:67], v[32:35], v[88:91], v[64:67]
    ds_read_b128 v[28:31], v7 offset:9216
    v_mfma_f32_16x16x32_bf16 v[68:71], v[32:35], v[92:95], v[68:71]
    v_cmp_gt_u32 vcc, 9, v252
    s_cbranch_vccnz L_g_cw_12
L_g_cw_12_b:
    buffer_load_dwordx4 v[88:91], v2, s[56:59], 0 offen offset:2048
    v_mfma_f32_16x16x32_bf16 v[48:51], v[36:39], v[96:99], v[48:51]
    ds_read_b128 v[32:35], v7 offset:10240
    v_mfma_f32_16x16x32_bf16 v[52:55], v[36:39], v[100:103], v[52:55]
    buffer_load_dwordx4 v[92:95], v2, s[56:59], 0 offen offset:3072
    v_mfma_f32_16x16x32_bf16 v[64:67], v[40:43], v[96:99], v[64:67]
    ds_read_b128 v[36:39], v7 offset:11264
    v_mfma_f32_16x16x32_bf16 v[68:71], v[40:43], v[100:103], v[68:71]
    buffer_load_dwordx4 v[96:99], v2, s[56:59], s60 offen offset:0
    s_waitcnt lgkmcnt(3)
    v_mfma_f32_16x16x32_bf16 v[48:51], v[44:47], v[104:107], v[48:51]
    ds_read_b128 v[40:43], v7 offset:12288
    v_mfma_f32_16x16x32_bf16 v[52:55], v[44:47], v[108:111], v[52:55]
    v_pk_mul_f32 v[56:57], v[56:57], v[246:247] op_sel_hi:[1,0]
    v_pk_mul_f32 v[58:59], v[58:59], v[246:247] op_sel_hi:[1,0]
    v_mfma_f32_16x16x32_bf16 v[64:67], v[20:23], v[104:107], v[64:67]
    ds_read_b128 v[44:47], v7 offset:13312
    v_mfma_f32_16x16x32_bf16 v[68:71], v[20:23], v[108:111], v[68:71]
    v_pk_mul_f32 v[72:73], v[72:73], v[246:247] op_sel_hi:[1,0]
    v_pk_mul_f32 v[74:75], v[74:75], v[246:247] op_sel_hi:[1,0]
    v_mfma_f32_16x16x32_bf16 v[48:51], v[24:27], v[112:115], v[48:51]
    ds_read_b128 v[20:23], v7 offset:14336
    v_mfma_f32_16x16x32_bf16 v[52:55], v[24:27], v[116:119], v[52:55]
    v_cvt_pk_bf16_f32 v56, v56, v57
    v_cvt_pk_bf16_f32 v57, v58, v59
    s_waitcnt lgkmcnt(3)
    v_mfma_f32_16x16x32_bf16 v[64:67], v[28:31], v[112:115], v[64:67]
    ds_read_b128 v[24:27], v7 offset:15360
    v_mfma_f32_16x16x32_bf16 v[68:71], v[28:31], v[116:119], v[68:71]
    v_cvt_pk_bf16_f32 v58, v72, v73
    v_cvt_pk_bf16_f32 v59, v74, v75
    v_mfma_f32_16x16x32_bf16 v[48:51], v[32:35], v[120:123], v[48:51]
    ds_read_b128 v[28:31], v7 offset:16384
    v_mfma_f32_16x16x32_bf16 v[52:55], v[32:35], v[124:127], v[52:55]
    s_mov_b32 exec_hi, 0
    buffer_store_dwordx4 v[56:59], v8, s[4:7], s53 offen offset:0 sc1
    ds_write_b128 v240, v[56:59] offset:4096
    s_mov_b32 exec_hi, -1
    v_mfma_f32_16x16x32_bf16 v[64:67], v[36:39], v[120:123], v[64:67]
    ds_read_b128 v[32:35], v7 offset:17408
    v_mfma_f32_16x16x32_bf16 v[68:71], v[36:39], v[124:127], v[68:71]
    v_pk_mul_f32 v[60:61], v[60:61], v[246:247] op_sel:[0,1] op_sel_hi:[1,1]
    v_pk_mul_f32 v[62:63], v[62:63], v[246:247] op_sel:[0,1] op_sel_hi:[1,1]
    s_waitcnt lgkmcnt(4)
    v_mfma_f32_16x16x32_bf16 v[48:51], v[40:43], v[128:131], v[48:51]
    ds_read_b128 v[36:39], v7 offset:18432
    v_mfma_f32_16x16x32_bf16 v[52:55], v[40:43], v[132:135], v[52:55]
    ds_read_u8 v252, v248 offset:64
    v_pk_mul_f32 v[76:77], v[76:77], v[246:247] op_sel:[0,1] op_sel_hi:[1,1]
    v_pk_mul_f32 v[78:79], v[78:79], v[246:247] op_sel:[0,1] op_sel_hi:[1,1]
    v_mfma_f32_16x16x32_bf16 v[64:67], v[44:47], v[128:131], v[64:67]
    ds_read_b128 v[40:43], v7 offset:19456
    v_mfma_f32_16x16x32_bf16 v[68:71], v[44:47], v[132:135], v[68:71]
    v_cvt_pk_bf16_f32 v60, v60, v61
    v_cvt_pk_bf16_f32 v61, v62, v63
    v_mfma_f32_16x16x32_bf16 v[48:51], v[20:23], v[136:139], v[48:51]
    ds_read_b128 v[44:47], v7 offset:20480
    v_mfma_f32_16x16x32_bf16 v[52:55], v[20:23], v[140:143], v[52:55]
    v_cvt_pk_bf16_f32 v62, v76, v77
    v_cvt_pk_bf16_f32 v63, v78, v79
    s_waitcnt lgkmcnt(4)
    v_mfma_f32_16x16x32_bf16 v[64:67], v[24:27], v[136:139], v[64:67]
    ds_read_b128 v[20:23], v7 offset:21504
    v_mfma_f32_16x16x32_bf16 v[68:71], v[24:27], v[140:143], v[68:71]
    s_mov_b32 exec_hi, 0
    buffer_store_dwordx4 v[60:63], v8, s[4:7], s53 offen offset:256 sc1
    ds_write_b128 v240, v[60:63] offset:4352
    s_mov_b32 exec_hi, -1
    v_mfma_f32_16x16x32_bf16 v[48:51], v[28:31], v[144:147], v[48:51]
    ds_read_b128 v[24:27], v7 offset:22528
    v_mfma_f32_16x16x32_bf16 v[52:55], v[28:31], v[148:151], v[52:55]
    v_mov_b32 v104, s32
    v_mfma_f32_16x16x32_bf16 v[64:67], v[32:35], v[144:147], v[64:67]
    ds_read_b128 v[28:31], v7 offset:23552
    v_mfma_f32_16x16x32_bf16 v[68:71], v[32:35], v[148:151], v[68:71]
    v_mov_b32 v105, s33
    s_waitcnt lgkmcnt(4)
    v_mfma_f32_16x16x32_bf16 v[48:51], v[36:39], v[152:155], v[48:51]
    ds_read_b128 v[32:35], v7 offset:24576
    v_mfma_f32_16x16x32_bf16 v[52:55], v[36:39], v[156:159], v[52:55]
    v_cmp_gt_u32 vcc, 10, v252
    s_cbranch_vccnz L_g_cw_13
L_g_cw_13_b:
    v_mov_b32 v108, 0
    v_mfma_f32_16x16x32_bf16 v[64:67], v[40:43], v[152:155], v[64:67]
    ds_read_b128 v[36:39], v7 offset:25600
    v_mfma_f32_16x16x32_bf16 v[68:71], v[40:43], v[156:159], v[68:71]
    v_mov_b32 v109, 0
    v_mfma_f32_16x16x32_bf16 v[48:51], v[44:47], v[160:163], v[48:51]
    ds_read_b128 v[40:43], v7 offset:26624
    v_mfma_f32_16x16x32_bf16 v[52:55], v[44:47], v[164:167], v[52:55]
    v_mov_b32 v110, 0
    s_waitcnt lgkmcnt(3)
    v_mfma_f32_16x16x32_bf16 v[64:67], v[20:23], v[160:163], v[64:67]
    ds_read_b128 v[44:47], v7 offset:27648
    v_mfma_f32_16x16x32_bf16 v[68:71], v[20:23], v[164:167], v[68:71]
    v_mov_b32 v111, 0
    v_mfma_f32_16x16x32_bf16 v[48:51], v[24:27], v[168:171], v[48:51]
    ds_read_b128 v[20:23], v7 offset:28672
    v_mfma_f32_16x16x32_bf16 v[52:55], v[24:27], v[172:175], v[52:55]
    v_mov_b32 v106, 0x3f803f80
    v_mfma_f32_16x16x32_bf16 v[64:67], v[28:31], v[168:171], v[64:67]
    ds_read_b128 v[24:27], v7 offset:29696
    v_mfma_f32_16x16x32_bf16 v[68:71], v[28:31], v[172:175], v[68:71]
    v_mov_b32 v107, 0x3f803f80
    s_waitcnt lgkmcnt(3)
    v_mfma_f32_16x16x32_bf16 v[48:51], v[32:35], v[176:179], v[48:51]
    ds_read_b128 v[28:31], v7 offset:30720
    v_mfma_f32_16x16x32_bf16 v[52:55], v[32:35], v[180:183], v[52:55]
    s_mov_b64 exec, 1
    ds_write_b128 v104, v[108:111] offset:2560
    ds_write_b64 v105, v[106:107] offset:2560
    ds_write_b64 v105, v[106:107] offset:2816
    s_mov_b64 exec, -1
    v_mfma_f32_16x16x32_bf16 v[64:67], v[36:39], v[176:179], v[64:67]
    ds_read_b128 v[32:35], v7 offset:31744
    v_mfma_f32_16x16x32_bf16 v[68:71], v[36:39], v[180:183], v[68:71]
    v_mov_b32 v104, 1
    v_mfma_f32_16x16x32_bf16 v[48:51], v[40:43], v[184:187], v[48:51]
    ds_read_b128 v[36:39], v7 offset:32768
    v_mfma_f32_16x16x32_bf16 v[52:55], v[40:43], v[188:191], v[52:55]
    ds_write_b8 v249, v104 offset:84
    s_waitcnt lgkmcnt(7)
    v_mfma_f32_16x16x32_bf16 v[64:67], v[44:47], v[184:187], v[64:67]
    ds_read_b128 v[40:43], v7 offset:33792
    v_mfma_f32_16x16x32_bf16 v[68:71], v[44:47], v[188:191], v[68:71]
    s_mov_b32 s26, s25
    v_mfma_f32_16x16x32_bf16 v[48:51], v[20:23], v[192:195], v[48:51]
    ds_read_b128 v[44:47], v7 offset:34816
    v_mfma_f32_16x16x32_bf16 v[52:55], v[20:23], v[196:199], v[52:55]
    s_mov_b32 s34, 0x07060302
    v_mfma_f32_16x16x32_bf16 v[64:67], v[24:27], v[192:195], v[64:67]
    ds_read_b128 v[20:23], v7 offset:35840
    v_mfma_f32_16x16x32_bf16 v[68:71], v[24:27], v[196:199], v[68:71]
    s_mov_b32 s35, s61
    s_waitcnt lgkmcnt(4)
    v_mfma_f32_16x16x32_bf16 v[48:51], v[28:31], v[200:203], v[48:51]
    ds_read_b128 v[24:27], v7 offset:36864
    v_mfma_f32_16x16x32_bf16 v[52:55], v[28:31], v[204:207], v[52:55]
    s_mov_b32 s36, s62
    v_mfma_f32_16x16x32_bf16 v[64:67], v[32:35], v[200:203], v[64:67]
    ds_read_b128 v[28:31], v7 offset:37888
    v_mfma_f32_16x16x32_bf16 v[68:71], v[32:35], v[204:207], v[68:71]
    s_add_u32 s28, s56, 5120
    s_addc_u32 s29, s57, 0
    v_mfma_f32_16x16x32_bf16 v[48:51], v[36:39], v[208:211], v[48:51]
    ds_read_b128 v[32:35], v7 offset:38912
    v_mfma_f32_16x16x32_bf16 v[52:55], v[36:39], v[212:215], v[52:55]
    s_load_dwordx16 s[40:55], s[28:29], 0
    s_waitcnt lgkmcnt(3)
    v_mfma_f32_16x16x32_bf16 v[64:67], v[40:43], v[208:211], v[64:67]
    ds_read_b128 v[36:39], v7 offset:39936
    v_mfma_f32_16x16x32_bf16 v[68:71], v[40:43], v[212:215], v[68:71]
    s_load_dwordx16 s[56:71], s[28:29], 64
    v_mfma_f32_16x16x32_bf16 v[48:51], v[44:47], v[216:219], v[48:51]
    ds_read_b128 v[40:43], v6 offset:1536
    v_mfma_f32_16x16x32_bf16 v[52:55], v[44:47], v[220:223], v[52:55]
    v_mfma_f32_16x16x32_bf16 v[64:67], v[20:23], v[216:219], v[64:67]
    ds_read_b128 v[44:47], v6 offset:1792
    v_mfma_f32_16x16x32_bf16 v[68:71], v[20:23], v[220:223], v[68:71]
    v_mov_b32 v251, 11
    s_waitcnt lgkmcnt(3)
    v_mfma_f32_16x16x32_bf16 v[48:51], v[24:27], v[224:227], v[48:51]
    v_mfma_f32_16x16x32_bf16 v[52:55], v[24:27], v[228:231], v[52:55]
    ds_write_b8 v249, v251 offset:68
    v_mfma_f32_16x16x32_bf16 v[64:67], v[28:31], v[224:227], v[64:67]
    v_mfma_f32_16x16x32_bf16 v[68:71], v[28:31], v[228:231], v[68:71]
    v_mfma_f32_16x16x32_bf16 v[48:51], v[32:35], v[232:235], v[48:51]
    v_mfma_f32_16x16x32_bf16 v[52:55], v[32:35], v[236:239], v[52:55]
    s_waitcnt lgkmcnt(1)
    v_mfma_f32_16x16x32_bf16 v[64:67], v[36:39], v[232:235], v[64:67]
    v_mfma_f32_16x16x32_bf16 v[68:71], v[36:39], v[236:239], v[68:71]
    v_mfma_f32_16x16x32_bf16 v[48:51], v[40:43], v[12:15], v[48:51]
    v_mfma_f32_16x16x32_bf16 v[52:55], v[40:43], v[16:19], v[52:55]
    v_mfma_f32_16x16x32_bf16 v[64:67], v[44:47], v[12:15], v[64:67]
    v_mfma_f32_16x16x32_bf16 v[68:71], v[44:47], v[16:19], v[68:71]
    ds_read_u8 v252, v248 offset:84
    ds_read_u8 v253, v248 offset:88
    v_permlane16_swap_b32 v56, v60
    v_permlane16_swap_b32 v57, v61
    v_permlane16_swap_b32 v58, v62
    v_permlane16_swap_b32 v59, v63
    s_nop 1
    v_pk_mul_f32 v[48:49], v[48:49], v[244:245] op_sel_hi:[1,0]
    v_pk_mul_f32 v[50:51], v[50:51], v[244:245] op_sel_hi:[1,0]
    v_pk_mul_f32 v[64:65], v[64:65], v[244:245] op_sel_hi:[1,0]
    v_pk_mul_f32 v[66:67], v[66:67], v[244:245] op_sel_hi:[1,0]
    v_cvt_pk_bf16_f32 v8, v48, v49
    v_cvt_pk_bf16_f32 v9, v50, v51
    v_cvt_pk_bf16_f32 v10, v64, v65
    v_cvt_pk_bf16_f32 v11, v66, v67
    v_pk_mul_f32 v[52:53], v[52:53], v[244:245] op_sel:[0,1] op_sel_hi:[1,1]
    v_pk_mul_f32 v[54:55], v[54:55], v[244:245] op_sel:[0,1] op_sel_hi:[1,1]
    v_pk_mul_f32 v[68:69], v[68:69], v[244:245] op_sel:[0,1] op_sel_hi:[1,1]
    v_pk_mul_f32 v[70:71], v[70:71], v[244:245] op_sel:[0,1] op_sel_hi:[1,1]
    v_cvt_pk_bf16_f32 v12, v52, v53
    v_cvt_pk_bf16_f32 v13, v54, v55
    v_cvt_pk_bf16_f32 v14, v68, v69
    v_cvt_pk_bf16_f32 v15, v70, v71
    v_mov_b32 v18, s87
    v_mov_b32 v19, s72
    s_waitcnt vmcnt(0)
    s_mov_b64 exec, 1
    buffer_store_dwordx2 v[18:19], off, s[4:7], s30 sc1
    s_mov_b64 exec, -1
    v_add_u32 v80, s35, v80
    v_add_u32 v81, s35, v81
    v_add_u32 v82, s35, v82
    v_add_u32 v86, s36, v86
    v_add_u32 v87, s36, v87
    v_add_u32 v88, s36, v88
    v_add_u32 v89, s36, v89
    v_permlane16_swap_b32 v8, v12
    v_permlane16_swap_b32 v9, v13
    v_permlane16_swap_b32 v10, v14
    v_permlane16_swap_b32 v11, v15
    v_mov_b32 v254, 0x3f80
    v_cndmask_b32 v4, v56, v254, s[38:39]
    v_cndmask_b32 v5, v57, 0, s[38:39]
    v_mov_b32 v6, 0
    v_mov_b32 v7, 0
    v_mov_b32 v244, 0
    v_mov_b32 v245, 0
    v_cndmask_b32 v246, v58, v254, s[38:39]
    v_cndmask_b32 v247, v59, 0, s[38:39]
    s_waitcnt lgkmcnt(0)
    v_cmp_gt_u32 vcc, 1, v252
    s_cbranch_vccnz L_ag_cw_14
L_ag_cw_14_b:
    v_cmp_gt_u32 vcc, 1, v253
    s_cbranch_vccnz L_ag_cw_15
L_ag_cw_15_b:
    ds_read_b128 v[16:19], v80 offset:18032
    ds_read_b128 v[20:23], v82 offset:18032
    ds_read_b128 v[24:27], v80 offset:20608
    ds_read_b128 v[28:31], v82 offset:20608
    ds_read_b128 v[32:35], v80 offset:0
    ds_read_b128 v[36:39], v82 offset:0
    s_waitcnt lgkmcnt(4)
    v_mfma_f32_32x32x16_bf16 v[212:227], v[16:19], v[8:11], 0
    ds_read_b128 v[40:43], v80 offset:15456
    ds_read_b128 v[44:47], v82 offset:15456
    v_mfma_f32_32x32x16_bf16 v[212:227], v[20:23], v[4:7], v[212:227]
    ds_read_b128 v[16:19], v80 offset:12880
    ds_read_b128 v[20:23], v82 offset:12880
    s_waitcnt lgkmcnt(6)
    v_mfma_f32_32x32x16_bf16 v[228:243], v[24:27], v[8:11], 0
    v_mfma_f32_32x32x16_bf16 v[228:243], v[28:31], v[4:7], v[228:243]
    ds_read_b128 v[24:27], v80 offset:10304
    ds_read_b128 v[28:31], v82 offset:10304
    s_waitcnt lgkmcnt(6)
    v_mfma_f32_32x32x16_bf16 v[100:115], v[32:35], v[8:11], 0
    v_mfma_f32_32x32x16_bf16 v[100:115], v[36:39], v[4:7], v[100:115]
    ds_read_b128 v[32:35], v80 offset:7728
    ds_read_b128 v[36:39], v82 offset:7728
    v_max_f32_e64 v83, v212, v213
    v_max_f32_e64 v90, v214, v215
    v_max_f32_e64 v91, v216, v217
    v_max3_f32 v83, v83, v218, v219
    v_max3_f32 v90, v90, v220, v221
    s_waitcnt lgkmcnt(6)
    v_mfma_f32_32x32x16_bf16 v[196:211], v[40:43], v[8:11], 0
    v_max3_f32 v91, v91, v222, v223
    v_max3_f32 v83, v83, v224, v225
    v_max3_f32 v90, v90, v226, v227
    v_cndmask_b32 v228, v100, v228, s[40:41]
    v_cndmask_b32 v229, v101, v229, s[42:43]
    v_mfma_f32_32x32x16_bf16 v[196:211], v[44:47], v[4:7], v[196:211]
    ds_read_b128 v[40:43], v80 offset:5152
    ds_read_b128 v[44:47], v82 offset:5152
    v_cndmask_b32 v230, v102, v230, s[44:45]
    v_cndmask_b32 v231, v103, v231, s[46:47]
    v_cndmask_b32 v232, v104, v232, s[48:49]
    v_cndmask_b32 v233, v105, v233, s[50:51]
    v_cndmask_b32 v234, v106, v234, s[52:53]
    s_waitcnt lgkmcnt(6)
    v_mfma_f32_32x32x16_bf16 v[180:195], v[16:19], v[8:11], 0
    v_cndmask_b32 v235, v107, v235, s[54:55]
    v_cndmask_b32 v236, v108, v236, s[56:57]
    v_cndmask_b32 v237, v109, v237, s[58:59]
    v_cndmask_b32 v238, v110, v238, s[60:61]
    v_cndmask_b32 v239, v111, v239, s[62:63]
    v_mfma_f32_32x32x16_bf16 v[180:195], v[20:23], v[4:7], v[180:195]
    ds_read_b128 v[16:19], v80 offset:2576
    ds_read_b128 v[20:23], v82 offset:2576
    v_cndmask_b32 v240, v112, v240, s[64:65]
    v_cndmask_b32 v241, v113, v241, s[66:67]
    v_cndmask_b32 v242, v114, v242, s[68:69]
    v_cndmask_b32 v243, v115, v243, s[70:71]
    v_max3_f32 v83, v83, v228, v229
    s_waitcnt lgkmcnt(6)
    v_mfma_f32_32x32x16_bf16 v[164:179], v[24:27], v[8:11], 0
    v_max3_f32 v90, v90, v230, v231
    v_max3_f32 v91, v91, v232, v233
    v_max3_f32 v83, v83, v234, v235
    v_max3_f32 v90, v90, v236, v237
    v_max3_f32 v91, v91, v238, v239
    v_mfma_f32_32x32x16_bf16 v[164:179], v[28:31], v[4:7], v[164:179]
    ds_read_b128 v[24:27], v81 offset:0
    ds_read_b128 v[28:31], v82 offset:0
    v_max3_f32 v83, v83, v240, v241
    v_max3_f32 v90, v90, v242, v243
    v_max3_f32 v83, v83, v196, v197
    v_max3_f32 v90, v90, v198, v199
    v_max3_f32 v91, v91, v200, v201
    s_waitcnt lgkmcnt(6)
    v_mfma_f32_32x32x16_bf16 v[148:163], v[32:35], v[8:11], 0
    v_max3_f32 v83, v83, v202, v203
    v_max3_f32 v90, v90, v204, v205
    v_max3_f32 v91, v91, v206, v207
    v_max3_f32 v83, v83, v208, v209
    v_max3_f32 v90, v90, v210, v211
    v_mfma_f32_32x32x16_bf16 v[148:163], v[36:39], v[4:7], v[148:163]
    ds_read_u8 v253, v248 offset:92
    ds_read_u8 v252, v248 offset:112
    v_max3_f32 v83, v83, v180, v181
    v_max3_f32 v90, v90, v182, v183
    v_max3_f32 v91, v91, v184, v185
    v_max3_f32 v83, v83, v186, v187
    v_max3_f32 v90, v90, v188, v189
    s_waitcnt lgkmcnt(6)
    v_mfma_f32_32x32x16_bf16 v[132:147], v[40:43], v[8:11], 0
    v_max3_f32 v91, v91, v190, v191
    v_max3_f32 v83, v83, v192, v193
    v_max3_f32 v90, v90, v194, v195
    v_max3_f32 v83, v83, v164, v165
    v_max3_f32 v90, v90, v166, v167
    v_mfma_f32_32x32x16_bf16 v[132:147], v[44:47], v[4:7], v[132:147]
    v_max3_f32 v91, v91, v168, v169
    v_max3_f32 v83, v83, v170, v171
    v_max3_f32 v90, v90, v172, v173
    v_max3_f32 v91, v91, v174, v175
    v_max3_f32 v83, v83, v176, v177
    s_waitcnt lgkmcnt(4)
    v_mfma_f32_32x32x16_bf16 v[116:131], v[16:19], v[8:11], 0
    v_max3_f32 v90, v90, v178, v179
    v_max3_f32 v83, v83, v148, v149
    v_max3_f32 v90, v90, v150, v151
    v_max3_f32 v91, v91, v152, v153
    v_max3_f32 v83, v83, v154, v155
    v_mfma_f32_32x32x16_bf16 v[116:131], v[20:23], v[4:7], v[116:131]
    ds_read_b128 v[16:19], v81 offset:20608
    ds_read_b128 v[20:23], v82 offset:20608
    v_max3_f32 v90, v90, v156, v157
    v_max3_f32 v91, v91, v158, v159
    v_max3_f32 v83, v83, v160, v161
    v_max3_f32 v90, v90, v162, v163
    v_max3_f32 v83, v83, v132, v133
    s_waitcnt lgkmcnt(2)
    v_readfirstlane_b32 s22, v252
    v_max3_f32 v90, v90, v134, v135
    v_max3_f32 v91, v91, v136, v137
    v_max3_f32 v83, v83, v138, v139
    v_max3_f32 v90, v90, v140, v141
    v_max3_f32 v91, v91, v142, v143
    v_max3_f32 v83, v83, v144, v145
    v_max3_f32 v90, v90, v146, v147
    v_max3_f32 v83, v83, v116, v117
    v_max3_f32 v90, v90, v118, v119
    v_max3_f32 v91, v91, v120, v121
    v_max3_f32 v83, v83, v122, v123
    v_max3_f32 v90, v90, v124, v125
    v_max3_f32 v91, v91, v126, v127
    v_max3_f32 v83, v83, v128, v129
    v_max3_f32 v90, v90, v130, v131
    v_max3_f32 v83, v83, v90, v91
    v_mov_b32 v90, v83
    s_nop 1
    v_permlane32_swap_b32 v83, v90
    s_nop 0
    v_max_f32 v83, v83, v90
    v_cndmask_b32 v254, 0, -v83, s[38:39]
    v_and_b32 v255, 0xffff0000, v254
    v_sub_f32 v254, v254, v255
    v_and_b32 v83, 0xffff0000, v254
    v_sub_f32 v254, v254, v83
    v_perm_b32 v4, v83, v255, s34
    v_lshrrev_b32 v5, 16, v254
    v_cmp_gt_u32 vcc, 1, v253
    s_cbranch_vccnz L_hv_cw_16
L_hv_cw_16_b:
    v_mfma_f32_32x32x16_bf16 v[116:131], v[84:87], v[4:7], v[116:131]
    ds_read_b64_tr_b16 v[40:41], v86 offset:2848
    ds_read_b64_tr_b16 v[42:43], v87 offset:2848
    v_mfma_f32_32x32x16_bf16 v[132:147], v[84:87], v[4:7], v[132:147]
    ds_read_b64_tr_b16 v[44:45], v86 offset:3104
    ds_read_b64_tr_b16 v[46:47], v87 offset:3104
    s_nop 6
    v_exp_f32 v116, v116
    v_exp_f32 v117, v117
    v_exp_f32 v118, v118
    v_exp_f32 v119, v119
    s_waitcnt lgkmcnt(4)
    v_mfma_f32_32x32x16_bf16 v[48:63], v[16:19], v[12:15], 0
    v_cvt_pk_bf16_f32 v116, v116, v117
    v_exp_f32 v120, v120
    v_exp_f32 v121, v121
    v_mfma_f32_32x32x16_bf16 v[48:63], v[20:23], v[244:247], v[48:63]
    ds_read_b128 v[16:19], v81 offset:2576
    ds_read_b128 v[20:23], v82 offset:2576
    v_cvt_pk_bf16_f32 v117, v118, v119
    v_exp_f32 v122, v122
    v_exp_f32 v123, v123
    v_mfma_f32_32x32x16_bf16 v[64:79], v[24:27], v[12:15], 0
    v_cvt_pk_bf16_f32 v118, v120, v121
    v_exp_f32 v124, v124
    v_exp_f32 v125, v125
    v_mfma_f32_32x32x16_bf16 v[64:79], v[28:31], v[244:247], v[64:79]
    ds_read_b128 v[24:27], v81 offset:5152
    ds_read_b128 v[28:31], v82 offset:5152
    v_cvt_pk_bf16_f32 v119, v122, v123
    v_exp_f32 v126, v126
    v_exp_f32 v127, v127
    v_cvt_pk_bf16_f32 v120, v124, v125
    v_exp_f32 v128, v128
    v_exp_f32 v129, v129
    v_mfma_f32_32x32x16_bf16 v[148:163], v[84:87], v[4:7], v[148:163]
    v_cvt_pk_bf16_f32 v121, v126, v127
    v_exp_f32 v130, v130
    v_exp_f32 v131, v131
    v_cndmask_b32 v48, v64, v48, s[40:41]
    v_cndmask_b32 v49, v65, v49, s[42:43]
    v_cvt_pk_bf16_f32 v122, v128, v129
    v_cndmask_b32 v50, v66, v50, s[44:45]
    v_cndmask_b32 v51, v67, v51, s[46:47]
    v_exp_f32 v132, v132
    v_exp_f32 v133, v133
    v_cvt_pk_bf16_f32 v123, v130, v131
    v_cndmask_b32 v52, v68, v52, s[48:49]
    v_cndmask_b32 v53, v69, v53, s[50:51]
    v_exp_f32 v134, v134
    v_exp_f32 v135, v135
    v_cndmask_b32 v54, v70, v54, s[52:53]
    v_cndmask_b32 v55, v71, v55, s[54:55]
    v_cvt_pk_bf16_f32 v132, v132, v133
    s_waitcnt lgkmcnt(4)
    v_mfma_f32_32x32x16_bf16 v[100:115], v[40:43], v[116:119], 0
    ds_read_b64_tr_b16 v[32:33], v86 offset:5696
    ds_read_b64_tr_b16 v[34:35], v87 offset:5696
    v_cndmask_b32 v56, v72, v56, s[56:57]
    v_cndmask_b32 v57, v73, v57, s[58:59]
    v_exp_f32 v136, v136
    v_exp_f32 v137, v137
    v_cndmask_b32 v58, v74, v58, s[60:61]
    v_cndmask_b32 v59, v75, v59, s[62:63]
    v_cvt_pk_bf16_f32 v133, v134, v135
    v_cndmask_b32 v60, v76, v60, s[64:65]
    v_cndmask_b32 v61, v77, v61, s[66:67]
    v_exp_f32 v138, v138
    v_exp_f32 v139, v139
    v_cndmask_b32 v62, v78, v62, s[68:69]
    v_cndmask_b32 v63, v79, v63, s[70:71]
    v_cvt_pk_bf16_f32 v134, v136, v137
    v_max_f32_e64 v83, v48, v49
    v_max_f32_e64 v90, v50, v51
    v_exp_f32 v140, v140
    v_exp_f32 v141, v141
    v_mfma_f32_32x32x16_bf16 v[100:115], v[44:47], v[120:123], v[100:115]
    ds_read_b64_tr_b16 v[36:37], v86 offset:5952
    ds_read_b64_tr_b16 v[38:39], v87 offset:5952
    v_max_f32_e64 v91, v52, v53
    v_max3_f32 v83, v83, v54, v55
    v_cvt_pk_bf16_f32 v135, v138, v139
    v_max3_f32 v90, v90, v56, v57
    v_max3_f32 v91, v91, v58, v59
    v_exp_f32 v142, v142
    v_exp_f32 v143, v143
    v_max3_f32 v83, v83, v60, v61
    v_max3_f32 v90, v90, v62, v63
    v_cvt_pk_bf16_f32 v136, v140, v141
    s_waitcnt lgkmcnt(6)
    v_mfma_f32_32x32x16_bf16 v[64:79], v[16:19], v[12:15], 0
    v_exp_f32 v144, v144
    v_exp_f32 v145, v145
    v_mfma_f32_32x32x16_bf16 v[164:179], v[84:87], v[4:7], v[164:179]
    v_cvt_pk_bf16_f32 v137, v142, v143
    v_exp_f32 v146, v146
    v_exp_f32 v147, v147
    v_mfma_f32_32x32x16_bf16 v[64:79], v[20:23], v[244:247], v[64:79]
    ds_read_b128 v[16:19], v81 offset:7728
    ds_read_b128 v[20:23], v82 offset:7728
    v_cvt_pk_bf16_f32 v138, v144, v145
    v_exp_f32 v148, v148
    v_exp_f32 v149, v149
    v_cvt_pk_bf16_f32 v139, v146, v147
    v_exp_f32 v150, v150
    v_exp_f32 v151, v151
    v_cvt_pk_bf16_f32 v148, v148, v149
    s_waitcnt lgkmcnt(2)
    v_mfma_f32_32x32x16_bf16 v[100:115], v[32:35], v[132:135], v[100:115]
    ds_read_b64_tr_b16 v[40:41], v86 offset:8544
    ds_read_b64_tr_b16 v[42:43], v87 offset:8544
    v_max3_f32 v83, v83, v64, v65
    v_max3_f32 v90, v90, v66, v67
    v_exp_f32 v152, v152
    v_exp_f32 v153, v153
    v_max3_f32 v91, v91, v68, v69
    v_max3_f32 v83, v83, v70, v71
    v_cvt_pk_bf16_f32 v149, v150, v151
    v_mfma_f32_32x32x16_bf16 v[116:131], v[24:27], v[12:15], 0
    ds_read_b64_tr_b16 v[44:45], v86 offset:8800
    ds_read_b64_tr_b16 v[46:47], v87 offset:8800
    v_max3_f32 v90, v90, v72, v73
    v_max3_f32 v91, v91, v74, v75
    v_exp_f32 v154, v154
    v_exp_f32 v155, v155
    v_max3_f32 v83, v83, v76, v77
    v_max3_f32 v90, v90, v78, v79
    v_cvt_pk_bf16_f32 v150, v152, v153
    v_exp_f32 v156, v156
    v_exp_f32 v157, v157
    v_mfma_f32_32x32x16_bf16 v[100:115], v[36:39], v[136:139], v[100:115]
    v_cvt_pk_bf16_f32 v151, v154, v155
    v_exp_f32 v158, v158
    v_exp_f32 v159, v159
    v_mfma_f32_32x32x16_bf16 v[116:131], v[28:31], v[244:247], v[116:131]
    ds_read_b128 v[24:27], v81 offset:10304
    ds_read_b128 v[28:31], v82 offset:10304
    v_cvt_pk_bf16_f32 v152, v156, v157
    v_exp_f32 v160, v160
    v_exp_f32 v161, v161
    v_mfma_f32_32x32x16_bf16 v[180:195], v[84:87], v[4:7], v[180:195]
    v_cvt_pk_bf16_f32 v153, v158, v159
    v_exp_f32 v162, v162
    v_exp_f32 v163, v163
    v_cvt_pk_bf16_f32 v154, v160, v161
    v_exp_f32 v164, v164
    v_exp_f32 v165, v165
    v_cvt_pk_bf16_f32 v155, v162, v163
    v_max3_f32 v83, v83, v116, v117
    v_max3_f32 v90, v90, v118, v119
    v_exp_f32 v166, v166
    v_exp_f32 v167, v167
    v_max3_f32 v91, v91, v120, v121
    v_max3_f32 v83, v83, v122, v123
    v_cvt_pk_bf16_f32 v164, v164, v165
    s_waitcnt lgkmcnt(2)
    v_mfma_f32_32x32x16_bf16 v[100:115], v[40:43], v[148:151], v[100:115]
    ds_read_b64_tr_b16 v[32:33], v86 offset:11392
    ds_read_b64_tr_b16 v[34:35], v87 offset:11392
    v_max3_f32 v90, v90, v124, v125
    v_max3_f32 v91, v91, v126, v127
    v_exp_f32 v168, v168
    v_exp_f32 v169, v169
    v_max3_f32 v83, v83, v128, v129
    v_max3_f32 v90, v90, v130, v131
    v_cvt_pk_bf16_f32 v165, v166, v167
    v_mfma_f32_32x32x16_bf16 v[132:147], v[16:19], v[12:15], 0
    ds_read_b64_tr_b16 v[36:37], v86 offset:11648
    ds_read_b64_tr_b16 v[38:39], v87 offset:11648
    v_exp_f32 v170, v170
    v_exp_f32 v171, v171
    v_cvt_pk_bf16_f32 v166, v168, v169
    v_exp_f32 v172, v172
    v_exp_f32 v173, v173
    v_mfma_f32_32x32x16_bf16 v[100:115], v[44:47], v[152:155], v[100:115]
    v_cvt_pk_bf16_f32 v167, v170, v171
    v_exp_f32 v174, v174
    v_exp_f32 v175, v175
    v_mfma_f32_32x32x16_bf16 v[132:147], v[20:23], v[244:247], v[132:147]
    ds_read_b128 v[16:19], v81 offset:12880
    ds_read_b128 v[20:23], v82 offset:12880
    v_cvt_pk_bf16_f32 v168, v172, v173
    v_exp_f32 v176, v176
    v_exp_f32 v177, v177
    v_mfma_f32_32x32x16_bf16 v[196:211], v[84:87], v[4:7], v[196:211]
    v_cvt_pk_bf16_f32 v169, v174, v175
    v_exp_f32 v178, v178
    v_exp_f32 v179, v179
    v_cvt_pk_bf16_f32 v170, v176, v177
    v_exp_f32 v180, v180
    v_exp_f32 v181, v181
    v_cvt_pk_bf16_f32 v171, v178, v179
    v_max3_f32 v83, v83, v132, v133
    v_max3_f32 v90, v90, v134, v135
    v_exp_f32 v182, v182
    v_exp_f32 v183, v183
    v_max3_f32 v91, v91, v136, v137
    v_max3_f32 v83, v83, v138, v139
    v_cvt_pk_bf16_f32 v180, v180, v181
    s_waitcnt lgkmcnt(2)
    v_mfma_f32_32x32x16_bf16 v[100:115], v[32:35], v[164:167], v[100:115]
    ds_read_b64_tr_b16 v[40:41], v86 offset:14240
    ds_read_b64_tr_b16 v[42:43], v87 offset:14240
    v_max3_f32 v90, v90, v140, v141
    v_max3_f32 v91, v91, v142, v143
    v_exp_f32 v184, v184
    v_exp_f32 v185, v185
    v_max3_f32 v83, v83, v144, v145
    v_max3_f32 v90, v90, v146, v147
    v_cvt_pk_bf16_f32 v181, v182, v183
    v_mfma_f32_32x32x16_bf16 v[148:163], v[24:27], v[12:15], 0
    ds_read_b64_tr_b16 v[44:45], v86 offset:14496
    ds_read_b64_tr_b16 v[46:47], v87 offset:14496
    v_exp_f32 v186, v186
    v_exp_f32 v187, v187
    v_cvt_pk_bf16_f32 v182, v184, v185
    v_exp_f32 v188, v188
    v_exp_f32 v189, v189
    v_mfma_f32_32x32x16_bf16 v[100:115], v[36:39], v[168:171], v[100:115]
    v_cvt_pk_bf16_f32 v183, v186, v187
    v_exp_f32 v190, v190
    v_exp_f32 v191, v191
    v_mfma_f32_32x32x16_bf16 v[148:163], v[28:31], v[244:247], v[148:163]
    ds_read_b128 v[24:27], v81 offset:15456
    ds_read_b128 v[28:31], v82 offset:15456
    v_cvt_pk_bf16_f32 v184, v188, v189
    v_exp_f32 v192, v192
    v_exp_f32 v193, v193
    v_mfma_f32_32x32x16_bf16 v[212:227], v[84:87], v[4:7], v[212:227]
    v_cvt_pk_bf16_f32 v185, v190, v191
    v_exp_f32 v194, v194
    v_exp_f32 v195, v195
    v_cvt_pk_bf16_f32 v186, v192, v193
    v_exp_f32 v196, v196
    v_exp_f32 v197, v197
    v_cvt_pk_bf16_f32 v187, v194, v195
    v_max3_f32 v83, v83, v148, v149
    v_max3_f32 v90, v90, v150, v151
    v_exp_f32 v198, v198
    v_exp_f32 v199, v199
    v_max3_f32 v91, v91, v152, v153
    v_max3_f32 v83, v83, v154, v155
    v_cvt_pk_bf16_f32 v196, v196, v197
    s_waitcnt lgkmcnt(2)
    v_mfma_f32_32x32x16_bf16 v[100:115], v[40:43], v[180:183], v[100:115]
    ds_read_b64_tr_b16 v[32:33], v86 offset:17088
    ds_read_b64_tr_b16 v[34:35], v87 offset:17088
    v_max3_f32 v90, v90, v156, v157
    v_max3_f32 v91, v91, v158, v159
    v_exp_f32 v200, v200
    v_exp_f32 v201, v201
    v_max3_f32 v83, v83, v160, v161
    v_max3_f32 v90, v90, v162, v163
    v_cvt_pk_bf16_f32 v197, v198, v199
    v_mfma_f32_32x32x16_bf16 v[164:179], v[16:19], v[12:15], 0
    ds_read_b64_tr_b16 v[36:37], v86 offset:17344
    ds_read_b64_tr_b16 v[38:39], v87 offset:17344
    v_exp_f32 v202, v202
    v_exp_f32 v203, v203
    v_cvt_pk_bf16_f32 v198, v200, v201
    v_exp_f32 v204, v204
    v_exp_f32 v205, v205
    v_mfma_f32_32x32x16_bf16 v[100:115], v[44:47], v[184:187], v[100:115]
    v_cvt_pk_bf16_f32 v199, v202, v203
    v_exp_f32 v206, v206
    v_exp_f32 v207, v207
    v_mfma_f32_32x32x16_bf16 v[164:179], v[20:23], v[244:247], v[164:179]
    ds_read_b128 v[16:19], v81 offset:18032
    ds_read_b128 v[20:23], v82 offset:18032
    v_mov_b32 v251, 1
    ds_write_b8 v249, v251 offset:96
    v_cvt_pk_bf16_f32 v200, v204, v205
    v_exp_f32 v208, v208
    v_exp_f32 v209, v209
    v_mfma_f32_32x32x16_bf16 v[228:243], v[84:87], v[4:7], v[228:243]
    v_cvt_pk_bf16_f32 v201, v206, v207
    v_exp_f32 v210, v210
    v_exp_f32 v211, v211
    v_cvt_pk_bf16_f32 v202, v208, v209
    v_max3_f32 v83, v83, v164, v165
    v_max3_f32 v90, v90, v166, v167
    v_exp_f32 v212, v212
    v_exp_f32 v213, v213
    v_cvt_pk_bf16_f32 v203, v210, v211
    v_max3_f32 v91, v91, v168, v169
    v_max3_f32 v83, v83, v170, v171
    v_exp_f32 v214, v214
    v_exp_f32 v215, v215
    v_max3_f32 v90, v90, v172, v173
    v_max3_f32 v91, v91, v174, v175
    v_cvt_pk_bf16_f32 v212, v212, v213
    s_waitcnt lgkmcnt(3)
    v_mfma_f32_32x32x16_bf16 v[100:115], v[32:35], v[196:199], v[100:115]
    ds_read_b64_tr_b16 v[40:41], v86 offset:19936
    ds_read_b64_tr_b16 v[42:43], v87 offset:19936
    v_max3_f32 v83, v83, v176, v177
    v_max3_f32 v90, v90, v178, v179
    v_exp_f32 v216, v216
    v_exp_f32 v217, v217
    v_cvt_pk_bf16_f32 v213, v214, v215
    v_mfma_f32_32x32x16_bf16 v[180:195], v[24:27], v[12:15], 0
    ds_read_b64_tr_b16 v[44:45], v86 offset:20192
    ds_read_b64_tr_b16 v[46:47], v87 offset:20192
    v_exp_f32 v218, v218
    v_exp_f32 v219, v219
    v_cvt_pk_bf16_f32 v214, v216, v217
    v_exp_f32 v220, v220
    v_exp_f32 v221, v221
    v_mfma_f32_32x32x16_bf16 v[100:115], v[36:39], v[200:203], v[100:115]
    v_cvt_pk_bf16_f32 v215, v218, v219
    v_exp_f32 v222, v222
    v_exp_f32 v223, v223
    v_mfma_f32_32x32x16_bf16 v[180:195], v[28:31], v[244:247], v[180:195]
    v_cvt_pk_bf16_f32 v216, v220, v221
    v_exp_f32 v224, v224
    v_exp_f32 v225, v225
    s_waitcnt lgkmcnt(5)
    v_mfma_f32_32x32x16_bf16 v[196:211], v[16:19], v[12:15], 0
    v_cvt_pk_bf16_f32 v217, v222, v223
    v_exp_f32 v226, v226
    v_exp_f32 v227, v227
    v_mfma_f32_32x32x16_bf16 v[196:211], v[20:23], v[244:247], v[196:211]
    v_cvt_pk_bf16_f32 v218, v224, v225
    v_exp_f32 v228, v228
    v_exp_f32 v229, v229
    v_cvt_pk_bf16_f32 v219, v226, v227
    v_max3_f32 v83, v83, v180, v181
    v_max3_f32 v90, v90, v182, v183
    v_exp_f32 v230, v230
    v_exp_f32 v231, v231
    v_max3_f32 v91, v91, v184, v185
    v_max3_f32 v83, v83, v186, v187
    v_cvt_pk_bf16_f32 v228, v228, v229
    s_waitcnt lgkmcnt(0)
    v_mfma_f32_32x32x16_bf16 v[100:115], v[40:43], v[212:215], v[100:115]
    ds_read_b64_tr_b16 v[32:33], v86 offset:22784
    ds_read_b64_tr_b16 v[34:35], v87 offset:22784
    v_max3_f32 v90, v90, v188, v189
    v_max3_f32 v91, v91, v190, v191
    v_exp_f32 v232, v232
    v_exp_f32 v233, v233
    ds_read_u8 v253, v248 offset:92
    v_max3_f32 v83, v83, v192, v193
    v_max3_f32 v90, v90, v194, v195
    v_cvt_pk_bf16_f32 v229, v230, v231
    v_max3_f32 v83, v83, v196, v197
    v_max3_f32 v90, v90, v198, v199
    v_exp_f32 v234, v234
    v_exp_f32 v235, v235
    v_max3_f32 v91, v91, v200, v201
    v_max3_f32 v83, v83, v202, v203
    v_cvt_pk_bf16_f32 v230, v232, v233
    v_max3_f32 v90, v90, v204, v205
    v_max3_f32 v91, v91, v206, v207
    v_exp_f32 v236, v236
    v_exp_f32 v237, v237
    v_mfma_f32_32x32x16_bf16 v[100:115], v[44:47], v[216:219], v[100:115]
    ds_read_b64_tr_b16 v[36:37], v86 offset:23040
    ds_read_b64_tr_b16 v[38:39], v87 offset:23040
    v_max3_f32 v83, v83, v208, v209
    v_max3_f32 v90, v90, v210, v211
    v_cvt_pk_bf16_f32 v231, v234, v235
    v_exp_f32 v238, v238
    v_exp_f32 v239, v239
    ds_read_b64_tr_b16 v[16:17], v86 offset:0
    ds_read_b64_tr_b16 v[18:19], v87 offset:0
    v_cvt_pk_bf16_f32 v232, v236, v237
    v_exp_f32 v240, v240
    v_exp_f32 v241, v241
    ds_read_b64_tr_b16 v[20:21], v86 offset:256
    ds_read_b64_tr_b16 v[22:23], v87 offset:256
    v_cvt_pk_bf16_f32 v233, v238, v239
    v_exp_f32 v242, v242
    v_exp_f32 v243, v243
    v_cvt_pk_bf16_f32 v234, v240, v241
    v_max3_f32 v83, v83, v90, v91
    v_mov_b32 v90, v83
    s_nop 1
    v_permlane32_swap_b32 v83, v90
    s_nop 0
    v_max_f32 v83, v83, v90
    v_cndmask_b32 v254, 0, -v83, s[38:39]
    v_and_b32 v255, 0xffff0000, v254
    v_sub_f32 v254, v254, v255
    v_and_b32 v83, 0xffff0000, v254
    v_sub_f32 v254, v254, v83
    v_perm_b32 v4, v83, v255, s34
    v_lshrrev_b32 v5, 16, v254
    s_waitcnt lgkmcnt(6)
    v_cmp_gt_u32 vcc, 2, v253
    s_cbranch_vccnz L_hv_cw_17
L_hv_cw_17_b:
    v_mfma_f32_32x32x16_bf16 v[64:79], v[84:87], v[4:7], v[64:79]
    v_mfma_f32_32x32x16_bf16 v[116:131], v[84:87], v[4:7], v[116:131]
    v_cvt_pk_bf16_f32 v235, v242, v243
    v_and_b32 v236, v228, v92
    v_and_b32 v237, v229, v93
    v_and_b32 v238, v230, v94
    v_and_b32 v239, v231, v95
    v_xor_b32 v228, v228, v236
    v_xor_b32 v229, v229, v237
    v_xor_b32 v230, v230, v238
    v_xor_b32 v231, v231, v239
    s_waitcnt lgkmcnt(0)
    v_mfma_f32_32x32x16_bf16 v[100:115], v[32:35], v[236:239], v[100:115]
    s_nop 0
    v_mfma_f32_32x32x16_bf16 v[100:115], v[16:19], v[228:231], v[100:115]
    ds_read_b64_tr_b16 v[40:41], v88 offset:2848
    ds_read_b64_tr_b16 v[42:43], v89 offset:2848
    v_and_b32 v240, v232, v96
    v_and_b32 v241, v233, v97
    v_and_b32 v242, v234, v98
    v_and_b32 v243, v235, v99
    v_xor_b32 v232, v232, v240
    v_xor_b32 v233, v233, v241
    v_xor_b32 v234, v234, v242
    v_xor_b32 v235, v235, v243
    v_mfma_f32_32x32x16_bf16 v[100:115], v[36:39], v[240:243], v[100:115]
    s_nop 0
    v_mfma_f32_32x32x16_bf16 v[100:115], v[20:23], v[232:235], v[100:115]
    ds_read_b64_tr_b16 v[44:45], v88 offset:3104
    ds_read_b64_tr_b16 v[46:47], v89 offset:3104
    v_exp_f32 v64, v64
    v_exp_f32 v65, v65
    v_exp_f32 v66, v66
    v_exp_f32 v67, v67
    v_cvt_pk_bf16_f32 v64, v64, v65
    v_exp_f32 v68, v68
    v_exp_f32 v69, v69
    v_cvt_pk_bf16_f32 v65, v66, v67
    v_exp_f32 v70, v70
    v_exp_f32 v71, v71
    v_rcp_f32 v254, v112
    v_cvt_pk_bf16_f32 v66, v68, v69
    s_nop 0
    v_exp_f32 v72, v72
    v_exp_f32 v73, v73
    v_mov_b32 v255, v254
    v_cvt_pk_bf16_f32 v67, v70, v71
    v_pk_mul_f32 v[100:101], v[100:101], v[254:255]
    v_exp_f32 v74, v74
    v_exp_f32 v75, v75
    v_pk_mul_f32 v[102:103], v[102:103], v[254:255]
    v_cvt_pk_bf16_f32 v68, v72, v73
    v_pk_mul_f32 v[104:105], v[104:105], v[254:255]
    v_exp_f32 v76, v76
    v_exp_f32 v77, v77
    v_mfma_f32_32x32x16_bf16 v[132:147], v[84:87], v[4:7], v[132:147]
    v_pk_mul_f32 v[106:107], v[106:107], v[254:255]
    v_cvt_pk_bf16_f32 v69, v74, v75
    v_pk_mul_f32 v[108:109], v[108:109], v[254:255]
    v_exp_f32 v78, v78
    v_exp_f32 v79, v79
    v_pk_mul_f32 v[110:111], v[110:111], v[254:255]
    v_cvt_pk_bf16_f32 v70, v76, v77
    v_cvt_pk_bf16_f32 v8, v100, v101
    v_exp_f32 v116, v116
    v_exp_f32 v117, v117
    v_cvt_pk_bf16_f32 v71, v78, v79
    v_cvt_pk_bf16_f32 v9, v102, v103
    v_exp_f32 v118, v118
    v_exp_f32 v119, v119
    v_cvt_pk_bf16_f32 v10, v104, v105
    v_cvt_pk_bf16_f32 v116, v116, v117
    s_waitcnt lgkmcnt(0)
    v_mfma_f32_32x32x16_bf16 v[212:227], v[40:43], v[64:67], 0
    ds_read_b64_tr_b16 v[32:33], v88 offset:5696
    ds_read_b64_tr_b16 v[34:35], v89 offset:5696
    v_cvt_pk_bf16_f32 v11, v106, v107
    v_exp_f32 v120, v120
    v_exp_f32 v121, v121
    v_cvt_pk_bf16_f32 v12, v108, v109
    v_cvt_pk_bf16_f32 v117, v118, v119
    v_cvt_pk_bf16_f32 v13, v110, v111
    v_exp_f32 v122, v122
    v_exp_f32 v123, v123
    v_cvt_pk_bf16_f32 v118, v120, v121
    v_exp_f32 v124, v124
    v_exp_f32 v125, v125
    v_mfma_f32_32x32x16_bf16 v[212:227], v[44:47], v[68:71], v[212:227]
    ds_read_b64_tr_b16 v[36:37], v88 offset:5952
    ds_read_b64_tr_b16 v[38:39], v89 offset:5952
    v_cvt_pk_bf16_f32 v119, v122, v123
    v_exp_f32 v126, v126
    v_exp_f32 v127, v127
    v_cvt_pk_bf16_f32 v120, v124, v125
    v_exp_f32 v128, v128
    v_exp_f32 v129, v129
    v_mfma_f32_32x32x16_bf16 v[148:163], v[84:87], v[4:7], v[148:163]
    v_cvt_pk_bf16_f32 v121, v126, v127
    v_exp_f32 v130, v130
    v_exp_f32 v131, v131
    v_cvt_pk_bf16_f32 v122, v128, v129
    v_exp_f32 v132, v132
    v_exp_f32 v133, v133
    v_cvt_pk_bf16_f32 v123, v130, v131
    s_cmp_lg_u32 s22, 0
    s_cbranch_scc1 L_slow_cw_18
    buffer_store_dwordx4 v[8:11], v2, s[4:7], s26 offen
L_back_cw_19:
    v_exp_f32 v134, v134
    v_exp_f32 v135, v135
    v_cvt_pk_bf16_f32 v132, v132, v133
    s_waitcnt lgkmcnt(0)
    v_mfma_f32_32x32x16_bf16 v[212:227], v[32:35], v[116:119], v[212:227]
    ds_read_b64_tr_b16 v[40:41], v88 offset:8544
    ds_read_b64_tr_b16 v[42:43], v89 offset:8544
    v_exp_f32 v136, v136
    v_exp_f32 v137, v137
    v_cvt_pk_bf16_f32 v133, v134, v135
    v_exp_f32 v138, v138
    v_exp_f32 v139, v139
    v_cvt_pk_bf16_f32 v134, v136, v137
    v_exp_f32 v140, v140
    v_exp_f32 v141, v141
    v_mfma_f32_32x32x16_bf16 v[212:227], v[36:39], v[120:123], v[212:227]
    ds_read_b64_tr_b16 v[44:45], v88 offset:8800
    ds_read_b64_tr_b16 v[46:47], v89 offset:8800
    v_cvt_pk_bf16_f32 v135, v138, v139
    v_exp_f32 v142, v142
    v_exp_f32 v143, v143
    v_cvt_pk_bf16_f32 v136, v140, v141
    v_exp_f32 v144, v144
    v_exp_f32 v145, v145
    v_mfma_f32_32x32x16_bf16 v[164:179], v[84:87], v[4:7], v[164:179]
    v_cvt_pk_bf16_f32 v137, v142, v143
    v_exp_f32 v146, v146
    v_exp_f32 v147, v147
    v_cvt_pk_bf16_f32 v138, v144, v145
    v_exp_f32 v148, v148
    v_exp_f32 v149, v149
    v_cvt_pk_bf16_f32 v139, v146, v147
    v_exp_f32 v150, v150
    v_exp_f32 v151, v151
    v_cvt_pk_bf16_f32 v148, v148, v149
    s_waitcnt lgkmcnt(0)
    v_mfma_f32_32x32x16_bf16 v[212:227], v[40:43], v[132:135], v[212:227]
    ds_read_b64_tr_b16 v[32:33], v88 offset:11392
    ds_read_b64_tr_b16 v[34:35], v89 offset:11392
    v_exp_f32 v152, v152
    v_exp_f32 v153, v153
    v_cvt_pk_bf16_f32 v149, v150, v151
    v_exp_f32 v154, v154
    v_exp_f32 v155, v155
    v_cvt_pk_bf16_f32 v150, v152, v153
    v_exp_f32 v156, v156
    v_exp_f32 v157, v157
    v_mfma_f32_32x32x16_bf16 v[212:227], v[44:47], v[136:139], v[212:227]
    ds_read_b64_tr_b16 v[36:37], v88 offset:11648
    ds_read_b64_tr_b16 v[38:39], v89 offset:11648
    v_cvt_pk_bf16_f32 v151, v154, v155
    v_exp_f32 v158, v158
    v_exp_f32 v159, v159
    v_cvt_pk_bf16_f32 v152, v156, v157
    v_exp_f32 v160, v160
    v_exp_f32 v161, v161
    v_mfma_f32_32x32x16_bf16 v[180:195], v[84:87], v[4:7], v[180:195]
    v_cvt_pk_bf16_f32 v153, v158, v159
    v_exp_f32 v162, v162
    v_exp_f32 v163, v163
    v_cvt_pk_bf16_f32 v154, v160, v161
    v_exp_f32 v164, v164
    v_exp_f32 v165, v165
    v_cvt_pk_bf16_f32 v155, v162, v163
    v_exp_f32 v166, v166
    v_exp_f32 v167, v167
    v_cvt_pk_bf16_f32 v164, v164, v165
    s_waitcnt lgkmcnt(0)
    v_mfma_f32_32x32x16_bf16 v[212:227], v[32:35], v[148:151], v[212:227]
    ds_read_b64_tr_b16 v[40:41], v88 offset:14240
    ds_read_b64_tr_b16 v[42:43], v89 offset:14240
    v_exp_f32 v168, v168
    v_exp_f32 v169, v169
    v_cvt_pk_bf16_f32 v165, v166, v167
    v_exp_f32 v170, v170
    v_exp_f32 v171, v171
    v_cvt_pk_bf16_f32 v166, v168, v169
    v_exp_f32 v172, v172
    v_exp_f32 v173, v173
    v_mfma_f32_32x32x16_bf16 v[212:227], v[36:39], v[152:155], v[212:227]
    ds_read_b64_tr_b16 v[44:45], v88 offset:14496
    ds_read_b64_tr_b16 v[46:47], v89 offset:14496
    v_cvt_pk_bf16_f32 v167, v170, v171
    v_exp_f32 v174, v174
    v_exp_f32 v175, v175
    v_cvt_pk_bf16_f32 v168, v172, v173
    v_exp_f32 v176, v176
    v_exp_f32 v177, v177
    v_mfma_f32_32x32x16_bf16 v[196:211], v[84:87], v[4:7], v[196:211]
    v_cvt_pk_bf16_f32 v169, v174, v175
    v_exp_f32 v178, v178
    v_exp_f32 v179, v179
    v_cvt_pk_bf16_f32 v170, v176, v177
    v_exp_f32 v180, v180
    v_exp_f32 v181, v181
    v_cvt_pk_bf16_f32 v171, v178, v179
    v_exp_f32 v182, v182
    v_exp_f32 v183, v183
    v_cvt_pk_bf16_f32 v180, v180, v181
    s_waitcnt lgkmcnt(0)
    v_mfma_f32_32x32x16_bf16 v[212:227], v[40:43], v[164:167], v[212:227]
    ds_read_b64_tr_b16 v[32:33], v88 offset:17088
    ds_read_b64_tr_b16 v[34:35], v89 offset:17088
    v_exp_f32 v184, v184
    v_exp_f32 v185, v185
    v_cvt_pk_bf16_f32 v181, v182, v183
    v_exp_f32 v186, v186
    v_exp_f32 v187, v187
    v_cvt_pk_bf16_f32 v182, v184, v185
    v_exp_f32 v188, v188
    v_exp_f32 v189, v189
    v_mfma_f32_32x32x16_bf16 v[212:227], v[44:47], v[168:171], v[212:227]
    ds_read_b64_tr_b16 v[36:37], v88 offset:17344
    ds_read_b64_tr_b16 v[38:39], v89 offset:17344
    v_cvt_pk_bf16_f32 v183, v186, v187
    v_exp_f32 v190, v190
    v_exp_f32 v191, v191
    v_cvt_pk_bf16_f32 v184, v188, v189
    v_exp_f32 v192, v192
    v_exp_f32 v193, v193
    v_mfma_f32_32x32x16_bf16 v[48:63], v[84:87], v[4:7], v[48:63]
    v_cvt_pk_bf16_f32 v185, v190, v191
    v_exp_f32 v194, v194
    v_exp_f32 v195, v195
    v_cvt_pk_bf16_f32 v186, v192, v193
    v_exp_f32 v196, v196
    v_exp_f32 v197, v197
    v_cvt_pk_bf16_f32 v187, v194, v195
    v_exp_f32 v198, v198
    v_exp_f32 v199, v199
    v_cvt_pk_bf16_f32 v196, v196, v197
    s_waitcnt lgkmcnt(0)
    v_mfma_f32_32x32x16_bf16 v[212:227], v[32:35], v[180:183], v[212:227]
    ds_read_b64_tr_b16 v[40:41], v88 offset:19936
    ds_read_b64_tr_b16 v[42:43], v89 offset:19936
    v_exp_f32 v200, v200
    v_exp_f32 v201, v201
    v_cvt_pk_bf16_f32 v197, v198, v199
    v_exp_f32 v202, v202
    v_exp_f32 v203, v203
    v_cvt_pk_bf16_f32 v198, v200, v201
    v_exp_f32 v204, v204
    v_exp_f32 v205, v205
    v_mfma_f32_32x32x16_bf16 v[212:227], v[36:39], v[184:187], v[212:227]
    ds_read_b64_tr_b16 v[44:45], v88 offset:20192
    ds_read_b64_tr_b16 v[46:47], v89 offset:20192
    v_cvt_pk_bf16_f32 v199, v202, v203
    v_exp_f32 v206, v206
    v_exp_f32 v207, v207
    v_cvt_pk_bf16_f32 v200, v204, v205
    v_exp_f32 v208, v208
    v_exp_f32 v209, v209
    v_cvt_pk_bf16_f32 v201, v206, v207
    v_exp_f32 v210, v210
    v_exp_f32 v211, v211
    v_cvt_pk_bf16_f32 v202, v208, v209
    v_exp_f32 v48, v48
    v_exp_f32 v49, v49
    v_cvt_pk_bf16_f32 v203, v210, v211
    v_exp_f32 v50, v50
    v_exp_f32 v51, v51
    v_cvt_pk_bf16_f32 v48, v48, v49
    s_waitcnt lgkmcnt(0)
    v_mfma_f32_32x32x16_bf16 v[212:227], v[40:43], v[196:199], v[212:227]
    ds_read_b64_tr_b16 v[32:33], v88 offset:22784
    ds_read_b64_tr_b16 v[34:35], v89 offset:22784
    v_exp_f32 v52, v52
    v_exp_f32 v53, v53
    v_cvt_pk_bf16_f32 v49, v50, v51
    v_exp_f32 v54, v54
    v_exp_f32 v55, v55
    v_cvt_pk_bf16_f32 v50, v52, v53
    v_exp_f32 v56, v56
    v_exp_f32 v57, v57
    v_mfma_f32_32x32x16_bf16 v[212:227], v[44:47], v[200:203], v[212:227]
    ds_read_b64_tr_b16 v[36:37], v88 offset:23040
    ds_read_b64_tr_b16 v[38:39], v89 offset:23040
    v_cvt_pk_bf16_f32 v51, v54, v55
    v_exp_f32 v58, v58
    v_exp_f32 v59, v59
    ds_read_b64_tr_b16 v[16:17], v88 offset:0
    ds_read_b64_tr_b16 v[18:19], v89 offset:0
    v_cvt_pk_bf16_f32 v52, v56, v57
    v_exp_f32 v60, v60
    v_exp_f32 v61, v61
    ds_read_b64_tr_b16 v[20:21], v88 offset:256
    ds_read_b64_tr_b16 v[22:23], v89 offset:256
    v_cvt_pk_bf16_f32 v53, v58, v59
    v_mov_b32 v251, 2
    ds_write_b8 v249, v251 offset:96
    v_exp_f32 v62, v62
    v_exp_f32 v63, v63
    v_cvt_pk_bf16_f32 v54, v60, v61
    s_nop 0
    v_cvt_pk_bf16_f32 v55, v62, v63
    v_and_b32 v56, v48, v92
    v_and_b32 v57, v49, v93
    v_and_b32 v58, v50, v94
    v_and_b32 v59, v51, v95
    v_xor_b32 v48, v48, v56
    v_xor_b32 v49, v49, v57
    v_xor_b32 v50, v50, v58
    v_xor_b32 v51, v51, v59
    s_waitcnt lgkmcnt(1)
    v_mfma_f32_32x32x16_bf16 v[212:227], v[32:35], v[56:59], v[212:227]
    s_nop 0
    v_mfma_f32_32x32x16_bf16 v[212:227], v[16:19], v[48:51], v[212:227]
    v_and_b32 v60, v52, v96
    v_and_b32 v61, v53, v97
    v_and_b32 v62, v54, v98
    v_and_b32 v63, v55, v99
    v_xor_b32 v52, v52, v60
    v_xor_b32 v53, v53, v61
    v_xor_b32 v54, v54, v62
    v_xor_b32 v55, v55, v63
    v_mfma_f32_32x32x16_bf16 v[212:227], v[36:39], v[60:63], v[212:227]
    s_nop 0
    v_mfma_f32_32x32x16_bf16 v[212:227], v[20:23], v[52:55], v[212:227]
    s_nop 11
    v_rcp_f32 v254, v224
    s_nop 0
    v_mov_b32 v255, v254
    v_pk_mul_f32 v[212:213], v[212:213], v[254:255]
    v_pk_mul_f32 v[214:215], v[214:215], v[254:255]
    v_pk_mul_f32 v[216:217], v[216:217], v[254:255]
    v_pk_mul_f32 v[218:219], v[218:219], v[254:255]
    v_pk_mul_f32 v[220:221], v[220:221], v[254:255]
    v_pk_mul_f32 v[222:223], v[222:223], v[254:255]
    v_cvt_pk_bf16_f32 v100, v212, v213
    v_cvt_pk_bf16_f32 v101, v214, v215
    v_cvt_pk_bf16_f32 v102, v216, v217
    v_cvt_pk_bf16_f32 v103, v218, v219
    v_cvt_pk_bf16_f32 v14, v220, v221
    v_cvt_pk_bf16_f32 v15, v222, v223
    s_cmp_lg_u32 s22, 0
    s_cbranch_scc1 L_slow_cw_20
    buffer_store_dwordx4 v[100:103], v2, s[4:7], s26 offen offset:1536
    s_mov_b32 exec_hi, 0
    buffer_store_dwordx4 v[12:15], v2, s[4:7], s26 offen offset:1024
    s_mov_b32 exec_hi, -1
L_back_cw_21:
    s_mov_b32 s80, s31
    s_mov_b32 s81, s85
    s_and_b32 s28, s18, 1
    s_lshr_b32 s29, s18, 1
    s_lshl_b32 s24, s19, 1
    s_add_u32 s24, s24, s28
    s_mul_i32 s32, s24, 40960
    s_mul_i32 s30, s20, 5120
    s_add_u32 s32, s32, s30
    s_add_u32 s33, s32, 4096
    s_lshl_b32 s30, s29, 8
    v_add_u32 v7, s30, v0
    s_xor_b32 s31, s30, 256
    v_add_u32 v8, s31, v0
    v_lshrrev_b32 v12, 4, v1
    v_and_b32 v13, 15, v1
    v_lshrrev_b32 v9, 5, v1
    v_lshlrev_b32 v9, 9, v9
    v_lshl_add_u32 v9, v13, 4, v9
    v_and_b32 v14, 1, v12
    v_lshl_add_u32 v9, v14, 3, v9
    v_add_u32 v9, s30, v9
    buffer_load_dwordx4 v[16:19], v7, s[4:7], s32 offen sc1
    buffer_load_dwordx4 v[20:23], v7, s[4:7], s32 offen offset:2048 sc1
    buffer_load_dwordx2 v[24:25], v9, s[4:7], s33 offen sc1
    v_lshlrev_b32 v40, 4, v12
    v_lshlrev_b32 v41, 3, v12
    s_mul_i32 s34, s20, 160
    s_mul_i32 s25, s24, 40960
    s_mul_i32 s30, s29, 20480
    s_add_u32 s25, s25, s30
    s_add_u32 s25, s25, 2621440
    s_add_u32 s40, s25, 0
    s_add_u32 s41, s25, 4096
    s_add_u32 s42, s25, 8192
    s_add_u32 s43, s25, 12288
    s_add_u32 s44, s25, 16384
    s_lshl_b32 s27, s24, 9
    s_lshl_b32 s30, s29, 6
    s_add_u32 s27, s27, s30
    s_add_u32 s27, s27, 32342016
    s_mul_i32 s30, s29, 5120
    v_add_u32 v4, s30, v2
    v_add_u32 v5, 0xf000, v4
    v_add_u32 v6, 0x1e000, v4
    s_lshl_b32 s38, s24, 11
    s_lshr_b32 s36, s20, 1
    s_lshl_b32 s36, s36, 9
    s_add_u32 s38, s38, s36
    s_and_b32 s36, s20, 1
    s_lshl_b32 s36, s36, 3
    s_add_u32 s38, s38, s36
    s_lshl_b32 s36, s29, 8
    s_add_u32 s38, s38, s36
    s_add_u32 s38, s38, 11534336
    s_lshl_b32 s36, s20, 1
    s_add_u32 s36, s36, s29
    s_lshl_b32 s36, s36, 3
    s_lshl_b32 s37, s24, 9
    s_add_u32 s36, s36, s37
    s_add_u32 s36, s36, 32342144
    s_mul_i32 s30, s18, 5120
    s_add_u32 s30, s30, 0
    v_add_u32 v14, s30, v2
    s_xor_b32 s30, s18, 2
    s_mul_i32 s30, s30, 5120
    s_add_u32 s30, s30, 0
    v_add_u32 v15, s30, v2
    s_cmp_lg_u32 s22, 0
    s_cbranch_scc1 L_slow_cw_22
    v_mov_b32 v10, s81
    v_mov_b32 v11, s72
    s_waitcnt vmcnt(3)
    s_mov_b64 exec, 1
    buffer_store_dwordx2 v[10:11], off, s[4:7], s80
    s_mov_b64 exec, -1
L_back_cw_23:
    s_waitcnt vmcnt(1)
    v_lshlrev_b32 v92, 16, v16
    v_and_b32 v93, 0xffff0000, v16
    v_lshlrev_b32 v94, 16, v17
    v_and_b32 v95, 0xffff0000, v17
    v_lshlrev_b32 v100, 16, v18
    v_and_b32 v101, 0xffff0000, v18
    v_lshlrev_b32 v102, 16, v19
    v_and_b32 v103, 0xffff0000, v19
    v_lshlrev_b32 v108, 16, v20
    v_and_b32 v109, 0xffff0000, v20
    v_lshlrev_b32 v110, 16, v21
    v_and_b32 v111, 0xffff0000, v21
    v_lshlrev_b32 v116, 16, v22
    v_and_b32 v117, 0xffff0000, v22
    v_lshlrev_b32 v118, 16, v23
    v_and_b32 v119, 0xffff0000, v23
    v_lshlrev_b32 v124, 16, v24
    v_and_b32 v125, 0xffff0000, v24
    v_lshlrev_b32 v126, 16, v25
    v_and_b32 v127, 0xffff0000, v25
    v_lshlrev_b32 v250, 3, v1
    s_mov_b64 exec, 0xff
    s_mov_b32 s90, 0
L_poll_cw_24:
    buffer_load_dwordx2 v[10:11], v250, s[4:7], s27 offen sc1
    s_add_u32 s90, s90, 1
    s_cmp_gt_u32 s90, 200000
    s_cbranch_scc1 L_poll_cw_24_out
    s_waitcnt vmcnt(0)
    v_subrev_u32 v10, s85, v10
    v_xor_b32 v11, s72, v11
    v_or_b32 v11, v10, v11
    v_cmp_lt_u32 vcc, 7, v11
    s_cbranch_vccnz L_poll_cw_24
L_poll_cw_24_out:
    s_mov_b64 exec, -1
    ds_read_u8 v252, v248 offset:64
    buffer_load_dwordx4 v[132:135], v7, s[4:7], s40 offen offset:0 sc1
    buffer_load_dwordx4 v[136:139], v8, s[4:7], s40 offen offset:0 sc1
    buffer_load_dwordx4 v[140:143], v7, s[4:7], s40 offen offset:2048 sc1
    buffer_load_dwordx4 v[144:147], v8, s[4:7], s40 offen offset:2048 sc1
    buffer_load_dwordx4 v[148:151], v7, s[4:7], s41 offen offset:0 sc1
    buffer_load_dwordx4 v[152:155], v8, s[4:7], s41 offen offset:0 sc1
    buffer_load_dwordx4 v[156:159], v7, s[4:7], s41 offen offset:2048 sc1
    buffer_load_dwordx4 v[160:163], v8, s[4:7], s41 offen offset:2048 sc1
    buffer_load_dwordx4 v[164:167], v7, s[4:7], s42 offen offset:0 sc1
    buffer_load_dwordx4 v[168:171], v8, s[4:7], s42 offen offset:0 sc1
    buffer_load_dwordx4 v[172:175], v7, s[4:7], s42 offen offset:2048 sc1
    buffer_load_dwordx4 v[176:179], v8, s[4:7], s42 offen offset:2048 sc1
    s_waitcnt lgkmcnt(0)
    v_cmp_gt_u32 vcc, 12, v252
    s_cbranch_vccnz L_lw_cw_25
L_lw_cw_25_b:
    ds_read_u8 v252, v248 offset:64
    s_waitcnt lgkmcnt(0)
    v_cmp_gt_u32 vcc, 13, v252
    s_cbranch_vccnz L_lw_cw_26
L_lw_cw_26_b:
    ds_read_b128 v[48:51], v5 offset:10112
    ds_read_b128 v[52:55], v5 offset:11136
    ds_read_b128 v[56:59], v5 offset:12160
    ds_read_b128 v[60:63], v5 offset:13184
    ds_read_b128 v[64:67], v5 offset:14208
    ds_read_b128 v[68:71], v5 offset:20352
    ds_read_b128 v[72:75], v5 offset:21376
    ds_read_b128 v[76:79], v5 offset:22400
    ds_read_b128 v[80:83], v5 offset:23424
    ds_read_b128 v[84:87], v5 offset:24448
    s_waitcnt vmcnt(10) lgkmcnt(5)
    v_mfma_f32_16x16x32_bf16 v[92:95], v[48:51], v[132:135], v[92:95]
    ds_read_b128 v[88:91], v5 offset:30592
    v_mfma_f32_16x16x32_bf16 v[96:99], v[48:51], v[136:139], 0
    ds_read_u8 v252, v248 offset:64
    v_mov_b32 v251, 12
    v_mfma_f32_16x16x32_bf16 v[100:103], v[52:55], v[132:135], v[100:103]
    ds_read_b128 v[48:51], v5 offset:31616
    v_mfma_f32_16x16x32_bf16 v[104:107], v[52:55], v[136:139], 0
    ds_write_b8 v249, v251 offset:68
    buffer_load_dwordx4 v[180:183], v7, s[4:7], s43 offen offset:0 sc1
    v_mfma_f32_16x16x32_bf16 v[108:111], v[56:59], v[132:135], v[108:111]
    ds_read_b128 v[52:55], v5 offset:32640
    v_mfma_f32_16x16x32_bf16 v[112:115], v[56:59], v[136:139], 0
    v_mfma_f32_16x16x32_bf16 v[116:119], v[60:63], v[132:135], v[116:119]
    ds_read_b128 v[56:59], v5 offset:33664
    v_mfma_f32_16x16x32_bf16 v[120:123], v[60:63], v[136:139], 0
    buffer_load_dwordx4 v[184:187], v8, s[4:7], s43 offen offset:0 sc1
    v_mfma_f32_16x16x32_bf16 v[124:127], v[64:67], v[132:135], v[124:127]
    ds_read_b128 v[60:63], v5 offset:34688
    v_mfma_f32_16x16x32_bf16 v[128:131], v[64:67], v[136:139], 0
    s_waitcnt vmcnt(10) lgkmcnt(7)
    v_mfma_f32_16x16x32_bf16 v[92:95], v[68:71], v[140:143], v[92:95]
    ds_read_b128 v[64:67], v5 offset:40832
    v_mfma_f32_16x16x32_bf16 v[96:99], v[68:71], v[144:147], v[96:99]
    v_mfma_f32_16x16x32_bf16 v[100:103], v[72:75], v[140:143], v[100:103]
    ds_read_b128 v[68:71], v5 offset:41856
    v_mfma_f32_16x16x32_bf16 v[104:107], v[72:75], v[144:147], v[104:107]
    buffer_load_dwordx4 v[188:191], v7, s[4:7], s43 offen offset:2048 sc1
    v_mfma_f32_16x16x32_bf16 v[108:111], v[76:79], v[140:143], v[108:111]
    ds_read_b128 v[72:75], v5 offset:42880
    v_mfma_f32_16x16x32_bf16 v[112:115], v[76:79], v[144:147], v[112:115]
    s_waitcnt lgkmcnt(8)
    v_cmp_gt_u32 vcc, 14, v252
    v_mfma_f32_16x16x32_bf16 v[116:119], v[80:83], v[140:143], v[116:119]
    ds_read_b128 v[76:79], v5 offset:43904
    v_mfma_f32_16x16x32_bf16 v[120:123], v[80:83], v[144:147], v[120:123]
    s_cbranch_vccnz L_lw_cw_27
L_lw_cw_27_b:
    buffer_load_dwordx4 v[192:195], v8, s[4:7], s43 offen offset:2048 sc1
    v_mfma_f32_16x16x32_bf16 v[124:127], v[84:87], v[140:143], v[124:127]
    ds_read_b128 v[80:83], v5 offset:44928
    v_mfma_f32_16x16x32_bf16 v[128:131], v[84:87], v[144:147], v[128:131]
    s_waitcnt vmcnt(10) lgkmcnt(5)
    v_mfma_f32_16x16x32_bf16 v[92:95], v[88:91], v[148:151], v[92:95]
    ds_read_b128 v[84:87], v5 offset:51072
    v_mfma_f32_16x16x32_bf16 v[96:99], v[88:91], v[152:155], v[96:99]
    ds_read_u8 v252, v248 offset:64
    v_mov_b32 v251, 13
    v_mfma_f32_16x16x32_bf16 v[100:103], v[48:51], v[148:151], v[100:103]
    ds_read_b128 v[88:91], v5 offset:52096
    v_mfma_f32_16x16x32_bf16 v[104:107], v[48:51], v[152:155], v[104:107]
    ds_write_b8 v249, v251 offset:68
    buffer_load_dwordx4 v[196:199], v7, s[4:7], s44 offen offset:0 sc1
    v_mfma_f32_16x16x32_bf16 v[108:111], v[52:55], v[148:151], v[108:111]
    ds_read_b128 v[48:51], v5 offset:53120
    v_mfma_f32_16x16x32_bf16 v[112:115], v[52:55], v[152:155], v[112:115]
    v_mfma_f32_16x16x32_bf16 v[116:119], v[56:59], v[148:151], v[116:119]
    ds_read_b128 v[52:55], v5 offset:54144
    v_mfma_f32_16x16x32_bf16 v[120:123], v[56:59], v[152:155], v[120:123]
    buffer_load_dwordx4 v[200:203], v8, s[4:7], s44 offen offset:0 sc1
    v_mfma_f32_16x16x32_bf16 v[124:127], v[60:63], v[148:151], v[124:127]
    ds_read_b128 v[56:59], v5 offset:55168
    v_mfma_f32_16x16x32_bf16 v[128:131], v[60:63], v[152:155], v[128:131]
    s_waitcnt vmcnt(10) lgkmcnt(7)
    v_mfma_f32_16x16x32_bf16 v[92:95], v[64:67], v[156:159], v[92:95]
    ds_read_b128 v[60:63], v5 offset:61312
    v_mfma_f32_16x16x32_bf16 v[96:99], v[64:67], v[160:163], v[96:99]
    v_mfma_f32_16x16x32_bf16 v[100:103], v[68:71], v[156:159], v[100:103]
    ds_read_b128 v[64:67], v5 offset:62336
    v_mfma_f32_16x16x32_bf16 v[104:107], v[68:71], v[160:163], v[104:107]
    buffer_load_dwordx4 v[204:207], v7, s[4:7], s44 offen offset:2048 sc1
    v_mfma_f32_16x16x32_bf16 v[108:111], v[72:75], v[156:159], v[108:111]
    ds_read_b128 v[68:71], v5 offset:63360
    v_mfma_f32_16x16x32_bf16 v[112:115], v[72:75], v[160:163], v[112:115]
    s_waitcnt lgkmcnt(8)
    v_cmp_gt_u32 vcc, 15, v252
    v_mfma_f32_16x16x32_bf16 v[116:119], v[76:79], v[156:159], v[116:119]
    ds_read_b128 v[72:75], v5 offset:64384
    v_mfma_f32_16x16x32_bf16 v[120:123], v[76:79], v[160:163], v[120:123]
    s_cbranch_vccnz L_lw_cw_28
L_lw_cw_28_b:
    buffer_load_dwordx4 v[208:211], v8, s[4:7], s44 offen offset:2048 sc1
    v_mfma_f32_16x16x32_bf16 v[124:127], v[80:83], v[156:159], v[124:127]
    ds_read_b128 v[76:79], v5 offset:65408
    v_mfma_f32_16x16x32_bf16 v[128:131], v[80:83], v[160:163], v[128:131]
    s_waitcnt vmcnt(10) lgkmcnt(5)
    v_mfma_f32_16x16x32_bf16 v[92:95], v[84:87], v[164:167], v[92:95]
    ds_read_b128 v[80:83], v6 offset:10112
    v_mfma_f32_16x16x32_bf16 v[96:99], v[84:87], v[168:171], v[96:99]
    ds_read_u8 v252, v248 offset:64
    v_mov_b32 v251, 14
    v_mfma_f32_16x16x32_bf16 v[100:103], v[88:91], v[164:167], v[100:103]
    ds_read_b128 v[84:87], v6 offset:11136
    v_mfma_f32_16x16x32_bf16 v[104:107], v[88:91], v[168:171], v[104:107]
    ds_write_b8 v249, v251 offset:68
    v_mfma_f32_16x16x32_bf16 v[108:111], v[48:51], v[164:167], v[108:111]
    ds_read_b128 v[88:91], v6 offset:12160
    v_mfma_f32_16x16x32_bf16 v[112:115], v[48:51], v[168:171], v[112:115]
    v_mfma_f32_16x16x32_bf16 v[116:119], v[52:55], v[164:167], v[116:119]
    ds_read_b128 v[48:51], v6 offset:13184
    v_mfma_f32_16x16x32_bf16 v[120:123], v[52:55], v[168:171], v[120:123]
    v_mfma_f32_16x16x32_bf16 v[124:127], v[56:59], v[164:167], v[124:127]
    ds_read_b128 v[52:55], v6 offset:14208
    v_mfma_f32_16x16x32_bf16 v[128:131], v[56:59], v[168:171], v[128:131]
    s_waitcnt vmcnt(8) lgkmcnt(7)
    v_mfma_f32_16x16x32_bf16 v[92:95], v[60:63], v[172:175], v[92:95]
    ds_read_b128 v[56:59], v6 offset:20352
    v_mfma_f32_16x16x32_bf16 v[96:99], v[60:63], v[176:179], v[96:99]
    v_mfma_f32_16x16x32_bf16 v[100:103], v[64:67], v[172:175], v[100:103]
    ds_read_b128 v[60:63], v6 offset:21376
    v_mfma_f32_16x16x32_bf16 v[104:107], v[64:67], v[176:179], v[104:107]
    v_mfma_f32_16x16x32_bf16 v[108:111], v[68:71], v[172:175], v[108:111]
    ds_read_b128 v[64:67], v6 offset:22400
    v_mfma_f32_16x16x32_bf16 v[112:115], v[68:71], v[176:179], v[112:115]
    s_waitcnt lgkmcnt(8)
    v_cmp_gt_u32 vcc, 16, v252
    v_mfma_f32_16x16x32_bf16 v[116:119], v[72:75], v[172:175], v[116:119]
    ds_read_b128 v[68:71], v6 offset:23424
    v_mfma_f32_16x16x32_bf16 v[120:123], v[72:75], v[176:179], v[120:123]
    s_cbranch_vccnz L_lw_cw_29
L_lw_cw_29_b:
    v_mfma_f32_16x16x32_bf16 v[124:127], v[76:79], v[172:175], v[124:127]
    ds_read_b128 v[72:75], v6 offset:24448
    v_mfma_f32_16x16x32_bf16 v[128:131], v[76:79], v[176:179], v[128:131]
    v_mov_b32 v251, 15
    s_waitcnt vmcnt(6) lgkmcnt(5)
    v_mfma_f32_16x16x32_bf16 v[92:95], v[80:83], v[180:183], v[92:95]
    ds_read_b128 v[76:79], v6 offset:30592
    v_mfma_f32_16x16x32_bf16 v[96:99], v[80:83], v[184:187], v[96:99]
    ds_write_b8 v249, v251 offset:68
    v_mfma_f32_16x16x32_bf16 v[100:103], v[84:87], v[180:183], v[100:103]
    ds_read_b128 v[80:83], v6 offset:31616
    v_mfma_f32_16x16x32_bf16 v[104:107], v[84:87], v[184:187], v[104:107]
    v_mfma_f32_16x16x32_bf16 v[108:111], v[88:91], v[180:183], v[108:111]
    ds_read_b128 v[84:87], v6 offset:32640
    v_mfma_f32_16x16x32_bf16 v[112:115], v[88:91], v[184:187], v[112:115]
    v_mfma_f32_16x16x32_bf16 v[116:119], v[48:51], v[180:183], v[116:119]
    ds_read_b128 v[88:91], v6 offset:33664
    v_mfma_f32_16x16x32_bf16 v[120:123], v[48:51], v[184:187], v[120:123]
    v_mfma_f32_16x16x32_bf16 v[124:127], v[52:55], v[180:183], v[124:127]
    ds_read_b128 v[48:51], v6 offset:34688
    v_mfma_f32_16x16x32_bf16 v[128:131], v[52:55], v[184:187], v[128:131]
    s_waitcnt vmcnt(4) lgkmcnt(6)
    v_mfma_f32_16x16x32_bf16 v[92:95], v[56:59], v[188:191], v[92:95]
    ds_read_b128 v[52:55], v4 offset:61312
    v_mfma_f32_16x16x32_bf16 v[96:99], v[56:59], v[192:195], v[96:99]
    v_mfma_f32_16x16x32_bf16 v[100:103], v[60:63], v[188:191], v[100:103]
    ds_read_b128 v[56:59], v4 offset:62336
    v_mfma_f32_16x16x32_bf16 v[104:107], v[60:63], v[192:195], v[104:107]
    v_mfma_f32_16x16x32_bf16 v[108:111], v[64:67], v[188:191], v[108:111]
    ds_read_b128 v[60:63], v4 offset:63360
    v_mfma_f32_16x16x32_bf16 v[112:115], v[64:67], v[192:195], v[112:115]
    v_mfma_f32_16x16x32_bf16 v[116:119], v[68:71], v[188:191], v[116:119]
    ds_read_b128 v[64:67], v4 offset:64384
    v_mfma_f32_16x16x32_bf16 v[120:123], v[68:71], v[192:195], v[120:123]
    v_mov_b32 v251, 16
    v_mfma_f32_16x16x32_bf16 v[124:127], v[72:75], v[188:191], v[124:127]
    ds_read_b128 v[68:71], v4 offset:65408
    v_mfma_f32_16x16x32_bf16 v[128:131], v[72:75], v[192:195], v[128:131]
    s_waitcnt vmcnt(2) lgkmcnt(5)
    v_mfma_f32_16x16x32_bf16 v[92:95], v[76:79], v[196:199], v[92:95]
    v_mfma_f32_16x16x32_bf16 v[96:99], v[76:79], v[200:203], v[96:99]
    ds_write_b8 v249, v251 offset:68
    v_mfma_f32_16x16x32_bf16 v[100:103], v[80:83], v[196:199], v[100:103]
    v_mfma_f32_16x16x32_bf16 v[104:107], v[80:83], v[200:203], v[104:107]
    ds_read_u8 v253, v248 offset:96
    v_mfma_f32_16x16x32_bf16 v[108:111], v[84:87], v[196:199], v[108:111]
    v_mfma_f32_16x16x32_bf16 v[112:115], v[84:87], v[200:203], v[112:115]
    v_mfma_f32_16x16x32_bf16 v[116:119], v[88:91], v[196:199], v[116:119]
    v_mfma_f32_16x16x32_bf16 v[120:123], v[88:91], v[200:203], v[120:123]
    v_mfma_f32_16x16x32_bf16 v[124:127], v[48:51], v[196:199], v[124:127]
    v_mfma_f32_16x16x32_bf16 v[128:131], v[48:51], v[200:203], v[128:131]
    s_waitcnt vmcnt(0) lgkmcnt(2)
    v_mfma_f32_16x16x32_bf16 v[92:95], v[52:55], v[204:207], v[92:95]
    v_mfma_f32_16x16x32_bf16 v[96:99], v[52:55], v[208:211], v[96:99]
    v_mfma_f32_16x16x32_bf16 v[100:103], v[56:59], v[204:207], v[100:103]
    v_mfma_f32_16x16x32_bf16 v[104:107], v[56:59], v[208:211], v[104:107]
    s_waitcnt lgkmcnt(0)
    v_cmp_gt_u32 vcc, 2, v253
    s_cbranch_vccnz L_xc_cw_30
L_xc_cw_30_b:
    v_mfma_f32_16x16x32_bf16 v[108:111], v[60:63], v[204:207], v[108:111]
    v_mfma_f32_16x16x32_bf16 v[112:115], v[60:63], v[208:211], v[112:115]
    v_mfma_f32_16x16x32_bf16 v[116:119], v[64:67], v[204:207], v[116:119]
    v_mfma_f32_16x16x32_bf16 v[120:123], v[64:67], v[208:211], v[120:123]
    v_mfma_f32_16x16x32_bf16 v[124:127], v[68:71], v[204:207], v[124:127]
    v_mfma_f32_16x16x32_bf16 v[128:131], v[68:71], v[208:211], v[128:131]
    v_mov_b32 v251, 17
    s_xor_b32 s30, s18, 2
    s_lshl_b32 s30, 1, s30
    s_nop 0
    ds_write_b128 v14, v[96:99] offset:0
    ds_write_b128 v14, v[104:107] offset:1024
    ds_write_b128 v14, v[112:115] offset:2048
    s_nop 1
    ds_write_b128 v14, v[120:123] offset:3072
    ds_write_b128 v14, v[128:131] offset:4096
    ds_write_b8 v249, v251 offset:80
    ds_read_u8 v250, v248 offset:80
    v_mov_b32 v10, 0x3f803f80
    v_mov_b32 v42, 0
    v_mov_b32 v43, 0
    s_mov_b32 s90, 0
    s_branch L_xw_cw_31_c
L_xw_cw_31:
    ds_read_u8 v250, v248 offset:80
    s_add_u32 s90, s90, 1
    s_cmp_gt_u32 s90, 1600000
    s_cbranch_scc1 L_xw_cw_31_out
L_xw_cw_31_c:
    s_waitcnt lgkmcnt(0)
    v_cmp_gt_u32 vcc, 17, v250
    s_and_b32 s37, vcc_lo, s30
    s_cbranch_scc1 L_xw_cw_31
L_xw_cw_31_out:
    ds_read_b128 v[132:135], v15 offset:0
    ds_read_b128 v[136:139], v15 offset:1024
    ds_read_b128 v[140:143], v15 offset:2048
    ds_read_b128 v[144:147], v15 offset:3072
    ds_read_b128 v[148:151], v15 offset:4096
    ds_write_b8 v249, v251 offset:68
    s_waitcnt lgkmcnt(5)
    v_pk_add_f32 v[132:133], v[132:133], v[92:93]
    v_pk_add_f32 v[134:135], v[134:135], v[94:95]
    v_cvt_pk_bf16_f32 v48, v132, v133
    v_cvt_pk_bf16_f32 v49, v134, v135
    s_waitcnt lgkmcnt(4)
    v_pk_add_f32 v[136:137], v[136:137], v[100:101]
    v_pk_add_f32 v[138:139], v[138:139], v[102:103]
    v_cvt_pk_bf16_f32 v50, v136, v137
    v_cvt_pk_bf16_f32 v51, v138, v139
    s_waitcnt lgkmcnt(3)
    v_pk_add_f32 v[140:141], v[140:141], v[108:109]
    v_pk_add_f32 v[142:143], v[142:143], v[110:111]
    v_cvt_pk_bf16_f32 v52, v140, v141
    v_cvt_pk_bf16_f32 v53, v142, v143
    s_waitcnt lgkmcnt(2)
    v_pk_add_f32 v[144:145], v[144:145], v[116:117]
    v_pk_add_f32 v[146:147], v[146:147], v[118:119]
    v_cvt_pk_bf16_f32 v54, v144, v145
    v_cvt_pk_bf16_f32 v55, v146, v147
    s_waitcnt lgkmcnt(1)
    v_pk_add_f32 v[148:149], v[148:149], v[124:125]
    v_pk_add_f32 v[150:151], v[150:151], v[126:127]
    v_cvt_pk_bf16_f32 v56, v148, v149
    v_cvt_pk_bf16_f32 v57, v150, v151
    s_cmp_lg_u32 s22, 0
    s_cbranch_scc1 L_slow_cw_32
    buffer_store_dwordx4 v[48:51], v7, s[4:7], s32 offen
    buffer_store_dwordx4 v[52:55], v7, s[4:7], s32 offen offset:2048
    buffer_store_dwordx2 v[56:57], v9, s[4:7], s33 offen
    v_dot2_f32_bf16 v42, v48, v10, v42
    v_dot2_f32_bf16 v43, v48, v48, v43
    v_dot2_f32_bf16 v42, v49, v10, v42
    v_dot2_f32_bf16 v43, v49, v49, v43
    v_dot2_f32_bf16 v42, v50, v10, v42
    v_dot2_f32_bf16 v43, v50, v50, v43
    v_dot2_f32_bf16 v42, v51, v10, v42
    v_dot2_f32_bf16 v43, v51, v51, v43
    v_dot2_f32_bf16 v42, v52, v10, v42
    v_dot2_f32_bf16 v43, v52, v52, v43
    v_dot2_f32_bf16 v42, v53, v10, v42
    v_dot2_f32_bf16 v43, v53, v53, v43
    v_dot2_f32_bf16 v42, v54, v10, v42
    v_dot2_f32_bf16 v43, v54, v54, v43
    v_dot2_f32_bf16 v42, v55, v10, v42
    v_dot2_f32_bf16 v43, v55, v55, v43
    v_dot2_f32_bf16 v42, v56, v10, v42
    v_dot2_f32_bf16 v43, v56, v56, v43
    v_dot2_f32_bf16 v42, v57, v10, v42
    v_dot2_f32_bf16 v43, v57, v57, v43
    s_nop 2
    v_mov_b32 v10, v42
    v_mov_b32 v11, v43
    s_nop 1
    v_permlane32_swap_b32 v42, v10
    v_permlane32_swap_b32 v43, v11
    s_nop 0
    v_add_f32 v42, v42, v10
    v_add_f32 v43, v43, v11
    v_mov_b32 v10, v42
    v_mov_b32 v11, v43
    s_nop 1
    v_permlane16_swap_b32 v42, v10
    v_permlane16_swap_b32 v43, v11
    s_nop 0
    v_add_f32 v42, v42, v10
    v_add_f32 v43, v43, v11
    s_mov_b64 exec, 0xffff
    buffer_store_dwordx2 v[42:43], v2, s[4:7], s38 offen
    s_mov_b64 exec, -1
L_back_cw_33:
    s_mov_b32 s80, s36
    s_mov_b32 s81, s87
    s_lshl_b32 s24, s16, 2
    s_add_u32 s24, s24, s18
    s_mul_i32 s25, s24, 40960
    s_lshl_b32 s26, s24, 11
    s_add_u32 s26, s26, 11534336
    s_lshl_b32 s27, s24, 9
    s_lshl_b32 s31, s17, 3
    s_add_u32 s30, s27, s31
    s_add_u32 s30, s30, 32342272
    s_add_u32 s27, s27, 32342144
    s_add_u32 s40, s25, 0
    s_add_u32 s41, s25, 4096
    s_add_u32 s42, s25, 8192
    s_add_u32 s43, s25, 12288
    s_add_u32 s44, s25, 16384
    s_add_u32 s45, s25, 20480
    s_add_u32 s46, s25, 24576
    s_add_u32 s47, s25, 28672
    s_add_u32 s48, s25, 32768
    s_add_u32 s49, s25, 36864
    s_mov_b32 s34, 0xffff0000
    s_mov_b32 s35, 0
    s_mov_b32 s36, 0xffff
    s_mov_b32 s37, 0
    v_add_u32 v4, 0xf000, v2
    v_add_u32 v5, 0x1e000, v2
    v_and_b32 v6, 15, v1
    v_lshlrev_b32 v6, 4, v6
    v_add_u32 v6, 58752, v6
    s_mul_i32 s28, s24, 98304
    s_mul_i32 s29, s17, 6144
    s_add_u32 s28, s28, s29
    s_add_u32 s28, s28, 5242880
    s_add_u32 s29, s28, 4096
    s_xor_b32 s82, s23, 1
    s_or_b32 s82, s82, s22
    s_cmp_lg_u32 s22, 0
    s_cbranch_scc1 L_slow_cw_34
    v_mov_b32 v10, s81
    v_mov_b32 v11, s72
    s_waitcnt vmcnt(0)
    s_mov_b64 exec, 1
    buffer_store_dwordx2 v[10:11], off, s[4:7], s80
    s_mov_b64 exec, -1
L_back_cw_35:
    s_and_b32 s68, s18, 1
    s_lshr_b32 s69, s18, 1
    s_lshl_b32 s70, s19, 1
    s_add_u32 s70, s70, s68
    s_mul_i32 s60, s70, 40960
    s_mul_i32 s71, s20, 5120
    s_add_u32 s60, s60, s71
    s_add_u32 s61, s60, 4096
    s_mul_i32 s62, s20, 160
    s_mul_i32 s52, s70, 98304
    s_mul_i32 s71, s69, 49152
    s_add_u32 s52, s52, s71
    s_add_u32 s52, s52, 5242880
    s_add_u32 s53, s52, 6144
    s_add_u32 s54, s52, 12288
    s_add_u32 s55, s52, 18432
    s_add_u32 s56, s52, 24576
    s_add_u32 s57, s52, 30720
    s_add_u32 s58, s52, 36864
    s_add_u32 s59, s52, 43008
    s_lshl_b32 s63, s70, 9
    s_lshl_b32 s71, s69, 6
    s_add_u32 s63, s63, s71
    s_add_u32 s63, s63, 32342272
    s_lshl_b32 s64, s70, 11
    s_lshr_b32 s71, s20, 1
    s_lshl_b32 s71, s71, 9
    s_add_u32 s64, s64, s71
    s_and_b32 s71, s20, 1
    s_lshl_b32 s71, s71, 3
    s_add_u32 s64, s64, s71
    s_lshl_b32 s66, s69, 8
    s_add_u32 s64, s64, s66
    s_add_u32 s64, s64, 11534336
    s_lshl_b32 s65, s20, 1
    s_add_u32 s65, s65, s69
    s_lshl_b32 s65, s65, 3
    s_lshl_b32 s71, s70, 9
    s_add_u32 s65, s65, s71
    s_add_u32 s65, s65, 32342144
    s_xor_b32 s67, s66, 256
    v_add_u32 v7, s66, v0
    v_add_u32 v8, s67, v0
    v_and_b32 v9, 7, v1
    v_lshlrev_b32 v9, 3, v9
    v_lshlrev_b32 v250, 3, v1
    s_mov_b64 exec, 0xffff
    s_mov_b32 s90, 0
L_poll_cw_36:
    buffer_load_dwordx2 v[10:11], v250, s[4:7], s27 offen sc1
    s_add_u32 s90, s90, 1
    s_cmp_gt_u32 s90, 200000
    s_cbranch_scc1 L_poll_cw_36_out
    s_waitcnt vmcnt(0)
    v_subrev_u32 v10, s87, v10
    v_xor_b32 v11, s72, v11
    v_or_b32 v11, v10, v11
    v_cmp_lt_u32 vcc, 7, v11
    s_cbranch_vccnz L_poll_cw_36
L_poll_cw_36_out:
    s_mov_b64 exec, -1
    ds_read_u8 v252, v248 offset:64
    buffer_load_dwordx4 v[80:83], v0, s[4:7], s40 offen offset:0 sc1
    buffer_load_dwordx4 v[84:87], v0, s[4:7], s40 offen offset:256 sc1
    buffer_load_dwordx4 v[88:91], v0, s[4:7], s40 offen offset:2048 sc1
    buffer_load_dwordx4 v[92:95], v0, s[4:7], s40 offen offset:2304 sc1
    buffer_load_dwordx4 v[232:235], v2, s[4:7], s26 offen offset:0 sc1
    buffer_load_dwordx4 v[236:239], v2, s[4:7], s26 offen offset:1024 sc1
    buffer_load_dwordx4 v[96:99], v0, s[4:7], s41 offen offset:0 sc1
    buffer_load_dwordx4 v[100:103], v0, s[4:7], s41 offen offset:256 sc1
    buffer_load_dwordx4 v[104:107], v0, s[4:7], s41 offen offset:2048 sc1
    buffer_load_dwordx4 v[108:111], v0, s[4:7], s41 offen offset:2304 sc1
    buffer_load_dwordx4 v[112:115], v0, s[4:7], s42 offen offset:0 sc1
    buffer_load_dwordx4 v[116:119], v0, s[4:7], s42 offen offset:256 sc1
    buffer_load_dwordx4 v[120:123], v0, s[4:7], s42 offen offset:2048 sc1
    buffer_load_dwordx4 v[124:127], v0, s[4:7], s42 offen offset:2304 sc1
    buffer_load_dwordx4 v[128:131], v0, s[4:7], s43 offen offset:0 sc1
    buffer_load_dwordx4 v[132:135], v0, s[4:7], s43 offen offset:256 sc1
    s_waitcnt lgkmcnt(0)
    v_cmp_gt_u32 vcc, 17, v252
    s_cbranch_vccnz L_1_c0
L_1_c0_b:
    ds_read_b128 v[20:23], v2 offset:34176
    ds_read_b128 v[24:27], v2 offset:35200
    ds_read_b128 v[28:31], v2 offset:36224
    ds_read_b128 v[32:35], v2 offset:37248
    ds_read_b128 v[36:39], v2 offset:38272
    ds_read_b128 v[40:43], v2 offset:39296
    s_waitcnt vmcnt(14) lgkmcnt(4)
    v_mfma_f32_16x16x32_bf16 v[48:51], v[20:23], v[80:83], 0
    ds_read_b128 v[44:47], v2 offset:40320
    v_mfma_f32_16x16x32_bf16 v[52:55], v[20:23], v[84:87], 0
    ds_read_u8 v252, v248 offset:64
    buffer_load_dwordx4 v[136:139], v0, s[4:7], s43 offen offset:2048 sc1
    v_mfma_f32_16x16x32_bf16 v[56:59], v[24:27], v[80:83], 0
    ds_read_b128 v[20:23], v2 offset:41344
    v_mfma_f32_16x16x32_bf16 v[60:63], v[24:27], v[84:87], 0
    s_waitcnt lgkmcnt(5)
    v_mfma_f32_16x16x32_bf16 v[64:67], v[28:31], v[80:83], 0
    ds_read_b128 v[24:27], v2 offset:42368
    v_mfma_f32_16x16x32_bf16 v[68:71], v[28:31], v[84:87], 0
    buffer_load_dwordx4 v[140:143], v0, s[4:7], s43 offen offset:2304 sc1
    v_mfma_f32_16x16x32_bf16 v[72:75], v[32:35], v[80:83], 0
    ds_read_b128 v[28:31], v2 offset:43392
    v_mfma_f32_16x16x32_bf16 v[76:79], v[32:35], v[84:87], 0
    s_waitcnt vmcnt(14) lgkmcnt(5)
    v_mfma_f32_16x16x32_bf16 v[48:51], v[36:39], v[88:91], v[48:51]
    ds_read_b128 v[32:35], v2 offset:44416
    v_mfma_f32_16x16x32_bf16 v[52:55], v[36:39], v[92:95], v[52:55]
    buffer_load_dwordx4 v[144:147], v0, s[4:7], s44 offen offset:0 sc1
    v_mfma_f32_16x16x32_bf16 v[56:59], v[40:43], v[88:91], v[56:59]
    ds_read_b128 v[36:39], v2 offset:45440
    v_mfma_f32_16x16x32_bf16 v[60:63], v[40:43], v[92:95], v[60:63]
    s_waitcnt lgkmcnt(5)
    v_cmp_gt_u32 vcc, 18, v252
    s_cbranch_vccnz L_g_cw_37
L_g_cw_37_b:
    s_waitcnt lgkmcnt(4)
    v_mfma_f32_16x16x32_bf16 v[64:67], v[44:47], v[88:91], v[64:67]
    ds_read_b128 v[40:43], v2 offset:46464
    v_mfma_f32_16x16x32_bf16 v[68:71], v[44:47], v[92:95], v[68:71]
    v_mov_b32 v251, 18
    buffer_load_dwordx4 v[148:151], v0, s[4:7], s44 offen offset:256 sc1
    v_mfma_f32_16x16x32_bf16 v[72:75], v[20:23], v[88:91], v[72:75]
    ds_read_b128 v[44:47], v2 offset:47488
    v_mfma_f32_16x16x32_bf16 v[76:79], v[20:23], v[92:95], v[76:79]
    ds_write_b8 v249, v251 offset:68
    s_waitcnt vmcnt(12) lgkmcnt(5)
    v_mfma_f32_16x16x32_bf16 v[48:51], v[24:27], v[96:99], v[48:51]
    ds_read_b128 v[20:23], v2 offset:48512
    v_mfma_f32_16x16x32_bf16 v[52:55], v[24:27], v[100:103], v[52:55]
    buffer_load_dwordx4 v[152:155], v0, s[4:7], s44 offen offset:2048 sc1
    v_mfma_f32_16x16x32_bf16 v[56:59], v[28:31], v[96:99], v[56:59]
    ds_read_b128 v[24:27], v2 offset:49536
    v_mfma_f32_16x16x32_bf16 v[60:63], v[28:31], v[100:103], v[60:63]
    s_waitcnt lgkmcnt(5)
    v_mfma_f32_16x16x32_bf16 v[64:67], v[32:35], v[96:99], v[64:67]
    ds_read_b128 v[28:31], v2 offset:50560
    v_mfma_f32_16x16x32_bf16 v[68:71], v[32:35], v[100:103], v[68:71]
    buffer_load_dwordx4 v[156:159], v0, s[4:7], s44 offen offset:2304 sc1
    v_mfma_f32_16x16x32_bf16 v[72:75], v[36:39], v[96:99], v[72:75]
    ds_read_b128 v[32:35], v2 offset:51584
    v_mfma_f32_16x16x32_bf16 v[76:79], v[36:39], v[100:103], v[76:79]
    s_waitcnt vmcnt(12) lgkmcnt(5)
    v_mfma_f32_16x16x32_bf16 v[48:51], v[40:43], v[104:107], v[48:51]
    ds_read_b128 v[36:39], v2 offset:52608
    v_mfma_f32_16x16x32_bf16 v[52:55], v[40:43], v[108:111], v[52:55]
    ds_read_u8 v252, v248 offset:64
    buffer_load_dwordx4 v[160:163], v0, s[4:7], s45 offen offset:0 sc1
    v_mfma_f32_16x16x32_bf16 v[56:59], v[44:47], v[104:107], v[56:59]
    ds_read_b128 v[40:43], v2 offset:53632
    v_mfma_f32_16x16x32_bf16 v[60:63], v[44:47], v[108:111], v[60:63]
    s_waitcnt lgkmcnt(5)
    v_mfma_f32_16x16x32_bf16 v[64:67], v[20:23], v[104:107], v[64:67]
    ds_read_b128 v[44:47], v2 offset:54656
    v_mfma_f32_16x16x32_bf16 v[68:71], v[20:23], v[108:111], v[68:71]
    buffer_load_dwordx4 v[164:167], v0, s[4:7], s45 offen offset:256 sc1
    v_mfma_f32_16x16x32_bf16 v[72:75], v[24:27], v[104:107], v[72:75]
    ds_read_b128 v[20:23], v2 offset:55680
    v_mfma_f32_16x16x32_bf16 v[76:79], v[24:27], v[108:111], v[76:79]
    s_waitcnt vmcnt(12) lgkmcnt(5)
    v_mfma_f32_16x16x32_bf16 v[48:51], v[28:31], v[112:115], v[48:51]
    ds_read_b128 v[24:27], v2 offset:56704
    v_mfma_f32_16x16x32_bf16 v[52:55], v[28:31], v[116:119], v[52:55]
    buffer_load_dwordx4 v[168:171], v0, s[4:7], s45 offen offset:2048 sc1
    s_waitcnt vmcnt(19)
    v_mfma_f32_16x16x32_bf16 v[56:59], v[32:35], v[112:115], v[56:59]
    ds_read_b128 v[28:31], v2 offset:57728
    v_mfma_f32_16x16x32_bf16 v[60:63], v[32:35], v[116:119], v[60:63]
    s_waitcnt lgkmcnt(5)
    v_cmp_gt_u32 vcc, 19, v252
    s_cbranch_vccnz L_g_cw_38
L_g_cw_38_b:
    v_pk_add_f32 v[232:233], v[232:233], v[234:235]
    s_waitcnt lgkmcnt(4)
    v_mfma_f32_16x16x32_bf16 v[64:67], v[36:39], v[112:115], v[64:67]
    ds_read_b128 v[32:35], v2 offset:20480
    v_mfma_f32_16x16x32_bf16 v[68:71], v[36:39], v[116:119], v[68:71]
    v_mov_b32 v251, 19
    buffer_load_dwordx4 v[172:175], v0, s[4:7], s45 offen offset:2304 sc1
    v_pk_add_f32 v[236:237], v[236:237], v[238:239]
    v_mfma_f32_16x16x32_bf16 v[72:75], v[40:43], v[112:115], v[72:75]
    ds_read_b128 v[36:39], v2 offset:21504
    v_mfma_f32_16x16x32_bf16 v[76:79], v[40:43], v[116:119], v[76:79]
    ds_write_b8 v249, v251 offset:68
    v_pk_add_f32 v[234:235], v[232:233], v[236:237]
    s_waitcnt vmcnt(12) lgkmcnt(5)
    v_mfma_f32_16x16x32_bf16 v[48:51], v[44:47], v[120:123], v[48:51]
    ds_read_b128 v[40:43], v2 offset:22528
    v_mfma_f32_16x16x32_bf16 v[52:55], v[44:47], v[124:127], v[52:55]
    buffer_load_dwordx4 v[176:179], v0, s[4:7], s46 offen offset:0 sc1
    v_pk_add_f32 v[232:233], v[232:233], v[236:237]
    v_mfma_f32_16x16x32_bf16 v[56:59], v[20:23], v[120:123], v[56:59]
    ds_read_b128 v[44:47], v2 offset:23552
    v_mfma_f32_16x16x32_bf16 v[60:63], v[20:23], v[124:127], v[60:63]
    v_permlane32_swap_b32 v232, v234
    s_waitcnt lgkmcnt(5)
    v_mfma_f32_16x16x32_bf16 v[64:67], v[24:27], v[120:123], v[64:67]
    ds_read_b128 v[20:23], v2 offset:24576
    v_mfma_f32_16x16x32_bf16 v[68:71], v[24:27], v[124:127], v[68:71]
    buffer_load_dwordx4 v[180:183], v0, s[4:7], s46 offen offset:256 sc1
    v_permlane32_swap_b32 v233, v235
    v_mfma_f32_16x16x32_bf16 v[72:75], v[28:31], v[120:123], v[72:75]
    ds_read_b128 v[24:27], v2 offset:25600
    v_mfma_f32_16x16x32_bf16 v[76:79], v[28:31], v[124:127], v[76:79]
    v_pk_add_f32 v[232:233], v[232:233], v[234:235]
    s_waitcnt vmcnt(12) lgkmcnt(5)
    v_mfma_f32_16x16x32_bf16 v[48:51], v[32:35], v[128:131], v[48:51]
    ds_read_b128 v[28:31], v2 offset:26624
    v_mfma_f32_16x16x32_bf16 v[52:55], v[32:35], v[132:135], v[52:55]
    ds_read_u8 v252, v248 offset:64
    buffer_load_dwordx4 v[184:187], v0, s[4:7], s46 offen offset:2048 sc1
    v_mul_f32 v232, 0xbacccccd, v232
    v_mfma_f32_16x16x32_bf16 v[56:59], v[36:39], v[128:131], v[56:59]
    ds_read_b128 v[32:35], v2 offset:27648
    v_mfma_f32_16x16x32_bf16 v[60:63], v[36:39], v[132:135], v[60:63]
    v_mul_f32 v233, 0x3acccccd, v233
    s_waitcnt lgkmcnt(5)
    v_mfma_f32_16x16x32_bf16 v[64:67], v[40:43], v[128:131], v[64:67]
    ds_read_b128 v[36:39], v2 offset:28672
    v_mfma_f32_16x16x32_bf16 v[68:71], v[40:43], v[132:135], v[68:71]
    buffer_load_dwordx4 v[188:191], v0, s[4:7], s46 offen offset:2304 sc1
    v_fma_f32 v233, -v232, v232, v233
    v_mfma_f32_16x16x32_bf16 v[72:75], v[44:47], v[128:131], v[72:75]
    ds_read_b128 v[40:43], v2 offset:29696
    v_mfma_f32_16x16x32_bf16 v[76:79], v[44:47], v[132:135], v[76:79]
    v_max_f32 v233, 0, v233
    s_waitcnt vmcnt(12) lgkmcnt(5)
    v_mfma_f32_16x16x32_bf16 v[48:51], v[20:23], v[136:139], v[48:51]
    ds_read_b128 v[44:47], v2 offset:30720
    v_mfma_f32_16x16x32_bf16 v[52:55], v[20:23], v[140:143], v[52:55]
    buffer_load_dwordx4 v[192:195], v0, s[4:7], s47 offen offset:0 sc1
    v_add_f32 v233, 0x3727c5ac, v233
    v_mfma_f32_16x16x32_bf16 v[56:59], v[24:27], v[136:139], v[56:59]
    ds_read_b128 v[20:23], v2 offset:31744
    v_mfma_f32_16x16x32_bf16 v[60:63], v[24:27], v[140:143], v[60:63]
    s_waitcnt lgkmcnt(5)
    v_cmp_gt_u32 vcc, 20, v252
    s_cbranch_vccnz L_g_cw_39
L_g_cw_39_b:
    v_rsq_f32 v242, v233
    s_waitcnt lgkmcnt(4)
    v_mfma_f32_16x16x32_bf16 v[64:67], v[28:31], v[136:139], v[64:67]
    ds_read_b128 v[24:27], v4 offset:10112
    v_mfma_f32_16x16x32_bf16 v[68:71], v[28:31], v[140:143], v[68:71]
    v_mov_b32 v251, 20
    buffer_load_dwordx4 v[196:199], v0, s[4:7], s47 offen offset:256 sc1
    v_cvt_pk_bf16_f32 v236, v232, v232
    v_mfma_f32_16x16x32_bf16 v[72:75], v[32:35], v[136:139], v[72:75]
    ds_read_b128 v[28:31], v4 offset:11136
    v_mfma_f32_16x16x32_bf16 v[76:79], v[32:35], v[140:143], v[76:79]
    ds_write_b8 v249, v251 offset:68
    v_mul_f32 v233, v233, v242
    s_waitcnt vmcnt(12) lgkmcnt(5)
    v_mfma_f32_16x16x32_bf16 v[48:51], v[36:39], v[144:147], v[48:51]
    ds_read_b128 v[32:35], v4 offset:12160
    v_mfma_f32_16x16x32_bf16 v[52:55], v[36:39], v[148:151], v[52:55]
    buffer_load_dwordx4 v[200:203], v0, s[4:7], s47 offen offset:2048 sc1
    v_mov_b32 v243, v242
    v_mfma_f32_16x16x32_bf16 v[56:59], v[40:43], v[144:147], v[56:59]
    ds_read_b128 v[36:39], v4 offset:13184
    v_mfma_f32_16x16x32_bf16 v[60:63], v[40:43], v[148:151], v[60:63]
    v_and_b32 v234, 0xffff0000, v236
    s_waitcnt lgkmcnt(5)
    v_mfma_f32_16x16x32_bf16 v[64:67], v[44:47], v[144:147], v[64:67]
    ds_read_b128 v[40:43], v4 offset:14208
    v_mfma_f32_16x16x32_bf16 v[68:71], v[44:47], v[148:151], v[68:71]
    buffer_load_dwordx4 v[204:207], v0, s[4:7], s47 offen offset:2304 sc1
    v_permlane16_swap_b32 v242, v243
    v_mfma_f32_16x16x32_bf16 v[72:75], v[20:23], v[144:147], v[72:75]
    ds_read_b128 v[44:47], v4 offset:15232
    v_mfma_f32_16x16x32_bf16 v[76:79], v[20:23], v[148:151], v[76:79]
    v_sub_f32 v234, v232, v234
    s_waitcnt vmcnt(12) lgkmcnt(5)
    v_mfma_f32_16x16x32_bf16 v[48:51], v[24:27], v[152:155], v[48:51]
    ds_read_b128 v[20:23], v4 offset:16256
    v_mfma_f32_16x16x32_bf16 v[52:55], v[24:27], v[156:159], v[52:55]
    ds_read_u8 v252, v248 offset:64
    buffer_load_dwordx4 v[208:211], v0, s[4:7], s48 offen offset:0 sc1
    v_cvt_pk_bf16_f32 v237, v234, v233
    v_mfma_f32_16x16x32_bf16 v[56:59], v[28:31], v[152:155], v[56:59]
    ds_read_b128 v[24:27], v4 offset:17280
    v_mfma_f32_16x16x32_bf16 v[60:63], v[28:31], v[156:159], v[60:63]
    v_and_b32 v235, 0xffff0000, v237
    s_waitcnt lgkmcnt(5)
    v_mfma_f32_16x16x32_bf16 v[64:67], v[32:35], v[152:155], v[64:67]
    ds_read_b128 v[28:31], v4 offset:18304
    v_mfma_f32_16x16x32_bf16 v[68:71], v[32:35], v[156:159], v[68:71]
    buffer_load_dwordx4 v[212:215], v0, s[4:7], s48 offen offset:256 sc1
    v_sub_f32 v235, v233, v235
    v_mfma_f32_16x16x32_bf16 v[72:75], v[36:39], v[152:155], v[72:75]
    ds_read_b128 v[32:35], v4 offset:19328
    v_mfma_f32_16x16x32_bf16 v[76:79], v[36:39], v[156:159], v[76:79]
    v_lshrrev_b32 v238, 16, v235
    s_waitcnt vmcnt(12) lgkmcnt(5)
    v_mfma_f32_16x16x32_bf16 v[48:51], v[40:43], v[160:163], v[48:51]
    ds_read_b128 v[36:39], v4 offset:20352
    v_mfma_f32_16x16x32_bf16 v[52:55], v[40:43], v[164:167], v[52:55]
    buffer_load_dwordx4 v[216:219], v0, s[4:7], s48 offen offset:2048 sc1
    v_cndmask_b32 v12, 0, v236, s[36:37]
    v_mfma_f32_16x16x32_bf16 v[56:59], v[44:47], v[160:163], v[56:59]
    ds_read_b128 v[40:43], v4 offset:21376
    v_mfma_f32_16x16x32_bf16 v[60:63], v[44:47], v[164:167], v[60:63]
    s_waitcnt lgkmcnt(5)
    v_cmp_gt_u32 vcc, 21, v252
    s_cbranch_vccnz L_g_cw_40
L_g_cw_40_b:
    v_cndmask_b32 v13, 0, v237, s[36:37]
    s_waitcnt lgkmcnt(4)
    v_mfma_f32_16x16x32_bf16 v[64:67], v[20:23], v[160:163], v[64:67]
    ds_read_b128 v[44:47], v4 offset:22400
    v_mfma_f32_16x16x32_bf16 v[68:71], v[20:23], v[164:167], v[68:71]
    v_mov_b32 v251, 21
    buffer_load_dwordx4 v[220:223], v0, s[4:7], s48 offen offset:2304 sc1
    v_cndmask_b32 v14, 0, v238, s[36:37]
    v_mfma_f32_16x16x32_bf16 v[72:75], v[24:27], v[160:163], v[72:75]
    ds_read_b128 v[20:23], v4 offset:23424
    v_mfma_f32_16x16x32_bf16 v[76:79], v[24:27], v[164:167], v[76:79]
    ds_write_b8 v249, v251 offset:68
    v_mov_b32 v15, 0
    s_waitcnt vmcnt(12) lgkmcnt(5)
    v_mfma_f32_16x16x32_bf16 v[48:51], v[28:31], v[168:171], v[48:51]
    ds_read_b128 v[24:27], v4 offset:24448
    v_mfma_f32_16x16x32_bf16 v[52:55], v[28:31], v[172:175], v[52:55]
    buffer_load_dwordx4 v[224:227], v0, s[4:7], s49 offen offset:0 sc1
    v_cndmask_b32 v16, 0, v236, s[34:35]
    v_mfma_f32_16x16x32_bf16 v[56:59], v[32:35], v[168:171], v[56:59]
    ds_read_b128 v[28:31], v4 offset:25472
    v_mfma_f32_16x16x32_bf16 v[60:63], v[32:35], v[172:175], v[60:63]
    v_cndmask_b32 v17, 0, v237, s[34:35]
    s_waitcnt lgkmcnt(5)
    v_mfma_f32_16x16x32_bf16 v[64:67], v[36:39], v[168:171], v[64:67]
    ds_read_b128 v[32:35], v4 offset:26496
    v_mfma_f32_16x16x32_bf16 v[68:71], v[36:39], v[172:175], v[68:71]
    buffer_load_dwordx4 v[228:231], v0, s[4:7], s49 offen offset:256 sc1
    v_cndmask_b32 v18, 0, v238, s[34:35]
    v_mfma_f32_16x16x32_bf16 v[72:75], v[40:43], v[168:171], v[72:75]
    ds_read_b128 v[36:39], v4 offset:27520
    v_mfma_f32_16x16x32_bf16 v[76:79], v[40:43], v[172:175], v[76:79]
    v_mov_b32 v19, 0
    s_waitcnt vmcnt(12) lgkmcnt(5)
    v_mfma_f32_16x16x32_bf16 v[48:51], v[44:47], v[176:179], v[48:51]
    ds_read_b128 v[40:43], v4 offset:28544
    v_mfma_f32_16x16x32_bf16 v[52:55], v[44:47], v[180:183], v[52:55]
    ds_read_u8 v252, v248 offset:64
    v_mfma_f32_16x16x32_bf16 v[56:59], v[20:23], v[176:179], v[56:59]
    ds_read_b128 v[44:47], v4 offset:29568
    v_mfma_f32_16x16x32_bf16 v[60:63], v[20:23], v[180:183], v[60:63]
    s_waitcnt lgkmcnt(5)
    v_mfma_f32_16x16x32_bf16 v[64:67], v[24:27], v[176:179], v[64:67]
    ds_read_b128 v[20:23], v4 offset:30592
    v_mfma_f32_16x16x32_bf16 v[68:71], v[24:27], v[180:183], v[68:71]
    v_mfma_f32_16x16x32_bf16 v[72:75], v[28:31], v[176:179], v[72:75]
    ds_read_b128 v[24:27], v4 offset:31616
    v_mfma_f32_16x16x32_bf16 v[76:79], v[28:31], v[180:183], v[76:79]
    s_waitcnt vmcnt(10) lgkmcnt(5)
    v_mfma_f32_16x16x32_bf16 v[48:51], v[32:35], v[184:187], v[48:51]
    ds_read_b128 v[28:31], v4 offset:32640
    v_mfma_f32_16x16x32_bf16 v[52:55], v[32:35], v[188:191], v[52:55]
    v_mfma_f32_16x16x32_bf16 v[56:59], v[36:39], v[184:187], v[56:59]
    ds_read_b128 v[32:35], v4 offset:33664
    v_mfma_f32_16x16x32_bf16 v[60:63], v[36:39], v[188:191], v[60:63]
    s_waitcnt lgkmcnt(5)
    v_cmp_gt_u32 vcc, 22, v252
    s_cbranch_vccnz L_g_cw_41
L_g_cw_41_b:
    s_waitcnt lgkmcnt(4)
    v_mfma_f32_16x16x32_bf16 v[64:67], v[40:43], v[184:187], v[64:67]
    ds_read_b128 v[36:39], v4 offset:34688
    v_mfma_f32_16x16x32_bf16 v[68:71], v[40:43], v[188:191], v[68:71]
    v_mov_b32 v251, 22
    v_mfma_f32_16x16x32_bf16 v[72:75], v[44:47], v[184:187], v[72:75]
    ds_read_b128 v[40:43], v4 offset:35712
    v_mfma_f32_16x16x32_bf16 v[76:79], v[44:47], v[188:191], v[76:79]
    ds_write_b8 v249, v251 offset:68
    s_waitcnt vmcnt(8) lgkmcnt(5)
    v_mfma_f32_16x16x32_bf16 v[48:51], v[20:23], v[192:195], v[48:51]
    ds_read_b128 v[44:47], v4 offset:36736
    v_mfma_f32_16x16x32_bf16 v[52:55], v[20:23], v[196:199], v[52:55]
    v_mfma_f32_16x16x32_bf16 v[56:59], v[24:27], v[192:195], v[56:59]
    ds_read_b128 v[20:23], v4 offset:37760
    v_mfma_f32_16x16x32_bf16 v[60:63], v[24:27], v[196:199], v[60:63]
    s_waitcnt lgkmcnt(5)
    v_mfma_f32_16x16x32_bf16 v[64:67], v[28:31], v[192:195], v[64:67]
    ds_read_b128 v[24:27], v4 offset:38784
    v_mfma_f32_16x16x32_bf16 v[68:71], v[28:31], v[196:199], v[68:71]
    v_mfma_f32_16x16x32_bf16 v[72:75], v[32:35], v[192:195], v[72:75]
    ds_read_b128 v[28:31], v4 offset:39808
    v_mfma_f32_16x16x32_bf16 v[76:79], v[32:35], v[196:199], v[76:79]
    s_waitcnt vmcnt(6) lgkmcnt(5)
    v_mfma_f32_16x16x32_bf16 v[48:51], v[36:39], v[200:203], v[48:51]
    ds_read_b128 v[32:35], v4 offset:40832
    v_mfma_f32_16x16x32_bf16 v[52:55], v[36:39], v[204:207], v[52:55]
    ds_read_u8 v252, v248 offset:64
    buffer_load_dwordx4 v[232:235], v0, s[4:7], s49 offen offset:2048 sc1
    v_mfma_f32_16x16x32_bf16 v[56:59], v[40:43], v[200:203], v[56:59]
    ds_read_b128 v[36:39], v4 offset:41856
    v_mfma_f32_16x16x32_bf16 v[60:63], v[40:43], v[204:207], v[60:63]
    s_waitcnt lgkmcnt(5)
    v_mfma_f32_16x16x32_bf16 v[64:67], v[44:47], v[200:203], v[64:67]
    ds_read_b128 v[40:43], v4 offset:42880
    v_mfma_f32_16x16x32_bf16 v[68:71], v[44:47], v[204:207], v[68:71]
    buffer_load_dwordx4 v[236:239], v0, s[4:7], s49 offen offset:2304 sc1
    v_mfma_f32_16x16x32_bf16 v[72:75], v[20:23], v[200:203], v[72:75]
    ds_read_b128 v[44:47], v4 offset:43904
    v_mfma_f32_16x16x32_bf16 v[76:79], v[20:23], v[204:207], v[76:79]
    s_waitcnt vmcnt(6) lgkmcnt(5)
    v_mfma_f32_16x16x32_bf16 v[48:51], v[24:27], v[208:211], v[48:51]
    ds_read_b128 v[20:23], v4 offset:44928
    v_mfma_f32_16x16x32_bf16 v[52:55], v[24:27], v[212:215], v[52:55]
    v_mfma_f32_16x16x32_bf16 v[56:59], v[28:31], v[208:211], v[56:59]
    ds_read_b128 v[24:27], v4 offset:45952
    v_mfma_f32_16x16x32_bf16 v[60:63], v[28:31], v[212:215], v[60:63]
    s_waitcnt lgkmcnt(5)
    v_cmp_gt_u32 vcc, 23, v252
    s_cbranch_vccnz L_g_cw_42
L_g_cw_42_b:
    s_waitcnt lgkmcnt(4)
    v_mfma_f32_16x16x32_bf16 v[64:67], v[32:35], v[208:211], v[64:67]
    ds_read_b128 v[28:31], v4 offset:46976
    v_mfma_f32_16x16x32_bf16 v[68:71], v[32:35], v[212:215], v[68:71]
    v_mov_b32 v251, 23
    v_mfma_f32_16x16x32_bf16 v[72:75], v[36:39], v[208:211], v[72:75]
    ds_read_b128 v[32:35], v4 offset:48000
    v_mfma_f32_16x16x32_bf16 v[76:79], v[36:39], v[212:215], v[76:79]
    ds_write_b8 v249, v251 offset:68
    s_waitcnt vmcnt(4) lgkmcnt(5)
    v_mfma_f32_16x16x32_bf16 v[48:51], v[40:43], v[216:219], v[48:51]
    ds_read_b128 v[36:39], v4 offset:49024
    v_mfma_f32_16x16x32_bf16 v[52:55], v[40:43], v[220:223], v[52:55]
    v_mfma_f32_16x16x32_bf16 v[56:59], v[44:47], v[216:219], v[56:59]
    ds_read_b128 v[40:43], v4 offset:50048
    v_mfma_f32_16x16x32_bf16 v[60:63], v[44:47], v[220:223], v[60:63]
    s_waitcnt lgkmcnt(5)
    v_mfma_f32_16x16x32_bf16 v[64:67], v[20:23], v[216:219], v[64:67]
    ds_read_b128 v[44:47], v4 offset:51072
    v_mfma_f32_16x16x32_bf16 v[68:71], v[20:23], v[220:223], v[68:71]
    v_mfma_f32_16x16x32_bf16 v[72:75], v[24:27], v[216:219], v[72:75]
    ds_read_b128 v[20:23], v4 offset:52096
    v_mfma_f32_16x16x32_bf16 v[76:79], v[24:27], v[220:223], v[76:79]
    s_waitcnt vmcnt(2) lgkmcnt(5)
    v_mfma_f32_16x16x32_bf16 v[48:51], v[28:31], v[224:227], v[48:51]
    ds_read_b128 v[24:27], v4 offset:53120
    v_mfma_f32_16x16x32_bf16 v[52:55], v[28:31], v[228:231], v[52:55]
    v_mfma_f32_16x16x32_bf16 v[56:59], v[32:35], v[224:227], v[56:59]
    ds_read_b128 v[28:31], v4 offset:54144
    v_mfma_f32_16x16x32_bf16 v[60:63], v[32:35], v[228:231], v[60:63]
    s_waitcnt lgkmcnt(4)
    v_mfma_f32_16x16x32_bf16 v[64:67], v[36:39], v[224:227], v[64:67]
    ds_read_b128 v[32:35], v6 offset:0
    v_mfma_f32_16x16x32_bf16 v[68:71], v[36:39], v[228:231], v[68:71]
    v_mfma_f32_16x16x32_bf16 v[72:75], v[40:43], v[224:227], v[72:75]
    ds_read_b128 v[36:39], v6 offset:256
    v_mfma_f32_16x16x32_bf16 v[76:79], v[40:43], v[228:231], v[76:79]
    s_waitcnt vmcnt(0) lgkmcnt(4)
    v_mfma_f32_16x16x32_bf16 v[48:51], v[44:47], v[232:235], v[48:51]
    ds_read_b128 v[40:43], v6 offset:512
    v_mfma_f32_16x16x32_bf16 v[52:55], v[44:47], v[236:239], v[52:55]
    ds_read_u8 v252, v248 offset:64
    v_mfma_f32_16x16x32_bf16 v[56:59], v[20:23], v[232:235], v[56:59]
    ds_read_b128 v[44:47], v6 offset:768
    v_mfma_f32_16x16x32_bf16 v[60:63], v[20:23], v[236:239], v[60:63]
    s_waitcnt lgkmcnt(5)
    v_mfma_f32_16x16x32_bf16 v[64:67], v[24:27], v[232:235], v[64:67]
    ds_read_b128 v[20:23], v4 offset:55168
    v_mfma_f32_16x16x32_bf16 v[68:71], v[24:27], v[236:239], v[68:71]
    v_mfma_f32_16x16x32_bf16 v[72:75], v[28:31], v[232:235], v[72:75]
    ds_read_b128 v[24:27], v4 offset:56192
    v_mfma_f32_16x16x32_bf16 v[76:79], v[28:31], v[236:239], v[76:79]
    s_waitcnt lgkmcnt(5)
    v_mfma_f32_16x16x32_bf16 v[48:51], v[32:35], v[12:15], v[48:51]
    ds_read_b128 v[28:31], v4 offset:57216
    v_mfma_f32_16x16x32_bf16 v[52:55], v[32:35], v[16:19], v[52:55]
    v_mfma_f32_16x16x32_bf16 v[56:59], v[36:39], v[12:15], v[56:59]
    ds_read_b128 v[32:35], v4 offset:58240
    v_mfma_f32_16x16x32_bf16 v[60:63], v[36:39], v[16:19], v[60:63]
    s_waitcnt lgkmcnt(5)
    v_cmp_gt_u32 vcc, 24, v252
    s_cbranch_vccnz L_g_cw_43
L_g_cw_43_b:
    s_waitcnt lgkmcnt(4)
    v_mfma_f32_16x16x32_bf16 v[64:67], v[40:43], v[12:15], v[64:67]
    ds_read_b128 v[36:39], v4 offset:59264
    v_mfma_f32_16x16x32_bf16 v[68:71], v[40:43], v[16:19], v[68:71]
    v_mov_b32 v251, 24
    v_mfma_f32_16x16x32_bf16 v[72:75], v[44:47], v[12:15], v[72:75]
    ds_read_b128 v[40:43], v4 offset:60288
    v_mfma_f32_16x16x32_bf16 v[76:79], v[44:47], v[16:19], v[76:79]
    ds_write_b8 v249, v251 offset:68
    v_max_f32 v48, 0, v48
    v_max_f32 v49, 0, v49
    v_max_f32 v50, 0, v50
    v_max_f32 v51, 0, v51
    v_max_f32 v56, 0, v56
    v_max_f32 v57, 0, v57
    v_max_f32 v58, 0, v58
    v_max_f32 v59, 0, v59
    v_pk_mul_f32 v[48:49], v[48:49], v[242:243] op_sel_hi:[1,0]
    v_pk_mul_f32 v[50:51], v[50:51], v[242:243] op_sel_hi:[1,0]
    v_pk_mul_f32 v[56:57], v[56:57], v[242:243] op_sel_hi:[1,0]
    v_pk_mul_f32 v[58:59], v[58:59], v[242:243] op_sel_hi:[1,0]
    v_pk_mul_f32 v[48:49], v[48:49], v[48:49]
    v_pk_mul_f32 v[50:51], v[50:51], v[50:51]
    v_pk_mul_f32 v[56:57], v[56:57], v[56:57]
    v_pk_mul_f32 v[58:59], v[58:59], v[58:59]
    v_cvt_pk_bf16_f32 v48, v48, v49
    v_cvt_pk_bf16_f32 v49, v50, v51
    v_cvt_pk_bf16_f32 v50, v56, v57
    v_cvt_pk_bf16_f32 v51, v58, v59
    s_cmp_lg_u32 s82, 0
    s_cbranch_scc1 L_slow_cw_44
    buffer_store_dwordx4 v[48:51], v0, s[4:7], s28 offen offset:0
L_back_cw_45:
    v_max_f32 v52, 0, v52
    v_max_f32 v53, 0, v53
    v_max_f32 v54, 0, v54
    v_max_f32 v55, 0, v55
    v_max_f32 v60, 0, v60
    v_max_f32 v61, 0, v61
    v_max_f32 v62, 0, v62
    v_max_f32 v63, 0, v63
    v_pk_mul_f32 v[52:53], v[52:53], v[242:243] op_sel:[0,1] op_sel_hi:[1,1]
    v_pk_mul_f32 v[54:55], v[54:55], v[242:243] op_sel:[0,1] op_sel_hi:[1,1]
    v_pk_mul_f32 v[60:61], v[60:61], v[242:243] op_sel:[0,1] op_sel_hi:[1,1]
    v_pk_mul_f32 v[62:63], v[62:63], v[242:243] op_sel:[0,1] op_sel_hi:[1,1]
    v_pk_mul_f32 v[52:53], v[52:53], v[52:53]
    v_pk_mul_f32 v[54:55], v[54:55], v[54:55]
    v_pk_mul_f32 v[60:61], v[60:61], v[60:61]
    v_pk_mul_f32 v[62:63], v[62:63], v[62:63]
    v_cvt_pk_bf16_f32 v52, v52, v53
    v_cvt_pk_bf16_f32 v53, v54, v55
    v_cvt_pk_bf16_f32 v54, v60, v61
    v_cvt_pk_bf16_f32 v55, v62, v63
    s_cmp_lg_u32 s82, 0
    s_cbranch_scc1 L_slow_cw_46
    buffer_store_dwordx4 v[52:55], v0, s[4:7], s28 offen offset:256
L_back_cw_47:
    v_max_f32 v64, 0, v64
    v_max_f32 v65, 0, v65
    v_max_f32 v66, 0, v66
    v_max_f32 v67, 0, v67
    v_max_f32 v72, 0, v72
    v_max_f32 v73, 0, v73
    v_max_f32 v74, 0, v74
    v_max_f32 v75, 0, v75
    v_pk_mul_f32 v[64:65], v[64:65], v[242:243] op_sel_hi:[1,0]
    v_pk_mul_f32 v[66:67], v[66:67], v[242:243] op_sel_hi:[1,0]
    v_pk_mul_f32 v[72:73], v[72:73], v[242:243] op_sel_hi:[1,0]
    v_pk_mul_f32 v[74:75], v[74:75], v[242:243] op_sel_hi:[1,0]
    v_pk_mul_f32 v[64:65], v[64:65], v[64:65]
    v_pk_mul_f32 v[66:67], v[66:67], v[66:67]
    v_pk_mul_f32 v[72:73], v[72:73], v[72:73]
    v_pk_mul_f32 v[74:75], v[74:75], v[74:75]
    v_cvt_pk_bf16_f32 v64, v64, v65
    v_cvt_pk_bf16_f32 v65, v66, v67
    v_cvt_pk_bf16_f32 v66, v72, v73
    v_cvt_pk_bf16_f32 v67, v74, v75
    s_cmp_lg_u32 s82, 0
    s_cbranch_scc1 L_slow_cw_48
    buffer_store_dwordx4 v[64:67], v0, s[4:7], s28 offen offset:2048
L_back_cw_49:
    v_max_f32 v68, 0, v68
    v_max_f32 v69, 0, v69
    v_max_f32 v70, 0, v70
    v_max_f32 v71, 0, v71
    v_max_f32 v76, 0, v76
    v_max_f32 v77, 0, v77
    v_max_f32 v78, 0, v78
    v_max_f32 v79, 0, v79
    v_pk_mul_f32 v[68:69], v[68:69], v[242:243] op_sel:[0,1] op_sel_hi:[1,1]
    v_pk_mul_f32 v[70:71], v[70:71], v[242:243] op_sel:[0,1] op_sel_hi:[1,1]
    v_pk_mul_f32 v[76:77], v[76:77], v[242:243] op_sel:[0,1] op_sel_hi:[1,1]
    v_pk_mul_f32 v[78:79], v[78:79], v[242:243] op_sel:[0,1] op_sel_hi:[1,1]
    v_pk_mul_f32 v[68:69], v[68:69], v[68:69]
    v_pk_mul_f32 v[70:71], v[70:71], v[70:71]
    v_pk_mul_f32 v[76:77], v[76:77], v[76:77]
    v_pk_mul_f32 v[78:79], v[78:79], v[78:79]
    v_cvt_pk_bf16_f32 v68, v68, v69
    v_cvt_pk_bf16_f32 v69, v70, v71
    v_cvt_pk_bf16_f32 v70, v76, v77
    v_cvt_pk_bf16_f32 v71, v78, v79
    s_cmp_lg_u32 s82, 0
    s_cbranch_scc1 L_slow_cw_50
    buffer_store_dwordx4 v[68:71], v0, s[4:7], s28 offen offset:2304
L_back_cw_51:
    s_waitcnt lgkmcnt(4)
    v_mfma_f32_16x16x32_bf16 v[56:59], v[20:23], v[80:83], 0
    ds_read_b128 v[44:47], v4 offset:61312
    v_mfma_f32_16x16x32_bf16 v[60:63], v[20:23], v[84:87], 0
    v_mfma_f32_16x16x32_bf16 v[72:75], v[24:27], v[80:83], 0
    ds_read_b128 v[20:23], v5 offset:896
    v_mfma_f32_16x16x32_bf16 v[76:79], v[24:27], v[84:87], 0
    v_mfma_f32_16x16x32_bf16 v[56:59], v[28:31], v[88:91], v[56:59]
    ds_read_b128 v[24:27], v5 offset:1920
    v_mfma_f32_16x16x32_bf16 v[60:63], v[28:31], v[92:95], v[60:63]
    s_waitcnt lgkmcnt(4)
    v_mfma_f32_16x16x32_bf16 v[72:75], v[32:35], v[88:91], v[72:75]
    ds_read_b128 v[28:31], v5 offset:2944
    v_mfma_f32_16x16x32_bf16 v[76:79], v[32:35], v[92:95], v[76:79]
    v_mfma_f32_16x16x32_bf16 v[56:59], v[36:39], v[96:99], v[56:59]
    ds_read_b128 v[32:35], v5 offset:3968
    v_mfma_f32_16x16x32_bf16 v[60:63], v[36:39], v[100:103], v[60:63]
    ds_read_u8 v252, v248 offset:64
    v_mfma_f32_16x16x32_bf16 v[72:75], v[40:43], v[96:99], v[72:75]
    ds_read_b128 v[36:39], v5 offset:4992
    v_mfma_f32_16x16x32_bf16 v[76:79], v[40:43], v[100:103], v[76:79]
    s_waitcnt lgkmcnt(4)
    v_mfma_f32_16x16x32_bf16 v[56:59], v[44:47], v[104:107], v[56:59]
    ds_read_b128 v[40:43], v5 offset:6016
    v_mfma_f32_16x16x32_bf16 v[60:63], v[44:47], v[108:111], v[60:63]
    v_mfma_f32_16x16x32_bf16 v[72:75], v[20:23], v[104:107], v[72:75]
    ds_read_b128 v[44:47], v5 offset:7040
    v_mfma_f32_16x16x32_bf16 v[76:79], v[20:23], v[108:111], v[76:79]
    v_mfma_f32_16x16x32_bf16 v[56:59], v[24:27], v[112:115], v[56:59]
    ds_read_b128 v[20:23], v5 offset:8064
    v_mfma_f32_16x16x32_bf16 v[60:63], v[24:27], v[116:119], v[60:63]
    s_waitcnt lgkmcnt(3)
    v_mfma_f32_16x16x32_bf16 v[72:75], v[28:31], v[112:115], v[72:75]
    ds_read_b128 v[24:27], v5 offset:9088
    v_mfma_f32_16x16x32_bf16 v[76:79], v[28:31], v[116:119], v[76:79]
    v_cmp_gt_u32 vcc, 25, v252
    s_cbranch_vccnz L_g_cw_52
L_g_cw_52_b:
    v_mfma_f32_16x16x32_bf16 v[56:59], v[32:35], v[120:123], v[56:59]
    ds_read_b128 v[28:31], v5 offset:10112
    v_mfma_f32_16x16x32_bf16 v[60:63], v[32:35], v[124:127], v[60:63]
    v_mov_b32 v251, 25
    v_mfma_f32_16x16x32_bf16 v[72:75], v[36:39], v[120:123], v[72:75]
    ds_read_b128 v[32:35], v5 offset:11136
    v_mfma_f32_16x16x32_bf16 v[76:79], v[36:39], v[124:127], v[76:79]
    ds_write_b8 v249, v251 offset:68
    s_waitcnt lgkmcnt(4)
    v_mfma_f32_16x16x32_bf16 v[56:59], v[40:43], v[128:131], v[56:59]
    ds_read_b128 v[36:39], v5 offset:12160
    v_mfma_f32_16x16x32_bf16 v[60:63], v[40:43], v[132:135], v[60:63]
    v_mfma_f32_16x16x32_bf16 v[72:75], v[44:47], v[128:131], v[72:75]
    ds_read_b128 v[40:43], v5 offset:13184
    v_mfma_f32_16x16x32_bf16 v[76:79], v[44:47], v[132:135], v[76:79]
    v_mfma_f32_16x16x32_bf16 v[56:59], v[20:23], v[136:139], v[56:59]
    ds_read_b128 v[44:47], v5 offset:14208
    v_mfma_f32_16x16x32_bf16 v[60:63], v[20:23], v[140:143], v[60:63]
    s_waitcnt lgkmcnt(4)
    v_mfma_f32_16x16x32_bf16 v[72:75], v[24:27], v[136:139], v[72:75]
    ds_read_b128 v[20:23], v5 offset:15232
    v_mfma_f32_16x16x32_bf16 v[76:79], v[24:27], v[140:143], v[76:79]
    v_mfma_f32_16x16x32_bf16 v[56:59], v[28:31], v[144:147], v[56:59]
    ds_read_b128 v[24:27], v5 offset:16256
    v_mfma_f32_16x16x32_bf16 v[60:63], v[28:31], v[148:151], v[60:63]
    ds_read_u8 v252, v248 offset:64
    s_cmp_lg_u32 s22, 0
    s_cbranch_scc1 L_slow_cw_53
    v_mov_b32 v10, s86
    v_mov_b32 v11, s72
    s_waitcnt vmcnt(0)
    s_mov_b64 exec, 1
    buffer_store_dwordx2 v[10:11], off, s[4:7], s30
    s_mov_b64 exec, -1
L_back_cw_54:
    v_mfma_f32_16x16x32_bf16 v[72:75], v[32:35], v[144:147], v[72:75]
    ds_read_b128 v[28:31], v5 offset:17280
    v_mfma_f32_16x16x32_bf16 v[76:79], v[32:35], v[148:151], v[76:79]
    s_waitcnt lgkmcnt(4)
    v_mfma_f32_16x16x32_bf16 v[56:59], v[36:39], v[152:155], v[56:59]
    ds_read_b128 v[32:35], v5 offset:18304
    v_mfma_f32_16x16x32_bf16 v[60:63], v[36:39], v[156:159], v[60:63]
    v_mfma_f32_16x16x32_bf16 v[72:75], v[40:43], v[152:155], v[72:75]
    ds_read_b128 v[36:39], v5 offset:19328
    v_mfma_f32_16x16x32_bf16 v[76:79], v[40:43], v[156:159], v[76:79]
    v_mfma_f32_16x16x32_bf16 v[56:59], v[44:47], v[160:163], v[56:59]
    ds_read_b128 v[40:43], v5 offset:20352
    v_mfma_f32_16x16x32_bf16 v[60:63], v[44:47], v[164:167], v[60:63]
    s_waitcnt lgkmcnt(3)
    v_mfma_f32_16x16x32_bf16 v[72:75], v[20:23], v[160:163], v[72:75]
    ds_read_b128 v[44:47], v5 offset:21376
    v_mfma_f32_16x16x32_bf16 v[76:79], v[20:23], v[164:167], v[76:79]
    v_cmp_gt_u32 vcc, 26, v252
    s_cbranch_vccnz L_g_cw_55
L_g_cw_55_b:
    v_mfma_f32_16x16x32_bf16 v[56:59], v[24:27], v[168:171], v[56:59]
    ds_read_b128 v[20:23], v5 offset:22400
    v_mfma_f32_16x16x32_bf16 v[60:63], v[24:27], v[172:175], v[60:63]
    v_mov_b32 v251, 26
    v_mfma_f32_16x16x32_bf16 v[72:75], v[28:31], v[168:171], v[72:75]
    ds_read_b128 v[24:27], v5 offset:23424
    v_mfma_f32_16x16x32_bf16 v[76:79], v[28:31], v[172:175], v[76:79]
    ds_write_b8 v249, v251 offset:68
    s_waitcnt lgkmcnt(4)
    v_mfma_f32_16x16x32_bf16 v[56:59], v[32:35], v[176:179], v[56:59]
    ds_read_b128 v[28:31], v5 offset:24448
    v_mfma_f32_16x16x32_bf16 v[60:63], v[32:35], v[180:183], v[60:63]
    v_mfma_f32_16x16x32_bf16 v[72:75], v[36:39], v[176:179], v[72:75]
    ds_read_b128 v[32:35], v5 offset:25472
    v_mfma_f32_16x16x32_bf16 v[76:79], v[36:39], v[180:183], v[76:79]
    v_mfma_f32_16x16x32_bf16 v[56:59], v[40:43], v[184:187], v[56:59]
    ds_read_b128 v[36:39], v5 offset:26496
    v_mfma_f32_16x16x32_bf16 v[60:63], v[40:43], v[188:191], v[60:63]
    s_waitcnt lgkmcnt(4)
    v_mfma_f32_16x16x32_bf16 v[72:75], v[44:47], v[184:187], v[72:75]
    ds_read_b128 v[40:43], v5 offset:27520
    v_mfma_f32_16x16x32_bf16 v[76:79], v[44:47], v[188:191], v[76:79]
    v_mfma_f32_16x16x32_bf16 v[56:59], v[20:23], v[192:195], v[56:59]
    ds_read_b128 v[44:47], v5 offset:28544
    v_mfma_f32_16x16x32_bf16 v[60:63], v[20:23], v[196:199], v[60:63]
    v_mfma_f32_16x16x32_bf16 v[72:75], v[24:27], v[192:195], v[72:75]
    ds_read_b128 v[20:23], v5 offset:29568
    v_mfma_f32_16x16x32_bf16 v[76:79], v[24:27], v[196:199], v[76:79]
    s_waitcnt lgkmcnt(3)
    v_mfma_f32_16x16x32_bf16 v[56:59], v[28:31], v[200:203], v[56:59]
    ds_read_b128 v[24:27], v5 offset:30592
    v_mfma_f32_16x16x32_bf16 v[60:63], v[28:31], v[204:207], v[60:63]
    v_mfma_f32_16x16x32_bf16 v[72:75], v[32:35], v[200:203], v[72:75]
    ds_read_b128 v[28:31], v5 offset:31616
    v_mfma_f32_16x16x32_bf16 v[76:79], v[32:35], v[204:207], v[76:79]
    v_mfma_f32_16x16x32_bf16 v[56:59], v[36:39], v[208:211], v[56:59]
    ds_read_b128 v[32:35], v5 offset:32640
    v_mfma_f32_16x16x32_bf16 v[60:63], v[36:39], v[212:215], v[60:63]
    s_waitcnt lgkmcnt(3)
    v_mfma_f32_16x16x32_bf16 v[72:75], v[40:43], v[208:211], v[72:75]
    ds_read_b128 v[36:39], v5 offset:33664
    v_mfma_f32_16x16x32_bf16 v[76:79], v[40:43], v[212:215], v[76:79]
    v_mfma_f32_16x16x32_bf16 v[56:59], v[44:47], v[216:219], v[56:59]
    ds_read_b128 v[40:43], v6 offset:1024
    v_mfma_f32_16x16x32_bf16 v[60:63], v[44:47], v[220:223], v[60:63]
    v_mfma_f32_16x16x32_bf16 v[72:75], v[20:23], v[216:219], v[72:75]
    ds_read_b128 v[44:47], v6 offset:1280
    v_mfma_f32_16x16x32_bf16 v[76:79], v[20:23], v[220:223], v[76:79]
    v_mov_b32 v251, 28
    s_waitcnt lgkmcnt(3)
    v_mfma_f32_16x16x32_bf16 v[56:59], v[24:27], v[224:227], v[56:59]
    v_mfma_f32_16x16x32_bf16 v[60:63], v[24:27], v[228:231], v[60:63]
    ds_write_b8 v249, v251 offset:68
    v_mfma_f32_16x16x32_bf16 v[72:75], v[28:31], v[224:227], v[72:75]
    v_mfma_f32_16x16x32_bf16 v[76:79], v[28:31], v[228:231], v[76:79]
    v_mfma_f32_16x16x32_bf16 v[56:59], v[32:35], v[232:235], v[56:59]
    v_mfma_f32_16x16x32_bf16 v[60:63], v[32:35], v[236:239], v[60:63]
    buffer_load_dwordx2 v[244:245], v9, s[4:7], s63 offen sc1
    s_waitcnt lgkmcnt(1)
    v_mfma_f32_16x16x32_bf16 v[72:75], v[36:39], v[232:235], v[72:75]
    v_mfma_f32_16x16x32_bf16 v[76:79], v[36:39], v[236:239], v[76:79]
    v_mfma_f32_16x16x32_bf16 v[56:59], v[40:43], v[12:15], v[56:59]
    v_mfma_f32_16x16x32_bf16 v[60:63], v[40:43], v[16:19], v[60:63]
    v_mfma_f32_16x16x32_bf16 v[72:75], v[44:47], v[12:15], v[72:75]
    v_mfma_f32_16x16x32_bf16 v[76:79], v[44:47], v[16:19], v[76:79]
    s_mul_i32 s71, s69, 5120
    v_add_u32 v4, s71, v2
    v_add_u32 v5, 0xf000, v4
    v_add_u32 v6, 0x1e000, v4
    s_nop 3
    v_max_f32 v56, 0, v56
    v_max_f32 v57, 0, v57
    v_max_f32 v58, 0, v58
    v_max_f32 v59, 0, v59
    v_max_f32 v72, 0, v72
    v_max_f32 v73, 0, v73
    v_max_f32 v74, 0, v74
    v_max_f32 v75, 0, v75
    v_pk_mul_f32 v[56:57], v[56:57], v[242:243] op_sel_hi:[1,0]
    v_pk_mul_f32 v[58:59], v[58:59], v[242:243] op_sel_hi:[1,0]
    v_pk_mul_f32 v[72:73], v[72:73], v[242:243] op_sel_hi:[1,0]
    v_pk_mul_f32 v[74:75], v[74:75], v[242:243] op_sel_hi:[1,0]
    v_pk_mul_f32 v[56:57], v[56:57], v[56:57]
    v_pk_mul_f32 v[58:59], v[58:59], v[58:59]
    v_pk_mul_f32 v[72:73], v[72:73], v[72:73]
    v_pk_mul_f32 v[74:75], v[74:75], v[74:75]
    v_cvt_pk_bf16_f32 v56, v56, v57
    v_cvt_pk_bf16_f32 v57, v58, v59
    v_cvt_pk_bf16_f32 v58, v72, v73
    v_cvt_pk_bf16_f32 v59, v74, v75
    v_max_f32 v60, 0, v60
    v_max_f32 v61, 0, v61
    v_max_f32 v62, 0, v62
    v_max_f32 v63, 0, v63
    v_max_f32 v76, 0, v76
    v_max_f32 v77, 0, v77
    v_max_f32 v78, 0, v78
    v_max_f32 v79, 0, v79
    v_pk_mul_f32 v[60:61], v[60:61], v[242:243] op_sel:[0,1] op_sel_hi:[1,1]
    v_pk_mul_f32 v[62:63], v[62:63], v[242:243] op_sel:[0,1] op_sel_hi:[1,1]
    v_pk_mul_f32 v[76:77], v[76:77], v[242:243] op_sel:[0,1] op_sel_hi:[1,1]
    v_pk_mul_f32 v[78:79], v[78:79], v[242:243] op_sel:[0,1] op_sel_hi:[1,1]
    v_pk_mul_f32 v[60:61], v[60:61], v[60:61]
    v_pk_mul_f32 v[62:63], v[62:63], v[62:63]
    v_pk_mul_f32 v[76:77], v[76:77], v[76:77]
    v_pk_mul_f32 v[78:79], v[78:79], v[78:79]
    v_cvt_pk_bf16_f32 v60, v60, v61
    v_cvt_pk_bf16_f32 v61, v62, v63
    v_cvt_pk_bf16_f32 v62, v76, v77
    v_cvt_pk_bf16_f32 v63, v78, v79
    s_waitcnt vmcnt(0)
    v_subrev_u32 v244, s86, v244
    v_xor_b32 v245, s72, v245
    v_or_b32 v245, v244, v245
    v_cmp_lt_u32 vcc, 7, v245
    s_cbranch_vccnz L_fc_cw_56
L_fc_cw_56_b:
    ds_read_u8 v252, v248 offset:64
    buffer_load_dwordx4 v[204:207], v7, s[4:7], s52 offen offset:0 sc1
    buffer_load_dwordx4 v[208:211], v8, s[4:7], s52 offen offset:0 sc1
    buffer_load_dwordx4 v[212:215], v7, s[4:7], s52 offen offset:2048 sc1
    buffer_load_dwordx4 v[216:219], v8, s[4:7], s52 offen offset:2048 sc1
    s_cmp_lg_u32 s82, 0
    s_cbranch_scc1 L_slow_cw_57
    buffer_store_dwordx4 v[56:59], v0, s[4:7], s29 offen offset:0
L_back_cw_58:
    s_cmp_lg_u32 s82, 0
    s_cbranch_scc1 L_slow_cw_59
    buffer_store_dwordx4 v[60:63], v0, s[4:7], s29 offen offset:256
L_back_cw_60:
    buffer_load_dwordx4 v[220:223], v7, s[4:7], s53 offen offset:0 sc1
    buffer_load_dwordx4 v[224:227], v8, s[4:7], s53 offen offset:0 sc1
    buffer_load_dwordx4 v[228:231], v7, s[4:7], s53 offen offset:2048 sc1
    buffer_load_dwordx4 v[232:235], v8, s[4:7], s53 offen offset:2048 sc1
    buffer_load_dwordx4 v[236:239], v7, s[4:7], s54 offen offset:0 sc1
    buffer_load_dwordx4 v[240:243], v8, s[4:7], s54 offen offset:0 sc1
    buffer_load_dwordx4 v[80:83], v7, s[4:7], s54 offen offset:2048 sc1
    buffer_load_dwordx4 v[84:87], v8, s[4:7], s54 offen offset:2048 sc1
    s_waitcnt lgkmcnt(0)
    v_cmp_gt_u32 vcc, 28, v252
    s_cbranch_vccnz L_lw_cw_61
L_lw_cw_61_b:
    ds_read_u8 v252, v248 offset:64
    s_waitcnt lgkmcnt(0)
    v_cmp_gt_u32 vcc, 29, v252
    s_cbranch_vccnz L_lw_cw_62
L_lw_cw_62_b:
    ds_read_u8 v252, v248 offset:64
    ds_read_b128 v[120:123], v4 offset:0
    ds_read_b128 v[124:127], v4 offset:1024
    ds_read_b128 v[128:131], v4 offset:2048
    ds_read_b128 v[132:135], v4 offset:3072
    ds_read_b128 v[136:139], v4 offset:4096
    ds_read_b128 v[140:143], v4 offset:10240
    ds_read_b128 v[144:147], v4 offset:11264
    ds_read_b128 v[148:151], v4 offset:12288
    ds_read_b128 v[152:155], v4 offset:13312
    ds_read_b128 v[156:159], v4 offset:14336
    s_waitcnt vmcnt(12) lgkmcnt(5)
    v_mfma_f32_16x16x32_bf16 v[164:167], v[120:123], v[204:207], 0
    ds_read_b128 v[160:163], v4 offset:40960
    v_mfma_f32_16x16x32_bf16 v[168:171], v[120:123], v[208:211], 0
    v_mov_b32 v251, 29
    v_mfma_f32_16x16x32_bf16 v[172:175], v[124:127], v[204:207], 0
    ds_read_b128 v[120:123], v4 offset:41984
    v_mfma_f32_16x16x32_bf16 v[176:179], v[124:127], v[208:211], 0
    ds_write_b8 v249, v251 offset:68
    buffer_load_dwordx4 v[88:91], v7, s[4:7], s55 offen offset:0 sc1
    v_mfma_f32_16x16x32_bf16 v[180:183], v[128:131], v[204:207], 0
    ds_read_b128 v[124:127], v4 offset:43008
    v_mfma_f32_16x16x32_bf16 v[184:187], v[128:131], v[208:211], 0
    v_add_u32 v46, 4096, v7
    v_mfma_f32_16x16x32_bf16 v[188:191], v[132:135], v[204:207], 0
    ds_read_b128 v[128:131], v4 offset:44032
    v_mfma_f32_16x16x32_bf16 v[192:195], v[132:135], v[208:211], 0
    buffer_load_dwordx4 v[92:95], v8, s[4:7], s55 offen offset:0 sc1
    v_mfma_f32_16x16x32_bf16 v[196:199], v[136:139], v[204:207], 0
    ds_read_b128 v[132:135], v4 offset:45056
    v_mfma_f32_16x16x32_bf16 v[200:203], v[136:139], v[208:211], 0
    s_waitcnt vmcnt(12) lgkmcnt(6)
    v_mfma_f32_16x16x32_bf16 v[164:167], v[140:143], v[212:215], v[164:167]
    ds_read_b128 v[136:139], v4 offset:20480
    v_mfma_f32_16x16x32_bf16 v[168:171], v[140:143], v[216:219], v[168:171]
    v_add_u32 v47, 4096, v8
    v_mfma_f32_16x16x32_bf16 v[172:175], v[144:147], v[212:215], v[172:175]
    ds_read_b128 v[140:143], v4 offset:21504
    v_mfma_f32_16x16x32_bf16 v[176:179], v[144:147], v[216:219], v[176:179]
    v_cmp_gt_u32 vcc, 30, v252
    buffer_load_dwordx4 v[36:39], v7, s[4:7], s55 offen offset:2048 sc1
    v_mfma_f32_16x16x32_bf16 v[180:183], v[148:151], v[212:215], v[180:183]
    ds_read_b128 v[144:147], v4 offset:22528
    v_mfma_f32_16x16x32_bf16 v[184:187], v[148:151], v[216:219], v[184:187]
    v_lshrrev_b32 v50, 4, v1
    v_mfma_f32_16x16x32_bf16 v[188:191], v[152:155], v[212:215], v[188:191]
    ds_read_b128 v[148:151], v4 offset:23552
    v_mfma_f32_16x16x32_bf16 v[192:195], v[152:155], v[216:219], v[192:195]
    s_cbranch_vccnz L_lw_cw_63
L_lw_cw_63_b:
    buffer_load_dwordx4 v[40:43], v8, s[4:7], s55 offen offset:2048 sc1
    v_mfma_f32_16x16x32_bf16 v[196:199], v[156:159], v[212:215], v[196:199]
    ds_read_b128 v[152:155], v4 offset:24576
    v_mfma_f32_16x16x32_bf16 v[200:203], v[156:159], v[216:219], v[200:203]
    ds_read_u8 v252, v248 offset:64
    s_waitcnt vmcnt(10) lgkmcnt(6)
    v_mfma_f32_16x16x32_bf16 v[164:167], v[160:163], v[220:223], v[164:167]
    ds_read_b128 v[156:159], v4 offset:30720
    v_mfma_f32_16x16x32_bf16 v[168:171], v[160:163], v[224:227], v[168:171]
    s_cmp_lg_u32 s22, 0
    s_cbranch_scc1 L_slow_cw_64
    v_mov_b32 v10, s87
    v_mov_b32 v11, s72
    s_waitcnt vmcnt(63)
    s_mov_b64 exec, 1
    buffer_store_dwordx2 v[10:11], off, s[4:7], s30
    s_mov_b64 exec, -1
L_back_cw_65:
    v_mov_b32 v251, 30
    v_mfma_f32_16x16x32_bf16 v[172:175], v[120:123], v[220:223], v[172:175]
    ds_read_b128 v[160:163], v4 offset:31744
    v_mfma_f32_16x16x32_bf16 v[176:179], v[120:123], v[224:227], v[176:179]
    ds_write_b8 v249, v251 offset:68
    buffer_load_dwordx4 v[64:67], v7, s[4:7], s56 offen offset:0 sc1
    v_mfma_f32_16x16x32_bf16 v[180:183], v[124:127], v[220:223], v[180:183]
    ds_read_b128 v[120:123], v4 offset:32768
    v_mfma_f32_16x16x32_bf16 v[184:187], v[124:127], v[224:227], v[184:187]
    v_and_b32 v51, 15, v1
    v_mfma_f32_16x16x32_bf16 v[188:191], v[128:131], v[220:223], v[188:191]
    ds_read_b128 v[124:127], v4 offset:33792
    v_mfma_f32_16x16x32_bf16 v[192:195], v[128:131], v[224:227], v[192:195]
    buffer_load_dwordx4 v[68:71], v8, s[4:7], s56 offen offset:0 sc1
    v_mfma_f32_16x16x32_bf16 v[196:199], v[132:135], v[220:223], v[196:199]
    ds_read_b128 v[128:131], v4 offset:34816
    v_mfma_f32_16x16x32_bf16 v[200:203], v[132:135], v[224:227], v[200:203]
    s_waitcnt vmcnt(11) lgkmcnt(7)
    v_mfma_f32_16x16x32_bf16 v[164:167], v[136:139], v[228:231], v[164:167]
    ds_read_b128 v[132:135], v5 offset:0
    v_mfma_f32_16x16x32_bf16 v[168:171], v[136:139], v[232:235], v[168:171]
    v_lshrrev_b32 v49, 5, v1
    v_mfma_f32_16x16x32_bf16 v[172:175], v[140:143], v[228:231], v[172:175]
    ds_read_b128 v[136:139], v5 offset:1024
    v_mfma_f32_16x16x32_bf16 v[176:179], v[140:143], v[232:235], v[176:179]
    s_waitcnt lgkmcnt(8)
    v_cmp_gt_u32 vcc, 31, v252
    buffer_load_dwordx4 v[72:75], v7, s[4:7], s56 offen offset:2048 sc1
    v_mfma_f32_16x16x32_bf16 v[180:183], v[144:147], v[228:231], v[180:183]
    ds_read_b128 v[140:143], v5 offset:2048
    v_mfma_f32_16x16x32_bf16 v[184:187], v[144:147], v[232:235], v[184:187]
    v_lshlrev_b32 v49, 9, v49
    v_mfma_f32_16x16x32_bf16 v[188:191], v[148:151], v[228:231], v[188:191]
    ds_read_b128 v[144:147], v5 offset:3072
    v_mfma_f32_16x16x32_bf16 v[192:195], v[148:151], v[232:235], v[192:195]
    s_cbranch_vccnz L_lw_cw_66
L_lw_cw_66_b:
    buffer_load_dwordx4 v[76:79], v8, s[4:7], s56 offen offset:2048 sc1
    v_mfma_f32_16x16x32_bf16 v[196:199], v[152:155], v[228:231], v[196:199]
    ds_read_b128 v[148:151], v5 offset:4096
    v_mfma_f32_16x16x32_bf16 v[200:203], v[152:155], v[232:235], v[200:203]
    ds_read_u8 v252, v248 offset:64
    s_waitcnt vmcnt(11) lgkmcnt(6)
    v_mfma_f32_16x16x32_bf16 v[164:167], v[156:159], v[236:239], v[164:167]
    ds_read_b128 v[152:155], v5 offset:10240
    v_mfma_f32_16x16x32_bf16 v[168:171], v[156:159], v[240:243], v[168:171]
    v_lshl_add_u32 v49, v51, 4, v49
    v_mov_b32 v251, 31
    v_mfma_f32_16x16x32_bf16 v[172:175], v[160:163], v[236:239], v[172:175]
    ds_read_b128 v[156:159], v5 offset:11264
    v_mfma_f32_16x16x32_bf16 v[176:179], v[160:163], v[240:243], v[176:179]
    ds_write_b8 v249, v251 offset:68
    buffer_load_dwordx4 v[204:207], v7, s[4:7], s57 offen offset:0 sc1
    v_mfma_f32_16x16x32_bf16 v[180:183], v[120:123], v[236:239], v[180:183]
    ds_read_b128 v[160:163], v5 offset:12288
    v_mfma_f32_16x16x32_bf16 v[184:187], v[120:123], v[240:243], v[184:187]
    v_and_b32 v52, 1, v50
    v_mfma_f32_16x16x32_bf16 v[188:191], v[124:127], v[236:239], v[188:191]
    ds_read_b128 v[120:123], v5 offset:13312
    v_mfma_f32_16x16x32_bf16 v[192:195], v[124:127], v[240:243], v[192:195]
    buffer_load_dwordx4 v[208:211], v8, s[4:7], s57 offen offset:0 sc1
    v_mfma_f32_16x16x32_bf16 v[196:199], v[128:131], v[236:239], v[196:199]
    ds_read_b128 v[124:127], v5 offset:14336
    v_mfma_f32_16x16x32_bf16 v[200:203], v[128:131], v[240:243], v[200:203]
    s_waitcnt vmcnt(11) lgkmcnt(7)
    v_mfma_f32_16x16x32_bf16 v[164:167], v[132:135], v[80:83], v[164:167]
    ds_read_b128 v[128:131], v5 offset:20480
    v_mfma_f32_16x16x32_bf16 v[168:171], v[132:135], v[84:87], v[168:171]
    v_lshl_add_u32 v49, v52, 3, v49
    v_mfma_f32_16x16x32_bf16 v[172:175], v[136:139], v[80:83], v[172:175]
    ds_read_b128 v[132:135], v5 offset:21504
    v_mfma_f32_16x16x32_bf16 v[176:179], v[136:139], v[84:87], v[176:179]
    s_waitcnt lgkmcnt(8)
    v_cmp_gt_u32 vcc, 32, v252
    buffer_load_dwordx4 v[212:215], v7, s[4:7], s57 offen offset:2048 sc1
    v_mfma_f32_16x16x32_bf16 v[180:183], v[140:143], v[80:83], v[180:183]
    ds_read_b128 v[136:139], v5 offset:22528
    v_mfma_f32_16x16x32_bf16 v[184:187], v[140:143], v[84:87], v[184:187]
    v_add_u32 v49, s66, v49
    v_mfma_f32_16x16x32_bf16 v[188:191], v[144:147], v[80:83], v[188:191]
    ds_read_b128 v[140:143], v5 offset:23552
    v_mfma_f32_16x16x32_bf16 v[192:195], v[144:147], v[84:87], v[192:195]
    s_cbranch_vccnz L_lw_cw_67
L_lw_cw_67_b:
    buffer_load_dwordx4 v[216:219], v8, s[4:7], s57 offen offset:2048 sc1
    v_mfma_f32_16x16x32_bf16 v[196:199], v[148:151], v[80:83], v[196:199]
    ds_read_b128 v[144:147], v5 offset:24576
    v_mfma_f32_16x16x32_bf16 v[200:203], v[148:151], v[84:87], v[200:203]
    ds_read_u8 v252, v248 offset:64
    s_waitcnt vmcnt(11) lgkmcnt(6)
    v_mfma_f32_16x16x32_bf16 v[164:167], v[152:155], v[88:91], v[164:167]
    ds_read_b128 v[148:151], v5 offset:30720
    v_mfma_f32_16x16x32_bf16 v[168:171], v[152:155], v[92:95], v[168:171]
    v_lshlrev_b32 v52, 4, v50
    v_mov_b32 v251, 32
    v_mfma_f32_16x16x32_bf16 v[172:175], v[156:159], v[88:91], v[172:175]
    ds_read_b128 v[152:155], v5 offset:31744
    v_mfma_f32_16x16x32_bf16 v[176:179], v[156:159], v[92:95], v[176:179]
    ds_write_b8 v249, v251 offset:68
    buffer_load_dwordx4 v[220:223], v7, s[4:7], s58 offen offset:0 sc1
    v_mfma_f32_16x16x32_bf16 v[180:183], v[160:163], v[88:91], v[180:183]
    ds_read_b128 v[156:159], v5 offset:32768
    v_mfma_f32_16x16x32_bf16 v[184:187], v[160:163], v[92:95], v[184:187]
    v_lshlrev_b32 v53, 3, v50
    v_mfma_f32_16x16x32_bf16 v[188:191], v[120:123], v[88:91], v[188:191]
    ds_read_b128 v[160:163], v5 offset:33792
    v_mfma_f32_16x16x32_bf16 v[192:195], v[120:123], v[92:95], v[192:195]
    buffer_load_dwordx4 v[224:227], v8, s[4:7], s58 offen offset:0 sc1
    v_mfma_f32_16x16x32_bf16 v[196:199], v[124:127], v[88:91], v[196:199]
    ds_read_b128 v[120:123], v5 offset:34816
    v_mfma_f32_16x16x32_bf16 v[200:203], v[124:127], v[92:95], v[200:203]
    s_waitcnt vmcnt(11) lgkmcnt(7)
    v_mfma_f32_16x16x32_bf16 v[164:167], v[128:131], v[36:39], v[164:167]
    ds_read_b128 v[124:127], v5 offset:40960
    v_mfma_f32_16x16x32_bf16 v[168:171], v[128:131], v[40:43], v[168:171]
    buffer_load_dwordx2 v[244:245], v9, s[4:7], s63 offen sc1
    v_mfma_f32_16x16x32_bf16 v[172:175], v[132:135], v[36:39], v[172:175]
    ds_read_b128 v[128:131], v5 offset:41984
    v_mfma_f32_16x16x32_bf16 v[176:179], v[132:135], v[40:43], v[176:179]
    s_waitcnt lgkmcnt(8)
    v_cmp_gt_u32 vcc, 33, v252
    buffer_load_dwordx4 v[228:231], v7, s[4:7], s58 offen offset:2048 sc1
    v_mfma_f32_16x16x32_bf16 v[180:183], v[136:139], v[36:39], v[180:183]
    ds_read_b128 v[132:135], v5 offset:43008
    v_mfma_f32_16x16x32_bf16 v[184:187], v[136:139], v[40:43], v[184:187]
    buffer_load_dwordx4 v[12:15], v7, s[4:7], s60 offen sc1
    v_mfma_f32_16x16x32_bf16 v[188:191], v[140:143], v[36:39], v[188:191]
    ds_read_b128 v[136:139], v5 offset:44032
    v_mfma_f32_16x16x32_bf16 v[192:195], v[140:143], v[40:43], v[192:195]
    s_cbranch_vccnz L_lw_cw_68
L_lw_cw_68_b:
    buffer_load_dwordx4 v[232:235], v8, s[4:7], s58 offen offset:2048 sc1
    v_mfma_f32_16x16x32_bf16 v[196:199], v[144:147], v[36:39], v[196:199]
    ds_read_b128 v[140:143], v5 offset:45056
    v_mfma_f32_16x16x32_bf16 v[200:203], v[144:147], v[40:43], v[200:203]
    ds_read_u8 v252, v248 offset:64
    s_waitcnt vmcnt(12) lgkmcnt(6)
    v_mfma_f32_16x16x32_bf16 v[164:167], v[148:151], v[64:67], v[164:167]
    ds_read_b128 v[144:147], v5 offset:51200
    v_mfma_f32_16x16x32_bf16 v[168:171], v[148:151], v[68:71], v[168:171]
    buffer_load_dwordx4 v[16:19], v7, s[4:7], s60 offen offset:2048 sc1
    v_mov_b32 v251, 33
    v_mfma_f32_16x16x32_bf16 v[172:175], v[152:155], v[64:67], v[172:175]
    ds_read_b128 v[148:151], v5 offset:52224
    v_mfma_f32_16x16x32_bf16 v[176:179], v[152:155], v[68:71], v[176:179]
    ds_write_b8 v249, v251 offset:68
    buffer_load_dwordx4 v[236:239], v7, s[4:7], s59 offen offset:0 sc1
    v_mfma_f32_16x16x32_bf16 v[180:183], v[156:159], v[64:67], v[180:183]
    ds_read_b128 v[152:155], v5 offset:53248
    v_mfma_f32_16x16x32_bf16 v[184:187], v[156:159], v[68:71], v[184:187]
    buffer_load_dwordx2 v[20:21], v49, s[4:7], s61 offen sc1
    v_mfma_f32_16x16x32_bf16 v[188:191], v[160:163], v[64:67], v[188:191]
    ds_read_b128 v[156:159], v5 offset:54272
    v_mfma_f32_16x16x32_bf16 v[192:195], v[160:163], v[68:71], v[192:195]
    buffer_load_dwordx4 v[240:243], v8, s[4:7], s59 offen offset:0 sc1
    v_mfma_f32_16x16x32_bf16 v[196:199], v[120:123], v[64:67], v[196:199]
    ds_read_b128 v[160:163], v5 offset:55296
    v_mfma_f32_16x16x32_bf16 v[200:203], v[120:123], v[68:71], v[200:203]
    s_waitcnt vmcnt(14) lgkmcnt(7)
    v_mfma_f32_16x16x32_bf16 v[164:167], v[124:127], v[72:75], v[164:167]
    ds_read_b128 v[120:123], v6 offset:0
    v_mfma_f32_16x16x32_bf16 v[168:171], v[124:127], v[76:79], v[168:171]
    buffer_load_dwordx4 v[24:27], v52, s[12:15], s62 offen
    v_mfma_f32_16x16x32_bf16 v[172:175], v[128:131], v[72:75], v[172:175]
    ds_read_b128 v[124:127], v6 offset:1024
    v_mfma_f32_16x16x32_bf16 v[176:179], v[128:131], v[76:79], v[176:179]
    s_waitcnt lgkmcnt(8)
    v_cmp_gt_u32 vcc, 34, v252
    buffer_load_dwordx4 v[80:83], v7, s[4:7], s59 offen offset:2048 sc1
    v_mfma_f32_16x16x32_bf16 v[180:183], v[132:135], v[72:75], v[180:183]
    ds_read_b128 v[128:131], v6 offset:2048
    v_mfma_f32_16x16x32_bf16 v[184:187], v[132:135], v[76:79], v[184:187]
    buffer_load_dwordx4 v[28:31], v52, s[12:15], s62 offen offset:64
    v_mfma_f32_16x16x32_bf16 v[188:191], v[136:139], v[72:75], v[188:191]
    ds_read_b128 v[132:135], v6 offset:3072
    v_mfma_f32_16x16x32_bf16 v[192:195], v[136:139], v[76:79], v[192:195]
    s_cbranch_vccnz L_lw_cw_69
L_lw_cw_69_b:
    buffer_load_dwordx4 v[84:87], v8, s[4:7], s59 offen offset:2048 sc1
    v_mfma_f32_16x16x32_bf16 v[196:199], v[140:143], v[72:75], v[196:199]
    ds_read_b128 v[136:139], v6 offset:4096
    v_mfma_f32_16x16x32_bf16 v[200:203], v[140:143], v[76:79], v[200:203]
    s_waitcnt vmcnt(11)
    v_subrev_u32 v244, s87, v244
    v_xor_b32 v245, s72, v245
    v_or_b32 v245, v244, v245
    v_cmp_lt_u32 vcc, 7, v245
    s_cbranch_vccnz L_fc_cw_70
L_fc_cw_70_b:
    ds_read_u8 v252, v248 offset:64
    s_waitcnt vmcnt(16) lgkmcnt(6)
    v_mfma_f32_16x16x32_bf16 v[164:167], v[144:147], v[204:207], v[164:167]
    ds_read_b128 v[140:143], v6 offset:10240
    v_mfma_f32_16x16x32_bf16 v[168:171], v[144:147], v[208:211], v[168:171]
    buffer_load_dwordx2 v[32:33], v53, s[12:15], s62 offen offset:128
    v_mov_b32 v251, 34
    v_mfma_f32_16x16x32_bf16 v[172:175], v[148:151], v[204:207], v[172:175]
    ds_read_b128 v[144:147], v6 offset:11264
    v_mfma_f32_16x16x32_bf16 v[176:179], v[148:151], v[208:211], v[176:179]
    ds_write_b8 v249, v251 offset:68
    buffer_load_dwordx4 v[88:91], v46, s[4:7], s52 offen sc1
    v_mfma_f32_16x16x32_bf16 v[180:183], v[152:155], v[204:207], v[180:183]
    ds_read_b128 v[148:151], v6 offset:12288
    v_mfma_f32_16x16x32_bf16 v[184:187], v[152:155], v[208:211], v[184:187]
    s_mul_i32 s71, s18, 5120
    v_mfma_f32_16x16x32_bf16 v[188:191], v[156:159], v[204:207], v[188:191]
    ds_read_b128 v[152:155], v6 offset:13312
    v_mfma_f32_16x16x32_bf16 v[192:195], v[156:159], v[208:211], v[192:195]
    buffer_load_dwordx4 v[92:95], v47, s[4:7], s52 offen sc1
    v_mfma_f32_16x16x32_bf16 v[196:199], v[160:163], v[204:207], v[196:199]
    ds_read_b128 v[156:159], v6 offset:14336
    v_mfma_f32_16x16x32_bf16 v[200:203], v[160:163], v[208:211], v[200:203]
    s_waitcnt vmcnt(17) lgkmcnt(7)
    v_mfma_f32_16x16x32_bf16 v[164:167], v[120:123], v[212:215], v[164:167]
    ds_read_b128 v[160:163], v6 offset:20480
    v_mfma_f32_16x16x32_bf16 v[168:171], v[120:123], v[216:219], v[168:171]
    s_add_u32 s71, s71, 133120
    v_mfma_f32_16x16x32_bf16 v[172:175], v[124:127], v[212:215], v[172:175]
    ds_read_b128 v[120:123], v6 offset:21504
    v_mfma_f32_16x16x32_bf16 v[176:179], v[124:127], v[216:219], v[176:179]
    s_waitcnt lgkmcnt(8)
    v_cmp_gt_u32 vcc, 35, v252
    buffer_load_dwordx4 v[36:39], v46, s[4:7], s53 offen sc1
    v_mfma_f32_16x16x32_bf16 v[180:183], v[128:131], v[212:215], v[180:183]
    ds_read_b128 v[124:127], v6 offset:22528
    v_mfma_f32_16x16x32_bf16 v[184:187], v[128:131], v[216:219], v[184:187]
    v_add_u32 v54, s71, v2
    v_mfma_f32_16x16x32_bf16 v[188:191], v[132:135], v[212:215], v[188:191]
    ds_read_b128 v[128:131], v6 offset:23552
    v_mfma_f32_16x16x32_bf16 v[192:195], v[132:135], v[216:219], v[192:195]
    s_cbranch_vccnz L_lw_cw_71
L_lw_cw_71_b:
    buffer_load_dwordx4 v[40:43], v47, s[4:7], s53 offen sc1
    v_mfma_f32_16x16x32_bf16 v[196:199], v[136:139], v[212:215], v[196:199]
    ds_read_b128 v[132:135], v6 offset:24576
    v_mfma_f32_16x16x32_bf16 v[200:203], v[136:139], v[216:219], v[200:203]
    ds_read_u8 v252, v248 offset:64
    s_waitcnt vmcnt(17) lgkmcnt(6)
    v_mfma_f32_16x16x32_bf16 v[164:167], v[140:143], v[220:223], v[164:167]
    ds_read_b128 v[136:139], v4 offset:51200
    v_mfma_f32_16x16x32_bf16 v[168:171], v[140:143], v[224:227], v[168:171]
    s_xor_b32 s71, s18, 2
    v_mov_b32 v251, 35
    v_mfma_f32_16x16x32_bf16 v[172:175], v[144:147], v[220:223], v[172:175]
    ds_read_b128 v[140:143], v4 offset:52224
    v_mfma_f32_16x16x32_bf16 v[176:179], v[144:147], v[224:227], v[176:179]
    ds_write_b8 v249, v251 offset:68
    buffer_load_dwordx4 v[64:67], v46, s[4:7], s54 offen sc1
    v_mfma_f32_16x16x32_bf16 v[180:183], v[148:151], v[220:223], v[180:183]
    ds_read_b128 v[144:147], v4 offset:53248
    v_mfma_f32_16x16x32_bf16 v[184:187], v[148:151], v[224:227], v[184:187]
    s_mul_i32 s71, s71, 5120
    v_mfma_f32_16x16x32_bf16 v[188:191], v[152:155], v[220:223], v[188:191]
    ds_read_b128 v[148:151], v4 offset:54272
    v_mfma_f32_16x16x32_bf16 v[192:195], v[152:155], v[224:227], v[192:195]
    buffer_load_dwordx4 v[68:71], v47, s[4:7], s54 offen sc1
    v_mfma_f32_16x16x32_bf16 v[196:199], v[156:159], v[220:223], v[196:199]
    ds_read_b128 v[152:155], v4 offset:55296
    v_mfma_f32_16x16x32_bf16 v[200:203], v[156:159], v[224:227], v[200:203]
    s_waitcnt vmcnt(15) lgkmcnt(7)
    v_mfma_f32_16x16x32_bf16 v[164:167], v[160:163], v[228:231], v[164:167]
    ds_read_b128 v[156:159], v4 offset:0
    v_mfma_f32_16x16x32_bf16 v[168:171], v[160:163], v[232:235], v[168:171]
    s_add_u32 s71, s71, 133120
    v_mfma_f32_16x16x32_bf16 v[172:175], v[120:123], v[228:231], v[172:175]
    ds_read_b128 v[160:163], v4 offset:1024
    v_mfma_f32_16x16x32_bf16 v[176:179], v[120:123], v[232:235], v[176:179]
    s_waitcnt lgkmcnt(8)
    v_cmp_gt_u32 vcc, 36, v252
    buffer_load_dwordx4 v[72:75], v46, s[4:7], s55 offen sc1
    v_mfma_f32_16x16x32_bf16 v[180:183], v[124:127], v[228:231], v[180:183]
    ds_read_b128 v[120:123], v4 offset:2048
    v_mfma_f32_16x16x32_bf16 v[184:187], v[124:127], v[232:235], v[184:187]
    v_add_u32 v55, s71, v2
    v_mfma_f32_16x16x32_bf16 v[188:191], v[128:131], v[228:231], v[188:191]
    ds_read_b128 v[124:127], v4 offset:3072
    v_mfma_f32_16x16x32_bf16 v[192:195], v[128:131], v[232:235], v[192:195]
    s_cbranch_vccnz L_lw_cw_72
L_lw_cw_72_b:
    buffer_load_dwordx4 v[76:79], v47, s[4:7], s55 offen sc1
    v_mfma_f32_16x16x32_bf16 v[196:199], v[132:135], v[228:231], v[196:199]
    ds_read_b128 v[128:131], v4 offset:4096
    v_mfma_f32_16x16x32_bf16 v[200:203], v[132:135], v[232:235], v[200:203]
    s_waitcnt vmcnt(13) lgkmcnt(5)
    v_mfma_f32_16x16x32_bf16 v[164:167], v[136:139], v[236:239], v[164:167]
    ds_read_b128 v[132:135], v4 offset:10240
    v_mfma_f32_16x16x32_bf16 v[168:171], v[136:139], v[240:243], v[168:171]
    ds_read_u8 v252, v248 offset:64
    v_mov_b32 v251, 36
    v_mfma_f32_16x16x32_bf16 v[172:175], v[140:143], v[236:239], v[172:175]
    ds_read_b128 v[136:139], v4 offset:11264
    v_mfma_f32_16x16x32_bf16 v[176:179], v[140:143], v[240:243], v[176:179]
    ds_write_b8 v249, v251 offset:68
    buffer_load_dwordx4 v[204:207], v46, s[4:7], s56 offen sc1
    v_mfma_f32_16x16x32_bf16 v[180:183], v[144:147], v[236:239], v[180:183]
    ds_read_b128 v[140:143], v4 offset:12288
    v_mfma_f32_16x16x32_bf16 v[184:187], v[144:147], v[240:243], v[184:187]
    v_mfma_f32_16x16x32_bf16 v[188:191], v[148:151], v[236:239], v[188:191]
    ds_read_b128 v[144:147], v4 offset:13312
    v_mfma_f32_16x16x32_bf16 v[192:195], v[148:151], v[240:243], v[192:195]
    buffer_load_dwordx4 v[208:211], v47, s[4:7], s56 offen sc1
    v_mfma_f32_16x16x32_bf16 v[196:199], v[152:155], v[236:239], v[196:199]
    ds_read_b128 v[148:151], v4 offset:14336
    v_mfma_f32_16x16x32_bf16 v[200:203], v[152:155], v[240:243], v[200:203]
    s_waitcnt vmcnt(11) lgkmcnt(7)
    v_mfma_f32_16x16x32_bf16 v[164:167], v[156:159], v[80:83], v[164:167]
    ds_read_b128 v[152:155], v4 offset:40960
    v_mfma_f32_16x16x32_bf16 v[168:171], v[156:159], v[84:87], v[168:171]
    v_mfma_f32_16x16x32_bf16 v[172:175], v[160:163], v[80:83], v[172:175]
    ds_read_b128 v[156:159], v4 offset:41984
    v_mfma_f32_16x16x32_bf16 v[176:179], v[160:163], v[84:87], v[176:179]
    buffer_load_dwordx4 v[212:215], v46, s[4:7], s57 offen sc1
    v_mfma_f32_16x16x32_bf16 v[180:183], v[120:123], v[80:83], v[180:183]
    ds_read_b128 v[160:163], v4 offset:43008
    v_mfma_f32_16x16x32_bf16 v[184:187], v[120:123], v[84:87], v[184:187]
    s_waitcnt lgkmcnt(8)
    v_cmp_gt_u32 vcc, 37, v252
    v_mfma_f32_16x16x32_bf16 v[188:191], v[124:127], v[80:83], v[188:191]
    ds_read_b128 v[120:123], v4 offset:44032
    v_mfma_f32_16x16x32_bf16 v[192:195], v[124:127], v[84:87], v[192:195]
    s_cbranch_vccnz L_lw_cw_73
L_lw_cw_73_b:
    buffer_load_dwordx4 v[216:219], v47, s[4:7], s57 offen sc1
    v_mfma_f32_16x16x32_bf16 v[196:199], v[128:131], v[80:83], v[196:199]
    ds_read_b128 v[124:127], v4 offset:45056
    v_mfma_f32_16x16x32_bf16 v[200:203], v[128:131], v[84:87], v[200:203]
    v_mov_b32 v251, 37
    s_waitcnt vmcnt(10) lgkmcnt(5)
    v_mfma_f32_16x16x32_bf16 v[164:167], v[132:135], v[88:91], v[164:167]
    ds_read_b128 v[128:131], v4 offset:20480
    v_mfma_f32_16x16x32_bf16 v[168:171], v[132:135], v[92:95], v[168:171]
    ds_write_b8 v249, v251 offset:68
    v_mfma_f32_16x16x32_bf16 v[172:175], v[136:139], v[88:91], v[172:175]
    ds_read_b128 v[132:135], v4 offset:21504
    v_mfma_f32_16x16x32_bf16 v[176:179], v[136:139], v[92:95], v[176:179]
    ds_read_u8 v252, v248 offset:64
    buffer_load_dwordx4 v[220:223], v46, s[4:7], s58 offen sc1
    v_mfma_f32_16x16x32_bf16 v[180:183], v[140:143], v[88:91], v[180:183]
    ds_read_b128 v[136:139], v4 offset:22528
    v_mfma_f32_16x16x32_bf16 v[184:187], v[140:143], v[92:95], v[184:187]
    v_mfma_f32_16x16x32_bf16 v[188:191], v[144:147], v[88:91], v[188:191]
    ds_read_b128 v[140:143], v4 offset:23552
    v_mfma_f32_16x16x32_bf16 v[192:195], v[144:147], v[92:95], v[192:195]
    buffer_load_dwordx4 v[224:227], v47, s[4:7], s58 offen sc1
    v_mfma_f32_16x16x32_bf16 v[196:199], v[148:151], v[88:91], v[196:199]
    ds_read_b128 v[144:147], v4 offset:24576
    v_mfma_f32_16x16x32_bf16 v[200:203], v[148:151], v[92:95], v[200:203]
    s_waitcnt vmcnt(10) lgkmcnt(7)
    v_mfma_f32_16x16x32_bf16 v[164:167], v[152:155], v[36:39], v[164:167]
    ds_read_b128 v[148:151], v4 offset:30720
    v_mfma_f32_16x16x32_bf16 v[168:171], v[152:155], v[40:43], v[168:171]
    s_waitcnt vmcnt(14)
    v_mfma_f32_16x16x32_bf16 v[172:175], v[156:159], v[36:39], v[172:175]
    ds_read_b128 v[152:155], v4 offset:31744
    v_mfma_f32_16x16x32_bf16 v[176:179], v[156:159], v[40:43], v[176:179]
    v_lshlrev_b32 v100, 16, v12
    v_and_b32 v101, 0xffff0000, v12
    buffer_load_dwordx4 v[228:231], v46, s[4:7], s59 offen sc1
    v_mfma_f32_16x16x32_bf16 v[180:183], v[160:163], v[36:39], v[180:183]
    ds_read_b128 v[156:159], v4 offset:32768
    v_mfma_f32_16x16x32_bf16 v[184:187], v[160:163], v[40:43], v[184:187]
    v_lshlrev_b32 v56, 16, v24
    v_and_b32 v57, 0xffff0000, v24
    v_mfma_f32_16x16x32_bf16 v[188:191], v[120:123], v[36:39], v[188:191]
    ds_read_b128 v[160:163], v4 offset:33792
    v_mfma_f32_16x16x32_bf16 v[192:195], v[120:123], v[40:43], v[192:195]
    v_pk_add_f32 v[100:101], v[100:101], v[56:57]
    v_lshlrev_b32 v102, 16, v13
    s_waitcnt lgkmcnt(7)
    v_cmp_gt_u32 vcc, 38, v252
    buffer_load_dwordx4 v[232:235], v47, s[4:7], s59 offen sc1
    v_mfma_f32_16x16x32_bf16 v[196:199], v[124:127], v[36:39], v[196:199]
    ds_read_b128 v[120:123], v4 offset:34816
    v_mfma_f32_16x16x32_bf16 v[200:203], v[124:127], v[40:43], v[200:203]
    v_and_b32 v103, 0xffff0000, v13
    v_lshlrev_b32 v56, 16, v25
    s_cbranch_vccnz L_lw_cw_74
L_lw_cw_74_b:
    v_mov_b32 v251, 38
    s_waitcnt vmcnt(10) lgkmcnt(5)
    v_mfma_f32_16x16x32_bf16 v[164:167], v[128:131], v[64:67], v[164:167]
    ds_read_b128 v[124:127], v5 offset:0
    v_mfma_f32_16x16x32_bf16 v[168:171], v[128:131], v[68:71], v[168:171]
    v_and_b32 v57, 0xffff0000, v25
    v_pk_add_f32 v[102:103], v[102:103], v[56:57]
    ds_write_b8 v249, v251 offset:68
    v_mfma_f32_16x16x32_bf16 v[172:175], v[132:135], v[64:67], v[172:175]
    ds_read_b128 v[128:131], v5 offset:1024
    v_mfma_f32_16x16x32_bf16 v[176:179], v[132:135], v[68:71], v[176:179]
    v_lshlrev_b32 v104, 16, v14
    v_and_b32 v105, 0xffff0000, v14
    ds_read_u8 v252, v248 offset:64
    v_mfma_f32_16x16x32_bf16 v[180:183], v[136:139], v[64:67], v[180:183]
    ds_read_b128 v[132:135], v5 offset:2048
    v_mfma_f32_16x16x32_bf16 v[184:187], v[136:139], v[68:71], v[184:187]
    v_lshlrev_b32 v56, 16, v26
    v_and_b32 v57, 0xffff0000, v26
    v_mfma_f32_16x16x32_bf16 v[188:191], v[140:143], v[64:67], v[188:191]
    ds_read_b128 v[136:139], v5 offset:3072
    v_mfma_f32_16x16x32_bf16 v[192:195], v[140:143], v[68:71], v[192:195]
    v_pk_add_f32 v[104:105], v[104:105], v[56:57]
    v_lshlrev_b32 v106, 16, v15
    v_mfma_f32_16x16x32_bf16 v[196:199], v[144:147], v[64:67], v[196:199]
    ds_read_b128 v[140:143], v5 offset:4096
    v_mfma_f32_16x16x32_bf16 v[200:203], v[144:147], v[68:71], v[200:203]
    v_and_b32 v107, 0xffff0000, v15
    v_lshlrev_b32 v56, 16, v27
    s_waitcnt vmcnt(8) lgkmcnt(7)
    v_mfma_f32_16x16x32_bf16 v[164:167], v[148:151], v[72:75], v[164:167]
    ds_read_b128 v[144:147], v5 offset:10240
    v_mfma_f32_16x16x32_bf16 v[168:171], v[148:151], v[76:79], v[168:171]
    v_and_b32 v57, 0xffff0000, v27
    v_pk_add_f32 v[106:107], v[106:107], v[56:57]
    v_mfma_f32_16x16x32_bf16 v[172:175], v[152:155], v[72:75], v[172:175]
    ds_read_b128 v[148:151], v5 offset:11264
    v_mfma_f32_16x16x32_bf16 v[176:179], v[152:155], v[76:79], v[176:179]
    v_lshlrev_b32 v108, 16, v16
    v_and_b32 v109, 0xffff0000, v16
    v_mfma_f32_16x16x32_bf16 v[180:183], v[156:159], v[72:75], v[180:183]
    ds_read_b128 v[152:155], v5 offset:12288
    v_mfma_f32_16x16x32_bf16 v[184:187], v[156:159], v[76:79], v[184:187]
    v_lshlrev_b32 v56, 16, v28
    v_and_b32 v57, 0xffff0000, v28
    v_mfma_f32_16x16x32_bf16 v[188:191], v[160:163], v[72:75], v[188:191]
    ds_read_b128 v[156:159], v5 offset:13312
    v_mfma_f32_16x16x32_bf16 v[192:195], v[160:163], v[76:79], v[192:195]
    v_pk_add_f32 v[108:109], v[108:109], v[56:57]
    v_lshlrev_b32 v110, 16, v17
    s_waitcnt lgkmcnt(7)
    v_cmp_gt_u32 vcc, 39, v252
    v_mfma_f32_16x16x32_bf16 v[196:199], v[120:123], v[72:75], v[196:199]
    ds_read_b128 v[160:163], v5 offset:14336
    v_mfma_f32_16x16x32_bf16 v[200:203], v[120:123], v[76:79], v[200:203]
    v_and_b32 v111, 0xffff0000, v17
    v_lshlrev_b32 v56, 16, v29
    s_cbranch_vccnz L_lw_cw_75
L_lw_cw_75_b:
    v_mov_b32 v251, 39
    s_waitcnt vmcnt(6) lgkmcnt(5)
    v_mfma_f32_16x16x32_bf16 v[164:167], v[124:127], v[204:207], v[164:167]
    ds_read_b128 v[120:123], v5 offset:20480
    v_mfma_f32_16x16x32_bf16 v[168:171], v[124:127], v[208:211], v[168:171]
    v_and_b32 v57, 0xffff0000, v29
    v_pk_add_f32 v[110:111], v[110:111], v[56:57]
    ds_write_b8 v249, v251 offset:68
    v_mfma_f32_16x16x32_bf16 v[172:175], v[128:131], v[204:207], v[172:175]
    ds_read_b128 v[124:127], v5 offset:21504
    v_mfma_f32_16x16x32_bf16 v[176:179], v[128:131], v[208:211], v[176:179]
    v_lshlrev_b32 v112, 16, v18
    v_and_b32 v113, 0xffff0000, v18
    v_mfma_f32_16x16x32_bf16 v[180:183], v[132:135], v[204:207], v[180:183]
    ds_read_b128 v[128:131], v5 offset:22528
    v_mfma_f32_16x16x32_bf16 v[184:187], v[132:135], v[208:211], v[184:187]
    v_lshlrev_b32 v56, 16, v30
    v_and_b32 v57, 0xffff0000, v30
    v_mfma_f32_16x16x32_bf16 v[188:191], v[136:139], v[204:207], v[188:191]
    ds_read_b128 v[132:135], v5 offset:23552
    v_mfma_f32_16x16x32_bf16 v[192:195], v[136:139], v[208:211], v[192:195]
    v_pk_add_f32 v[112:113], v[112:113], v[56:57]
    v_lshlrev_b32 v114, 16, v19
    v_mfma_f32_16x16x32_bf16 v[196:199], v[140:143], v[204:207], v[196:199]
    ds_read_b128 v[136:139], v5 offset:24576
    v_mfma_f32_16x16x32_bf16 v[200:203], v[140:143], v[208:211], v[200:203]
    v_and_b32 v115, 0xffff0000, v19
    v_lshlrev_b32 v56, 16, v31
    s_waitcnt vmcnt(4) lgkmcnt(6)
    v_mfma_f32_16x16x32_bf16 v[164:167], v[144:147], v[212:215], v[164:167]
    ds_read_b128 v[140:143], v5 offset:30720
    v_mfma_f32_16x16x32_bf16 v[168:171], v[144:147], v[216:219], v[168:171]
    v_and_b32 v57, 0xffff0000, v31
    v_pk_add_f32 v[114:115], v[114:115], v[56:57]
    v_mfma_f32_16x16x32_bf16 v[172:175], v[148:151], v[212:215], v[172:175]
    ds_read_b128 v[144:147], v5 offset:31744
    v_mfma_f32_16x16x32_bf16 v[176:179], v[148:151], v[216:219], v[176:179]
    v_lshlrev_b32 v116, 16, v20
    v_and_b32 v117, 0xffff0000, v20
    v_mfma_f32_16x16x32_bf16 v[180:183], v[152:155], v[212:215], v[180:183]
    ds_read_b128 v[148:151], v5 offset:32768
    v_mfma_f32_16x16x32_bf16 v[184:187], v[152:155], v[216:219], v[184:187]
    v_lshlrev_b32 v56, 16, v32
    v_and_b32 v57, 0xffff0000, v32
    v_mfma_f32_16x16x32_bf16 v[188:191], v[156:159], v[212:215], v[188:191]
    ds_read_b128 v[152:155], v5 offset:33792
    v_mfma_f32_16x16x32_bf16 v[192:195], v[156:159], v[216:219], v[192:195]
    v_pk_add_f32 v[116:117], v[116:117], v[56:57]
    v_lshlrev_b32 v118, 16, v21
    v_mfma_f32_16x16x32_bf16 v[196:199], v[160:163], v[212:215], v[196:199]
    ds_read_b128 v[156:159], v5 offset:34816
    v_mfma_f32_16x16x32_bf16 v[200:203], v[160:163], v[216:219], v[200:203]
    v_and_b32 v119, 0xffff0000, v21
    v_lshlrev_b32 v56, 16, v33
    s_waitcnt vmcnt(2) lgkmcnt(5)
    v_mfma_f32_16x16x32_bf16 v[164:167], v[120:123], v[220:223], v[164:167]
    v_mfma_f32_16x16x32_bf16 v[168:171], v[120:123], v[224:227], v[168:171]
    v_and_b32 v57, 0xffff0000, v33
    v_pk_add_f32 v[118:119], v[118:119], v[56:57]
    v_mfma_f32_16x16x32_bf16 v[172:175], v[124:127], v[220:223], v[172:175]
    v_mfma_f32_16x16x32_bf16 v[176:179], v[124:127], v[224:227], v[176:179]
    ds_read_u8 v253, v248 offset:68
    v_mov_b32 v251, 40
    v_mfma_f32_16x16x32_bf16 v[180:183], v[128:131], v[220:223], v[180:183]
    v_mfma_f32_16x16x32_bf16 v[184:187], v[128:131], v[224:227], v[184:187]
    ds_write_b8 v249, v251 offset:68
    v_mfma_f32_16x16x32_bf16 v[188:191], v[132:135], v[220:223], v[188:191]
    v_mfma_f32_16x16x32_bf16 v[192:195], v[132:135], v[224:227], v[192:195]
    v_mfma_f32_16x16x32_bf16 v[196:199], v[136:139], v[220:223], v[196:199]
    v_mfma_f32_16x16x32_bf16 v[200:203], v[136:139], v[224:227], v[200:203]
    s_waitcnt vmcnt(0) lgkmcnt(2)
    v_mfma_f32_16x16x32_bf16 v[164:167], v[140:143], v[228:231], v[164:167]
    v_mfma_f32_16x16x32_bf16 v[168:171], v[140:143], v[232:235], v[168:171]
    v_mfma_f32_16x16x32_bf16 v[172:175], v[144:147], v[228:231], v[172:175]
    v_mfma_f32_16x16x32_bf16 v[176:179], v[144:147], v[232:235], v[176:179]
    s_waitcnt lgkmcnt(1)
    v_cmp_gt_u32 vcc, 35, v253
    s_cbranch_vccnz L_xc_cw_76
L_xc_cw_76_b:
    v_mfma_f32_16x16x32_bf16 v[180:183], v[148:151], v[228:231], v[180:183]
    v_mfma_f32_16x16x32_bf16 v[184:187], v[148:151], v[232:235], v[184:187]
    v_mfma_f32_16x16x32_bf16 v[188:191], v[152:155], v[228:231], v[188:191]
    v_mfma_f32_16x16x32_bf16 v[192:195], v[152:155], v[232:235], v[192:195]
    v_mfma_f32_16x16x32_bf16 v[196:199], v[156:159], v[228:231], v[196:199]
    v_mfma_f32_16x16x32_bf16 v[200:203], v[156:159], v[232:235], v[200:203]
    v_mov_b32 v251, 41
    s_xor_b32 s30, s18, 2
    s_lshl_b32 s30, 1, s30
    s_nop 0
    ds_write_b128 v54, v[168:171] offset:0
    ds_write_b128 v54, v[176:179] offset:1024
    ds_write_b128 v54, v[184:187] offset:2048
    s_nop 1
    ds_write_b128 v54, v[192:195] offset:3072
    ds_write_b128 v54, v[200:203] offset:4096
    ds_write_b8 v249, v251 offset:80
    ds_read_u8 v250, v248 offset:80
    v_mov_b32 v10, 0x3f803f80
    v_mov_b32 v42, 0
    v_mov_b32 v43, 0
    v_pk_add_f32 v[164:165], v[164:165], v[100:101]
    v_pk_add_f32 v[166:167], v[166:167], v[102:103]
    v_pk_add_f32 v[172:173], v[172:173], v[104:105]
    v_pk_add_f32 v[174:175], v[174:175], v[106:107]
    v_pk_add_f32 v[180:181], v[180:181], v[108:109]
    v_pk_add_f32 v[182:183], v[182:183], v[110:111]
    v_pk_add_f32 v[188:189], v[188:189], v[112:113]
    v_pk_add_f32 v[190:191], v[190:191], v[114:115]
    v_pk_add_f32 v[196:197], v[196:197], v[116:117]
    v_pk_add_f32 v[198:199], v[198:199], v[118:119]
    s_mov_b32 s90, 0
    s_branch L_xw_cw_77_c
L_xw_cw_77:
    ds_read_u8 v250, v248 offset:80
    s_add_u32 s90, s90, 1
    s_cmp_gt_u32 s90, 1600000
    s_cbranch_scc1 L_xw_cw_77_out
L_xw_cw_77_c:
    s_waitcnt lgkmcnt(0)
    v_cmp_gt_u32 vcc, 41, v250
    s_and_b32 s37, vcc_lo, s30
    s_cbranch_scc1 L_xw_cw_77
L_xw_cw_77_out:
    ds_read_b128 v[204:207], v55 offset:0
    ds_read_b128 v[208:211], v55 offset:1024
    ds_read_b128 v[212:215], v55 offset:2048
    ds_read_b128 v[216:219], v55 offset:3072
    ds_read_b128 v[220:223], v55 offset:4096
    ds_write_b8 v249, v251 offset:68
    s_waitcnt lgkmcnt(5)
    v_pk_add_f32 v[204:205], v[204:205], v[164:165]
    v_pk_add_f32 v[206:207], v[206:207], v[166:167]
    v_cvt_pk_bf16_f32 v12, v204, v205
    v_cvt_pk_bf16_f32 v13, v206, v207
    s_waitcnt lgkmcnt(4)
    v_pk_add_f32 v[208:209], v[208:209], v[172:173]
    v_pk_add_f32 v[210:211], v[210:211], v[174:175]
    v_cvt_pk_bf16_f32 v14, v208, v209
    v_cvt_pk_bf16_f32 v15, v210, v211
    s_waitcnt lgkmcnt(3)
    v_pk_add_f32 v[212:213], v[212:213], v[180:181]
    v_pk_add_f32 v[214:215], v[214:215], v[182:183]
    v_cvt_pk_bf16_f32 v16, v212, v213
    v_cvt_pk_bf16_f32 v17, v214, v215
    s_waitcnt lgkmcnt(2)
    v_pk_add_f32 v[216:217], v[216:217], v[188:189]
    v_pk_add_f32 v[218:219], v[218:219], v[190:191]
    v_cvt_pk_bf16_f32 v18, v216, v217
    v_cvt_pk_bf16_f32 v19, v218, v219
    s_waitcnt lgkmcnt(1)
    v_pk_add_f32 v[220:221], v[220:221], v[196:197]
    v_pk_add_f32 v[222:223], v[222:223], v[198:199]
    v_cvt_pk_bf16_f32 v20, v220, v221
    v_cvt_pk_bf16_f32 v21, v222, v223
    s_cmp_eq_u32 s23, 1
    s_cbranch_scc1 L_final_cw_78
    s_cmp_lg_u32 s22, 0
    s_cbranch_scc1 L_slow_cw_79
    buffer_store_dwordx4 v[12:15], v7, s[4:7], s60 offen
    buffer_store_dwordx4 v[16:19], v7, s[4:7], s60 offen offset:2048
    buffer_store_dwordx2 v[20:21], v49, s[4:7], s61 offen
    v_dot2_f32_bf16 v42, v12, v10, v42
    v_dot2_f32_bf16 v43, v12, v12, v43
    v_dot2_f32_bf16 v42, v13, v10, v42
    v_dot2_f32_bf16 v43, v13, v13, v43
    v_dot2_f32_bf16 v42, v14, v10, v42
    v_dot2_f32_bf16 v43, v14, v14, v43
    v_dot2_f32_bf16 v42, v15, v10, v42
    v_dot2_f32_bf16 v43, v15, v15, v43
    v_dot2_f32_bf16 v42, v16, v10, v42
    v_dot2_f32_bf16 v43, v16, v16, v43
    v_dot2_f32_bf16 v42, v17, v10, v42
    v_dot2_f32_bf16 v43, v17, v17, v43
    v_dot2_f32_bf16 v42, v18, v10, v42
    v_dot2_f32_bf16 v43, v18, v18, v43
    v_dot2_f32_bf16 v42, v19, v10, v42
    v_dot2_f32_bf16 v43, v19, v19, v43
    v_dot2_f32_bf16 v42, v20, v10, v42
    v_dot2_f32_bf16 v43, v20, v20, v43
    v_dot2_f32_bf16 v42, v21, v10, v42
    v_dot2_f32_bf16 v43, v21, v21, v43
    s_nop 2
    v_mov_b32 v10, v42
    v_mov_b32 v11, v43
    s_nop 1
    v_permlane32_swap_b32 v42, v10
    v_permlane32_swap_b32 v43, v11
    s_nop 0
    v_add_f32 v42, v42, v10
    v_add_f32 v43, v43, v11
    v_mov_b32 v10, v42
    v_mov_b32 v11, v43
    s_nop 1
    v_permlane16_swap_b32 v42, v10
    v_permlane16_swap_b32 v43, v11
    s_nop 0
    v_add_f32 v42, v42, v10
    v_add_f32 v43, v43, v11
    s_mov_b64 exec, 0xffff
    buffer_store_dwordx2 v[42:43], v2, s[4:7], s64 offen
    s_mov_b64 exec, -1
L_back_cw_80:
    s_mov_b32 s80, s65
    s_mov_b32 s81, s98
    s_add_u32 s21, s21, 5242880
    s_add_u32 s23, s23, 1
    s_add_u32 s95, s95, 16
    v_add_u32 v248, 64, v248
    v_add_u32 v249, 64, v249
    s_add_u32 s85, s85, 1
    s_add_u32 s86, s86, 2
    s_add_u32 s87, s87, 2
    s_branch L_cw_layer
L_hw_start:
    s_cmp_ge_u32 s70, 640
    s_cbranch_scc1 L_hw_nojob
    s_mov_b32 s40, s26
    s_mov_b32 s41, s27
    s_mov_b32 s42, 2457600
    s_mov_b32 s43, 0x00020000
    v_add_u32 v26, 80, v24
    v_add_u32 v27, 155, v24
    v_cmp_lt_u32 vcc, 4, v24
    s_nop 1
    v_cndmask_b32 v26, v26, v27, vcc
    v_subrev_u32 v27, 10, v24
    v_lshlrev_b32 v27, 2, v27
    s_mov_b32 s91, 0x413022
    v_lshrrev_b32 v27, v27, s91
    v_and_b32 v27, 15, v27
    v_cmp_lt_u32 vcc, 9, v24
    s_nop 1
    v_cndmask_b32 v26, v26, v27, vcc
    v_mul_u32_u24 v31, 3840, v25
    v_lshl_add_u32 v31, v26, 4, v31
    s_and_b32 s58, s70, 15
    s_lshr_b32 s59, s70, 4
    s_mul_i32 s56, s59, 61440
    s_mul_i32 s60, s58, 80
    s_add_u32 s56, s56, s60
    s_lshl_b32 s61, s73, 12
    s_add_u32 s61, s61, 114560
    s_add_u32 m0, s61, 0
    s_nop 0
    buffer_load_dwordx4 v31, s[40:43], s56 offen lds
    s_add_u32 s56, s56, 15360
    s_add_u32 m0, s61, 1024
    s_nop 0
    buffer_load_dwordx4 v31, s[40:43], s56 offen lds
    s_add_u32 s56, s56, 15360
    s_add_u32 m0, s61, 2048
    s_nop 0
    buffer_load_dwordx4 v31, s[40:43], s56 offen lds
    s_add_u32 s56, s56, 15360
    s_add_u32 m0, s61, 3072
    s_nop 0
    buffer_load_dwordx4 v31, s[40:43], s56 offen lds
    s_add_u32 s56, s56, 15360
    s_mul_i32 s55, s58, 155648
    s_add_u32 s55, s55, 22282240
    s_lshr_b32 s57, s59, 1
    s_and_b32 s60, s59, 1
    s_mul_i32 s63, s60, 384
    s_mul_i32 s53, s57, 1536
    s_add_u32 s63, s63, s53
    s_add_u32 s63, s63, s55
    s_add_u32 s63, s63, 81920
    s_lshl_b32 s60, s60, 9
    s_add_u32 s55, s55, s60
    s_lshl_b32 s53, s57, 11
    s_add_u32 s53, s53, s55
    s_add_u32 s53, s53, 112640
    s_lshl_b32 s57, s57, 12
    s_add_u32 s55, s55, s57
    v_bfe_u32 v26, v1, 4, 1
    v_and_b32 v27, 15, v1
    v_lshlrev_b32 v7, 11, v26
    v_lshl_add_u32 v7, v27, 4, v7
    v_lshl_add_u32 v7, v5, 3, v7
    v_lshlrev_b32 v47, 10, v5
    v_lshl_add_u32 v47, v26, 8, v47
    v_lshl_add_u32 v47, v27, 4, v47
    v_add_u32 v7, s61, v7
    v_subrev_u32 v34, 4, v27
    v_cmp_gt_u32 vcc, 12, v27
    v_mul_u32_u24 v35, 768, v5
    v_mul_u32_u24 v36, 192, v26
    v_cndmask_b32 v34, v34, v27, vcc
    v_lshlrev_b32 v34, 4, v34
    v_add3_u32 v34, v34, v35, v36
    s_waitcnt vmcnt(0)
    ds_read_b64_tr_b16 v[48:49], v7 offset:0
    ds_read_b64_tr_b16 v[50:51], v7 offset:1024
    ds_read_b64_tr_b16 v[52:53], v7 offset:256
    ds_read_b64_tr_b16 v[54:55], v7 offset:1280
    ds_read_b64_tr_b16 v[56:57], v7 offset:512
    ds_read_b64_tr_b16 v[58:59], v7 offset:1536
    ds_read_b64_tr_b16 v[60:61], v7 offset:768
    ds_read_b64_tr_b16 v[62:63], v7 offset:1792
    s_waitcnt lgkmcnt(6)
    buffer_store_dwordx4 v[48:51], v47, s[4:7], s55 offen offset:0 sc1
    s_waitcnt lgkmcnt(4)
    buffer_store_dwordx4 v[52:55], v47, s[4:7], s55 offen offset:2048 sc1
    s_waitcnt lgkmcnt(2)
    buffer_store_dwordx4 v[56:59], v34, s[4:7], s63 offen sc1
    s_waitcnt lgkmcnt(0)
    buffer_store_dwordx4 v[60:63], v47, s[4:7], s53 offen sc1
    s_mul_i32 s62, s58, 160
    s_add_u32 s62, s62, s59
    s_lshl_b32 s62, s62, 7
    s_add_u32 s62, s62, 31686656
    v_mov_b32 v64, 0
    v_mov_b32 v65, 0
    v_mov_b32 v66, 0
    v_mov_b32 v67, 0
    v_dot2_f32_bf16 v64, v48, v40, v64
    v_dot2_f32_bf16 v65, v52, v40, v65
    v_dot2_f32_bf16 v66, v56, v40, v66
    v_dot2_f32_bf16 v67, v60, v40, v67
    v_dot2_f32_bf16 v64, v49, v40, v64
    v_dot2_f32_bf16 v65, v53, v40, v65
    v_dot2_f32_bf16 v66, v57, v40, v66
    v_dot2_f32_bf16 v67, v61, v40, v67
    v_dot2_f32_bf16 v64, v50, v40, v64
    v_dot2_f32_bf16 v65, v54, v40, v65
    v_dot2_f32_bf16 v66, v58, v40, v66
    v_dot2_f32_bf16 v67, v62, v40, v67
    v_dot2_f32_bf16 v64, v51, v40, v64
    v_dot2_f32_bf16 v65, v55, v40, v65
    v_dot2_f32_bf16 v66, v59, v40, v66
    v_dot2_f32_bf16 v67, v63, v40, v67
    s_nop 2
    v_mov_b32 v68, v64
    v_mov_b32 v69, v65
    v_mov_b32 v70, v66
    v_mov_b32 v71, v67
    s_nop 1
    v_permlane16_swap_b32 v64, v68
    v_permlane16_swap_b32 v65, v69
    v_permlane16_swap_b32 v66, v70
    v_permlane16_swap_b32 v67, v71
    s_nop 1
    v_add_f32 v64, v64, v68
    v_add_f32 v65, v65, v69
    v_add_f32 v66, v66, v70
    v_add_f32 v67, v67, v71
    s_mov_b32 s60, 0xffff
    s_mov_b32 s61, 0xffff
    v_cndmask_b32 v12, v65, v64, s[60:61]
    v_cndmask_b32 v13, v67, v66, s[60:61]
    v_and_b32 v14, 15, v1
    v_lshl_add_u32 v14, v5, 4, v14
    v_lshlrev_b32 v14, 2, v14
    v_bfe_u32 v68, v1, 4, 1
    v_mul_u32_u24 v68, 5120, v68
    v_add_u32 v14, v14, v68
    buffer_store_dword v12, v14, s[4:7], s62 offen sc1
    s_add_u32 s62, s62, 10240
    buffer_store_dword v13, v14, s[4:7], s62 offen sc1
    v_readfirstlane_b32 s96, v255
    s_mul_i32 s97, s96, 0x9e3779b1
    s_add_u32 s97, s97, 0x7f4a7c15
    s_add_u32 s85, s97, 1
    s_add_u32 s86, s97, 1
    s_add_u32 s87, s97, 2
    s_add_u32 s98, s97, 3
    s_xor_b32 s72, s96, 0x5bd1e995
    s_mul_i32 s72, s72, 0x85ebca6b
    s_lshl_b32 s56, s58, 6
    s_add_u32 s56, s56, s59
    s_lshl_b32 s56, s56, 7
    s_add_u32 s56, s56, 32636928
    v_mov_b32 v42, s85
    v_mov_b32 v43, s72
    s_waitcnt vmcnt(0)
    s_mov_b64 exec, 1
    buffer_store_dwordx2 v[42:43], off, s[4:7], s56 sc1
    s_mov_b64 exec, -1
L_hw_nojob:
    s_mov_b32 s64, s34
    s_mov_b32 s65, s35
    s_mov_b32 s66, 3072
    s_mov_b32 s67, 0x00020000
    s_lshl_b32 s71, s73, 10
    s_waitcnt vmcnt(0)
    v_mov_b32 v251, 1
    ds_write_b8 v249, v251 offset:72
    v_readfirstlane_b32 s96, v255
    s_mul_i32 s97, s96, 0x9e3779b1
    s_add_u32 s97, s97, 0x7f4a7c15
    s_add_u32 s85, s97, 1
    s_add_u32 s86, s97, 1
    s_add_u32 s87, s97, 2
    s_add_u32 s98, s97, 3
    s_xor_b32 s72, s96, 0x5bd1e995
    s_mul_i32 s72, s72, 0x85ebca6b
    s_lshl_b32 s26, s16, 2
    s_cmp_eq_u32 s73, 0
    s_cbranch_scc0 L_hw_r1
    v_min_u32 v169, 39, v1
    v_lshlrev_b32 v169, 7, v169
    s_lshl_b32 s24, s17, 13
    s_add_u32 s24, s24, 32636928
    s_mov_b32 s90, 0
L_hw_gq:
    buffer_load_dwordx2 v[252:253], v169, s[4:7], s24 offen sc1
    s_add_u32 s90, s90, 1
    s_cmp_gt_u32 s90, 200000
    s_cbranch_scc1 L_hw_gq_out
    s_waitcnt vmcnt(0)
    v_subrev_u32 v252, s85, v252
    v_xor_b32 v253, s72, v253
    v_or_b32 v253, v252, v253
    v_cmp_lt_u32 vcc, 7, v253
    s_cbranch_vccz L_hw_gq_out
    s_sleep 2
    s_branch L_hw_gq
L_hw_gq_out:
    s_mov_b32 s90, 0
L_spin_hw_1:
    ds_read_u8 v250, v248 offset:72
    s_add_u32 s90, s90, 1
    s_cmp_gt_u32 s90, 1600000
    s_cbranch_scc1 L_spin_hw_1_out
    s_sleep 1
    s_waitcnt lgkmcnt(0)
    v_cmp_gt_u32 vcc, 1, v250
    s_cbranch_vccnz L_spin_hw_1
L_spin_hw_1_out:
    s_waitcnt lgkmcnt(0)
    v_mov_b32 v252, 1
    ds_write_b8 v248, v252 offset:100
    s_branch L_hw_rj
L_hw_r1:
    s_cmp_eq_u32 s73, 1
    s_cbranch_scc0 L_hw_r2
    s_add_u32 s24, s74, 0
    buffer_load_dword v0, v4, s[4:7], s24 offen sc1
    s_add_u32 s24, s74, 4096
    buffer_load_dword v0, v4, s[4:7], s24 offen sc1
    s_lshl_b32 s25, s3, 12
    s_add_u32 s24, s25, 32342016
    buffer_load_dword v0, v4, s[4:7], s24 offen sc1
    s_branch L_hw_rj
L_hw_r2:
    s_cmp_eq_u32 s73, 3
    s_cbranch_scc0 L_hw_nohi
    s_lshl_b32 s24, s3, 5
    s_add_u32 s24, s24, s99
    s_lshl_b32 s24, s24, 7
    s_add_u32 s24, s24, 32899072
    s_add_u32 s27, s85, s79
    v_mov_b32 v252, s27
    v_mov_b32 v253, s72
    s_waitcnt vmcnt(0)
    s_mov_b64 exec, 1
    buffer_store_dwordx2 v[252:253], off, s[4:7], s24 sc1
    s_mov_b64 exec, -1
L_hw_nohi:
    s_branch L_hw_rj
    s_sub_u32 s25, s73, 2
    s_lshl_b32 s25, s25, 1
    s_add_u32 s26, s26, s25
    s_mul_i32 s27, s26, 98304
    s_mul_i32 s25, s17, 6144
    s_add_u32 s27, s27, s25
    s_add_u32 s24, s27, 5242880
    buffer_load_dword v0, v4, s[4:7], s24 offen sc1
    s_mov_b32 exec_hi, 0
    s_add_u32 s24, s27, 5246976
    buffer_load_dword v0, v4, s[4:7], s24 offen sc1
    s_mul_i32 s27, s26, 40960
    s_mul_i32 s25, s17, 2560
    s_add_u32 s27, s27, s25
    s_mov_b32 exec_hi, 0xff
    s_add_u32 s24, s27, 2621440
    buffer_load_dword v0, v4, s[4:7], s24 offen sc1
    s_mov_b32 exec_hi, -1
    s_add_u32 s26, s26, 1
    s_mul_i32 s27, s26, 98304
    s_mul_i32 s25, s17, 6144
    s_add_u32 s27, s27, s25
    s_add_u32 s24, s27, 5242880
    buffer_load_dword v0, v4, s[4:7], s24 offen sc1
    s_mov_b32 exec_hi, 0
    s_add_u32 s24, s27, 5246976
    buffer_load_dword v0, v4, s[4:7], s24 offen sc1
    s_mul_i32 s27, s26, 40960
    s_mul_i32 s25, s17, 2560
    s_add_u32 s27, s27, s25
    s_mov_b32 exec_hi, 0xff
    s_add_u32 s24, s27, 2621440
    buffer_load_dword v0, v4, s[4:7], s24 offen sc1
    s_mov_b32 exec_hi, -1
    s_add_u32 s26, s26, 1
L_hw_rj:
    v_add_u32 v5, s71, v2
    v_add_u32 v6, 0xf000, v5
    v_add_u32 v7, 0x1e000, v5
    s_mul_i32 s26, s17, 155648
    s_add_u32 s26, s26, 22282240
    s_add_u32 s26, s26, s71
    s_mov_b32 s90, 0
L_spin_hw_2:
    ds_read_u8 v250, v248 offset:100
    s_add_u32 s90, s90, 1
    s_cmp_gt_u32 s90, 1600000
    s_cbranch_scc1 L_spin_hw_2_out
    s_sleep 1
    s_waitcnt lgkmcnt(0)
    v_cmp_gt_u32 vcc, 1, v250
    s_cbranch_vccnz L_spin_hw_2
L_spin_hw_2_out:
    s_waitcnt lgkmcnt(0)
    s_add_u32 s30, s26, 0
    buffer_load_dwordx4 v[8:11], v2, s[4:7], s30 offen sc1
    s_add_u32 s30, s26, 4096
    buffer_load_dwordx4 v[12:15], v2, s[4:7], s30 offen sc1
    s_add_u32 s30, s26, 8192
    buffer_load_dwordx4 v[16:19], v2, s[4:7], s30 offen sc1
    s_add_u32 s30, s26, 12288
    buffer_load_dwordx4 v[20:23], v2, s[4:7], s30 offen sc1
    s_add_u32 s30, s26, 16384
    buffer_load_dwordx4 v[24:27], v2, s[4:7], s30 offen sc1
    s_add_u32 s30, s26, 20480
    buffer_load_dwordx4 v[28:31], v2, s[4:7], s30 offen sc1
    s_add_u32 s30, s26, 24576
    buffer_load_dwordx4 v[32:35], v2, s[4:7], s30 offen sc1
    s_add_u32 s30, s26, 28672
    buffer_load_dwordx4 v[36:39], v2, s[4:7], s30 offen sc1
    s_add_u32 s30, s26, 32768
    buffer_load_dwordx4 v[40:43], v2, s[4:7], s30 offen sc1
    v_and_b32 v172, 31, v1
    v_lshlrev_b32 v172, 2, v172
    v_lshrrev_b32 v174, 5, v1
    v_lshl_add_u32 v172, v174, 7, v172
    s_mul_i32 s25, s17, 20480
    s_mul_i32 s27, s73, 5120
    s_add_u32 s25, s25, s27
    s_add_u32 s25, s25, 31686656
    buffer_load_dword v200, v172, s[4:7], s25 offen offset:0 sc1
    buffer_load_dword v201, v172, s[4:7], s25 offen offset:256 sc1
    buffer_load_dword v202, v172, s[4:7], s25 offen offset:512 sc1
    buffer_load_dword v203, v172, s[4:7], s25 offen offset:768 sc1
    buffer_load_dword v204, v172, s[4:7], s25 offen offset:1024 sc1
    buffer_load_dword v205, v172, s[4:7], s25 offen offset:1280 sc1
    buffer_load_dword v206, v172, s[4:7], s25 offen offset:1536 sc1
    buffer_load_dword v207, v172, s[4:7], s25 offen offset:1792 sc1
    buffer_load_dword v208, v172, s[4:7], s25 offen offset:2048 sc1
    buffer_load_dword v209, v172, s[4:7], s25 offen offset:2304 sc1
    buffer_load_dword v210, v172, s[4:7], s25 offen offset:2560 sc1
    buffer_load_dword v211, v172, s[4:7], s25 offen offset:2816 sc1
    buffer_load_dword v212, v172, s[4:7], s25 offen offset:3072 sc1
    buffer_load_dword v213, v172, s[4:7], s25 offen offset:3328 sc1
    buffer_load_dword v214, v172, s[4:7], s25 offen offset:3584 sc1
    buffer_load_dword v215, v172, s[4:7], s25 offen offset:3840 sc1
    s_add_u32 s25, s25, 4096
    buffer_load_dword v216, v172, s[4:7], s25 offen offset:0 sc1
    buffer_load_dword v217, v172, s[4:7], s25 offen offset:256 sc1
    buffer_load_dword v218, v172, s[4:7], s25 offen offset:512 sc1
    buffer_load_dword v219, v172, s[4:7], s25 offen offset:768 sc1
    s_waitcnt vmcnt(28)
    ds_write_b128 v5, v[8:11] offset:0
    s_add_u32 s30, s26, 36864
    buffer_load_dwordx4 v[44:47], v2, s[4:7], s30 offen sc1
    s_waitcnt vmcnt(28)
    ds_write_b128 v5, v[12:15] offset:4096
    s_add_u32 s30, s26, 40960
    buffer_load_dwordx4 v[48:51], v2, s[4:7], s30 offen sc1
    s_waitcnt vmcnt(28)
    ds_write_b128 v5, v[16:19] offset:8192
    s_add_u32 s30, s26, 45056
    buffer_load_dwordx4 v[52:55], v2, s[4:7], s30 offen sc1
    s_waitcnt vmcnt(28)
    ds_write_b128 v5, v[20:23] offset:12288
    v_mov_b32 v251, 1
    ds_write_b8 v249, v251 offset:64
    s_add_u32 s30, s26, 49152
    buffer_load_dwordx4 v[56:59], v2, s[4:7], s30 offen sc1
    s_waitcnt vmcnt(28)
    ds_write_b128 v5, v[24:27] offset:16384
    s_add_u32 s30, s26, 53248
    buffer_load_dwordx4 v[60:63], v2, s[4:7], s30 offen sc1
    s_waitcnt vmcnt(28)
    ds_write_b128 v5, v[28:31] offset:20480
    s_add_u32 s30, s26, 57344
    buffer_load_dwordx4 v[64:67], v2, s[4:7], s30 offen sc1
    s_waitcnt vmcnt(28)
    ds_write_b128 v5, v[32:35] offset:24576
    s_add_u32 s30, s26, 61440
    buffer_load_dwordx4 v[68:71], v2, s[4:7], s30 offen sc1
    s_waitcnt vmcnt(28)
    ds_write_b128 v5, v[36:39] offset:28672
    v_mov_b32 v251, 2
    ds_write_b8 v249, v251 offset:64
    s_add_u32 s30, s26, 65536
    buffer_load_dwordx4 v[72:75], v2, s[4:7], s30 offen sc1
    s_waitcnt vmcnt(28)
    ds_write_b128 v5, v[40:43] offset:32768
    s_add_u32 s30, s26, 69632
    buffer_load_dwordx4 v[76:79], v2, s[4:7], s30 offen sc1
    s_waitcnt vmcnt(8)
    ds_write_b128 v5, v[44:47] offset:36864
    s_add_u32 s30, s26, 73728
    buffer_load_dwordx4 v[80:83], v2, s[4:7], s30 offen sc1
    s_waitcnt vmcnt(8)
    ds_write_b128 v5, v[48:51] offset:40960
    s_add_u32 s30, s26, 77824
    buffer_load_dwordx4 v[84:87], v2, s[4:7], s30 offen sc1
    s_waitcnt vmcnt(8)
    ds_write_b128 v5, v[52:55] offset:45056
    v_mov_b32 v251, 3
    ds_write_b8 v249, v251 offset:64
    s_add_u32 s30, s26, 81920
    buffer_load_dwordx4 v[88:91], v2, s[4:7], s30 offen sc1
    s_waitcnt vmcnt(8)
    ds_write_b128 v5, v[56:59] offset:49152
    s_cmp_lg_u32 s23, 0
    s_cbranch_scc1 L_hw_nolate
    s_cmp_ge_u32 s73, 2
    s_cselect_b32 s25, 47, 19
    v_min_u32 v169, s25, v1
    s_cmp_eq_u32 s73, 1
    s_cselect_b32 s25, 11, 10
    v_lshlrev_b32 v169, s25, v169
    s_add_u32 s24, s20, 480
    s_cmp_eq_u32 s73, 1
    s_cselect_b32 s24, s17, s24
    s_add_u32 s25, s20, 320
    s_cmp_eq_u32 s73, 0
    s_cselect_b32 s24, s25, s24
    s_lshl_b32 s24, s24, 7
    s_add_u32 s24, s24, 32768000
    v_and_b32 v170, 31, v1
    v_lshlrev_b32 v170, 7, v170
    s_lshl_b32 s25, s3, 12
    s_add_u32 s25, s25, 32899072
    s_cmp_eq_u32 s73, 3
    s_cselect_b32 s24, s25, s24
    s_cselect_b64 vcc, -1, 0
    v_cndmask_b32 v169, v169, v170, vcc
    s_mov_b32 s90, 0
L_hw_gg:
    buffer_load_dwordx2 v[252:253], v169, s[4:7], s24 offen sc1
    s_add_u32 s90, s90, 1
    s_cmp_gt_u32 s90, 200000
    s_cbranch_scc1 L_hw_gg_out
    s_waitcnt vmcnt(0)
    v_subrev_u32 v252, s85, v252
    v_xor_b32 v253, s72, v253
    v_or_b32 v253, v252, v253
    v_cmp_lt_u32 vcc, 7, v253
    s_cbranch_vccz L_hw_gg_out
    s_sleep 2
    s_branch L_hw_gg
L_hw_gg_out:
    s_cmp_lg_u32 s73, 3
    s_cbranch_scc1 L_hw_nopur
    v_cmp_ne_u32 vcc, s79, v252
    s_or_b64 vcc, vcc, vcc
    s_cselect_b32 s22, 1, 0
    v_mov_b32 v170, s22
    ds_write_b8 v248, v170 offset:112
    ds_write_b8 v248, v170 offset:176
L_hw_nopur:
    v_mov_b32 v251, 2
    ds_write_b8 v249, v251 offset:72
    s_mov_b32 s90, 0
L_spin_hw_3:
    ds_read_u8 v250, v248 offset:72
    s_add_u32 s90, s90, 1
    s_cmp_gt_u32 s90, 1600000
    s_cbranch_scc1 L_spin_hw_3_out
    s_sleep 1
    s_waitcnt lgkmcnt(0)
    v_cmp_gt_u32 vcc, 2, v250
    s_cbranch_vccnz L_spin_hw_3
L_spin_hw_3_out:
    s_waitcnt lgkmcnt(0)
    v_and_b32 v172, 31, v1
    v_lshlrev_b32 v172, 2, v172
    v_lshrrev_b32 v174, 5, v1
    v_lshl_add_u32 v172, v174, 7, v172
    s_mul_i32 s25, s17, 20480
    s_mul_i32 s27, s73, 5120
    s_add_u32 s25, s25, s27
    s_add_u32 s25, s25, 32014336
    buffer_load_dword v220, v172, s[4:7], s25 offen offset:0 sc1
    buffer_load_dword v221, v172, s[4:7], s25 offen offset:256 sc1
    buffer_load_dword v222, v172, s[4:7], s25 offen offset:512 sc1
    buffer_load_dword v223, v172, s[4:7], s25 offen offset:768 sc1
    buffer_load_dword v224, v172, s[4:7], s25 offen offset:1024 sc1
    buffer_load_dword v225, v172, s[4:7], s25 offen offset:1280 sc1
    buffer_load_dword v226, v172, s[4:7], s25 offen offset:1536 sc1
    buffer_load_dword v227, v172, s[4:7], s25 offen offset:1792 sc1
    buffer_load_dword v228, v172, s[4:7], s25 offen offset:2048 sc1
    buffer_load_dword v229, v172, s[4:7], s25 offen offset:2304 sc1
    v_bfe_u32 v173, v1, 2, 2
    s_lshl_b32 s25, s73, 2
    v_add_u32 v173, s25, v173
    v_bfe_u32 v174, v1, 4, 1
    v_lshl_add_u32 v173, v173, 1, v174
    v_and_b32 v174, 3, v1
    v_lshl_add_u32 v173, v173, 2, v174
    v_lshlrev_b32 v173, 1, v173
    s_mul_i32 s27, s17, 192
    buffer_load_ushort v175, v173, s[64:67], s27 offen
L_hw_nolate:
    s_add_u32 s30, s26, 86016
    buffer_load_dwordx4 v[92:95], v2, s[4:7], s30 offen sc1
    s_waitcnt vmcnt(18)
    ds_write_b128 v5, v[60:63] offset:53248
    s_add_u32 s30, s26, 90112
    buffer_load_dwordx4 v[96:99], v2, s[4:7], s30 offen sc1
    s_waitcnt vmcnt(18)
    ds_write_b128 v5, v[64:67] offset:57344
    v_mov_b32 v251, 4
    ds_write_b8 v249, v251 offset:64
    s_add_u32 s30, s26, 94208
    buffer_load_dwordx4 v[100:103], v2, s[4:7], s30 offen sc1
    s_waitcnt vmcnt(18)
    ds_write_b128 v6, v[68:71] offset:0
    s_add_u32 s30, s26, 98304
    buffer_load_dwordx4 v[104:107], v2, s[4:7], s30 offen sc1
    s_waitcnt vmcnt(18)
    ds_write_b128 v6, v[72:75] offset:4096
    s_add_u32 s30, s26, 102400
    buffer_load_dwordx4 v[108:111], v2, s[4:7], s30 offen sc1
    s_waitcnt vmcnt(18)
    ds_write_b128 v6, v[76:79] offset:8192
    s_add_u32 s30, s26, 106496
    buffer_load_dwordx4 v[112:115], v2, s[4:7], s30 offen sc1
    s_waitcnt vmcnt(18)
    s_mov_b32 s90, 0
L_spin_hw_4:
    ds_read_u8 v250, v248 offset:76
    s_add_u32 s90, s90, 1
    s_cmp_gt_u32 s90, 1600000
    s_cbranch_scc1 L_spin_hw_4_out
    s_sleep 1
    s_waitcnt lgkmcnt(0)
    v_cmp_gt_u32 vcc, 1, v250
    s_cbranch_vccnz L_spin_hw_4
L_spin_hw_4_out:
    s_waitcnt lgkmcnt(0)
    s_lshl_b32 s27, s73, 9
    v_add_u32 v192, s27, v2
    v_add_u32 v193, 153600, v192
    s_mov_b32 s60, -1
    s_mov_b32 s61, 0
    v_add_f32 v200, v200, v201
    v_add_f32 v200, v200, v202
    v_add_f32 v200, v200, v203
    v_add_f32 v200, v200, v204
    v_add_f32 v200, v200, v205
    v_add_f32 v200, v200, v206
    v_add_f32 v200, v200, v207
    v_add_f32 v200, v200, v208
    v_add_f32 v200, v200, v209
    v_add_f32 v200, v200, v210
    v_add_f32 v200, v200, v211
    v_add_f32 v200, v200, v212
    v_add_f32 v200, v200, v213
    v_add_f32 v200, v200, v214
    v_add_f32 v200, v200, v215
    v_add_f32 v200, v200, v216
    v_add_f32 v200, v200, v217
    v_add_f32 v200, v200, v218
    v_add_f32 v200, v200, v219
    v_mov_b32 v201, v200
    s_nop 1
    v_permlane32_swap_b32 v200, v201
    s_nop 1
    v_add_f32 v200, v200, v201
    v_cvt_pk_bf16_f32 v201, v200, v200
    v_and_b32 v202, 0xffff0000, v201
    v_sub_f32 v202, v200, v202
    v_cvt_pk_bf16_f32 v204, v200, v202
    v_and_b32 v205, 0xffff, v201
    v_mov_b32 v206, 0
    v_mov_b32 v207, 0
    v_cndmask_b32 v204, 0, v204, s[60:61]
    v_cndmask_b32 v205, 0, v205, s[60:61]
    s_mov_b32 exec_hi, 0
    buffer_store_dwordx4 v[204:207], v192, s[4:7], s74 offen
    ds_write_b128 v193, v[204:207]
    s_mov_b32 exec_hi, -1
    ds_write_b128 v6, v[80:83] offset:12288
    v_mov_b32 v251, 5
    ds_write_b8 v249, v251 offset:64
    s_add_u32 s30, s26, 110592
    buffer_load_dwordx4 v[116:119], v2, s[4:7], s30 offen sc1
    s_waitcnt vmcnt(18)
    ds_write_b128 v6, v[84:87] offset:16384
    s_add_u32 s30, s26, 114688
    buffer_load_dwordx4 v[120:123], v2, s[4:7], s30 offen sc1
    s_waitcnt vmcnt(18)
    ds_write_b128 v6, v[88:91] offset:20480
    s_add_u32 s30, s26, 118784
    buffer_load_dwordx4 v[124:127], v2, s[4:7], s30 offen sc1
    s_waitcnt vmcnt(8)
    ds_write_b128 v6, v[92:95] offset:24576
    s_add_u32 s30, s26, 122880
    buffer_load_dwordx4 v[128:131], v2, s[4:7], s30 offen sc1
    s_waitcnt vmcnt(8)
    ds_write_b128 v6, v[96:99] offset:28672
    v_mov_b32 v251, 6
    ds_write_b8 v249, v251 offset:64
    s_add_u32 s30, s26, 126976
    buffer_load_dwordx4 v[132:135], v2, s[4:7], s30 offen sc1
    s_waitcnt vmcnt(8)
    ds_write_b128 v6, v[100:103] offset:32768
    s_add_u32 s30, s26, 131072
    buffer_load_dwordx4 v[136:139], v2, s[4:7], s30 offen sc1
    s_waitcnt vmcnt(8)
    ds_write_b128 v6, v[104:107] offset:36864
    s_add_u32 s30, s26, 135168
    buffer_load_dwordx4 v[140:143], v2, s[4:7], s30 offen sc1
    s_waitcnt vmcnt(8)
    ds_write_b128 v6, v[108:111] offset:40960
    s_add_u32 s30, s26, 139264
    buffer_load_dwordx4 v[144:147], v2, s[4:7], s30 offen sc1
    s_waitcnt vmcnt(8)
    ds_write_b128 v6, v[112:115] offset:45056
    v_mov_b32 v251, 7
    ds_write_b8 v249, v251 offset:64
    s_add_u32 s30, s26, 143360
    buffer_load_dwordx4 v[148:151], v2, s[4:7], s30 offen sc1
    s_waitcnt vmcnt(8)
    ds_write_b128 v6, v[116:119] offset:49152
    s_add_u32 s30, s26, 147456
    buffer_load_dwordx4 v[152:155], v2, s[4:7], s30 offen sc1
    s_waitcnt vmcnt(8)
    ds_write_b128 v6, v[120:123] offset:53248
    s_add_u32 s30, s26, 151552
    buffer_load_dwordx4 v[156:159], v2, s[4:7], s30 offen sc1
    s_waitcnt vmcnt(8)
    ds_write_b128 v6, v[124:127] offset:57344
    v_mov_b32 v251, 8
    ds_write_b8 v249, v251 offset:64
    s_waitcnt vmcnt(7)
    ds_write_b128 v7, v[128:131] offset:0
    s_waitcnt vmcnt(6)
    ds_write_b128 v7, v[132:135] offset:4096
    s_waitcnt vmcnt(5)
    ds_write_b128 v7, v[136:139] offset:8192
    s_waitcnt vmcnt(4)
    ds_write_b128 v7, v[140:143] offset:12288
    v_mov_b32 v251, 9
    ds_write_b8 v249, v251 offset:64
    s_waitcnt vmcnt(3)
    ds_write_b128 v7, v[144:147] offset:16384
    s_waitcnt vmcnt(2)
    ds_write_b128 v7, v[148:151] offset:20480
    s_waitcnt vmcnt(1)
    ds_write_b128 v7, v[152:155] offset:24576
    s_waitcnt vmcnt(0)
    s_cmp_ge_u32 s73, 2
    s_cbranch_scc1 L_q37_hw_5
    ds_write_b128 v7, v[156:159] offset:28672
L_q37_hw_5:
    v_mov_b32 v251, 10
    ds_write_b8 v249, v251 offset:64
    s_waitcnt vmcnt(0)
    s_mov_b32 s60, -1
    s_mov_b32 s61, 0
    v_add_f32 v220, v220, v221
    v_add_f32 v220, v220, v222
    v_add_f32 v220, v220, v223
    v_add_f32 v220, v220, v224
    v_add_f32 v220, v220, v225
    v_add_f32 v220, v220, v226
    v_add_f32 v220, v220, v227
    v_add_f32 v220, v220, v228
    v_add_f32 v220, v220, v229
    v_mov_b32 v221, v220
    s_nop 1
    v_permlane32_swap_b32 v220, v221
    s_nop 1
    v_add_f32 v220, v220, v221
    v_cvt_pk_bf16_f32 v221, v220, v220
    v_and_b32 v222, 0xffff0000, v221
    v_sub_f32 v222, v220, v222
    v_cvt_pk_bf16_f32 v224, v220, v222
    v_and_b32 v225, 0xffff, v221
    v_lshl_or_b32 v225, v175, 16, v225
    v_cndmask_b32 v226, 0, v175, s[60:61]
    v_mov_b32 v227, 0
    v_cndmask_b32 v224, 0, v224, s[60:61]
    v_cndmask_b32 v225, 0, v225, s[60:61]
    s_lshl_b32 s27, s73, 9
    v_add_u32 v193, s27, v2
    s_add_u32 s27, s74, 4096
    s_mov_b32 exec_hi, 0
    buffer_store_dwordx4 v[224:227], v193, s[4:7], s27 offen
    s_mov_b32 exec_hi, -1
    s_mul_i32 s26, s73, 3072
    s_add_u32 s70, s76, s26
    s_add_u32 s70, s70, 73728
    s_add_u32 s26, s70, 0
    buffer_load_dwordx4 v[160:163], v2, s[4:7], s26 offen offset:0 sc1
    buffer_load_dwordx4 v[164:167], v2, s[4:7], s26 offen offset:1024 sc1
    buffer_load_dwordx4 v[168:171], v2, s[4:7], s26 offen offset:2048 sc1
    s_add_u32 s26, s70, 12288
    buffer_load_dwordx4 v[172:175], v2, s[4:7], s26 offen offset:0 sc1
    buffer_load_dwordx4 v[176:179], v2, s[4:7], s26 offen offset:1024 sc1
    buffer_load_dwordx4 v[180:183], v2, s[4:7], s26 offen offset:2048 sc1
    s_branch L_hw_common
L_hw_layer1:
    v_add_u32 v5, s71, v2
    v_add_u32 v6, 0xf000, v5
    v_add_u32 v7, 0x1e000, v5
    s_lshl_b32 s25, s73, 9
    s_add_u32 m0, s25, 153600
    s_add_u32 s25, s25, s74
    s_mov_b32 exec_hi, 0
    buffer_load_dwordx4 v2, s[4:7], s25 offen sc1 lds
    s_mov_b32 exec_hi, -1
    s_mov_b32 s90, 0
L_spin_hw_6:
    ds_read_u8 v250, v248 offset:4
    s_add_u32 s90, s90, 1
    s_cmp_gt_u32 s90, 1600000
    s_cbranch_scc1 L_spin_hw_6_out
    s_sleep 1
    s_waitcnt lgkmcnt(0)
    v_cmp_gt_u32 vcc, 40, v250
    s_cbranch_vccnz L_spin_hw_6
L_spin_hw_6_out:
    s_waitcnt lgkmcnt(0)
    s_waitcnt vmcnt(0)
    ds_write_b128 v5, v[8:11] offset:0
    ds_write_b128 v5, v[12:15] offset:4096
    ds_write_b128 v5, v[16:19] offset:8192
    ds_write_b128 v5, v[20:23] offset:12288
    v_mov_b32 v251, 1
    ds_write_b8 v249, v251 offset:64
    ds_write_b128 v5, v[24:27] offset:16384
    ds_write_b128 v5, v[28:31] offset:20480
    ds_write_b128 v5, v[32:35] offset:24576
    ds_write_b128 v5, v[36:39] offset:28672
    v_mov_b32 v251, 2
    ds_write_b8 v249, v251 offset:64
    s_waitcnt lgkmcnt(4)
    ds_write_b128 v5, v[40:43] offset:32768
    ds_write_b128 v5, v[44:47] offset:36864
    ds_write_b128 v5, v[48:51] offset:40960
    ds_write_b128 v5, v[52:55] offset:45056
    v_mov_b32 v251, 3
    ds_write_b8 v249, v251 offset:64
    ds_write_b128 v5, v[56:59] offset:49152
    ds_write_b128 v5, v[60:63] offset:53248
    ds_write_b128 v5, v[64:67] offset:57344
    v_mov_b32 v251, 4
    ds_write_b8 v249, v251 offset:64
    ds_write_b128 v6, v[68:71] offset:0
    s_waitcnt lgkmcnt(4)
    ds_write_b128 v6, v[72:75] offset:4096
    ds_write_b128 v6, v[76:79] offset:8192
    ds_write_b128 v6, v[80:83] offset:12288
    v_mov_b32 v251, 5
    ds_write_b8 v249, v251 offset:64
    ds_write_b128 v6, v[84:87] offset:16384
    ds_write_b128 v6, v[88:91] offset:20480
    ds_write_b128 v6, v[92:95] offset:24576
    ds_write_b128 v6, v[96:99] offset:28672
    v_mov_b32 v251, 6
    ds_write_b8 v249, v251 offset:64
    ds_write_b128 v6, v[100:103] offset:32768
    s_waitcnt lgkmcnt(4)
    ds_write_b128 v6, v[104:107] offset:36864
    ds_write_b128 v6, v[108:111] offset:40960
    ds_write_b128 v6, v[112:115] offset:45056
    v_mov_b32 v251, 7
    ds_write_b8 v249, v251 offset:64
    ds_write_b128 v6, v[116:119] offset:49152
    ds_write_b128 v6, v[120:123] offset:53248
    ds_write_b128 v6, v[124:127] offset:57344
    v_mov_b32 v251, 8
    ds_write_b8 v249, v251 offset:64
    ds_write_b128 v7, v[128:131] offset:0
    ds_write_b128 v7, v[132:135] offset:4096
    s_waitcnt lgkmcnt(4)
    s_mov_b32 s90, 0
L_spin_hw_7:
    ds_read_u8 v250, v248 offset:4
    s_add_u32 s90, s90, 1
    s_cmp_gt_u32 s90, 1600000
    s_cbranch_scc1 L_spin_hw_7_out
    s_sleep 1
    s_waitcnt lgkmcnt(0)
    v_cmp_gt_u32 vcc, 41, v250
    s_cbranch_vccnz L_spin_hw_7
L_spin_hw_7_out:
    s_waitcnt lgkmcnt(0)
    ds_write_b128 v7, v[136:139] offset:8192
    ds_write_b128 v7, v[140:143] offset:12288
    v_mov_b32 v251, 9
    ds_write_b8 v249, v251 offset:64
    ds_write_b128 v7, v[144:147] offset:16384
    ds_write_b128 v7, v[148:151] offset:20480
    ds_write_b128 v7, v[152:155] offset:24576
    s_cmp_ge_u32 s73, 2
    s_cbranch_scc1 L_q37_hw_8
    ds_write_b128 v7, v[156:159] offset:28672
L_q37_hw_8:
    v_mov_b32 v251, 10
    ds_write_b8 v249, v251 offset:64
    s_xor_b32 s24, s18, 4
    s_or_b32 s24, s2, s24
    s_cmp_lg_u32 s24, 0
    s_cbranch_scc1 L_noep
    v_lshlrev_b32 v5, 7, v1
    s_add_u32 s25, s97, 1
    s_mov_b32 s24, 32899072
    s_mov_b32 s90, 0
L_ep_poll0:
    buffer_load_dwordx2 v[252:253], v5, s[4:7], s24 offen sc1
    s_add_u32 s90, s90, 1
    s_cmp_gt_u32 s90, 200000
    s_cbranch_scc1 L_ep_out0
    s_waitcnt vmcnt(0)
    v_subrev_u32 v252, s25, v252
    v_xor_b32 v253, s72, v253
    v_or_b32 v253, v252, v253
    v_cmp_lt_u32 vcc, 7, v253
    s_cbranch_vccnz L_ep_poll0
L_ep_out0:
    s_mov_b32 s24, 32907264
    s_mov_b32 s90, 0
L_ep_poll1:
    buffer_load_dwordx2 v[252:253], v5, s[4:7], s24 offen sc1
    s_add_u32 s90, s90, 1
    s_cmp_gt_u32 s90, 200000
    s_cbranch_scc1 L_ep_out1
    s_waitcnt vmcnt(0)
    v_subrev_u32 v252, s25, v252
    v_xor_b32 v253, s72, v253
    v_or_b32 v253, v252, v253
    v_cmp_lt_u32 vcc, 7, v253
    s_cbranch_vccnz L_ep_poll1
L_ep_out1:
    s_mov_b32 s24, 32915456
    s_mov_b32 s90, 0
L_ep_poll2:
    buffer_load_dwordx2 v[252:253], v5, s[4:7], s24 offen sc1
    s_add_u32 s90, s90, 1
    s_cmp_gt_u32 s90, 200000
    s_cbranch_scc1 L_ep_out2
    s_waitcnt vmcnt(0)
    v_subrev_u32 v252, s25, v252
    v_xor_b32 v253, s72, v253
    v_or_b32 v253, v252, v253
    v_cmp_lt_u32 vcc, 7, v253
    s_cbranch_vccnz L_ep_poll2
L_ep_out2:
    s_mov_b32 s24, 32923648
    s_mov_b32 s90, 0
L_ep_poll3:
    buffer_load_dwordx2 v[252:253], v5, s[4:7], s24 offen sc1
    s_add_u32 s90, s90, 1
    s_cmp_gt_u32 s90, 200000
    s_cbranch_scc1 L_ep_out3
    s_waitcnt vmcnt(0)
    v_subrev_u32 v252, s25, v252
    v_xor_b32 v253, s72, v253
    v_or_b32 v253, v252, v253
    v_cmp_lt_u32 vcc, 7, v253
    s_cbranch_vccnz L_ep_poll3
L_ep_out3:
    s_add_u32 s96, s96, 1
    s_mov_b32 s24, 32931840
    v_mov_b32 v252, s96
    v_mov_b32 v253, s72
    s_waitcnt vmcnt(0)
    s_mov_b64 exec, 1
    buffer_store_dwordx2 v[252:253], off, s[4:7], s24 sc1
    s_mov_b64 exec, -1
L_noep:
L_hw_common:
    s_lshl_b32 s26, s73, 1
    s_lshl_b32 s27, s16, 2
    s_add_u32 s27, s27, s26
    s_sub_i32 s27, s27, 8
    s_mul_i32 s30, s26, 2576
    s_add_u32 s30, s30, 34176
    s_mul_i32 s68, s26, 2848
    v_mul_u32_u24 v5, 2576, v1
    v_add_u32 v5, s30, v5
    v_mul_u32_u24 v0, 2848, v1
    v_add_u32 v0, s68, v0
    s_cmp_lt_i32 s27, 0
    s_cselect_b32 s24, 0xf149, 0
    v_mov_b32 v252, s24
    v_mov_b32 v253, 0
    v_mov_b32 v254, s24
    v_mov_b32 v255, 0
    v_mov_b32 v6, 0x3f803f80
    v_mov_b32 v7, 0x3f803f80
    s_mov_b32 s90, 0
L_spin_hw_9:
    ds_read_u8 v250, v248 offset:68
    s_add_u32 s90, s90, 1
    s_cmp_gt_u32 s90, 1600000
    s_cbranch_scc1 L_spin_hw_9_out
    s_sleep 1
    s_waitcnt lgkmcnt(0)
    v_cmp_gt_u32 vcc, 6, v250
    s_cbranch_vccnz L_spin_hw_9
L_spin_hw_9_out:
    s_waitcnt lgkmcnt(0)
    s_mov_b64 exec, 3
    ds_write_b128 v5, v[252:255] offset:2560
    ds_write_b64 v0, v[6:7] offset:2560
    ds_write_b64 v0, v[6:7] offset:2816
    s_mov_b64 exec, -1
    s_cmp_lt_i32 s27, 0
    s_cbranch_scc1 L_hw_neg
    s_lshl_b32 s28, s27, 4
    s_add_u32 s28, s28, s17
    s_lshl_b32 s29, s28, 7
    s_add_u32 s29, s29, 32374784
    s_mul_i32 s28, s28, 5120
    s_add_u32 s28, s28, s21
    s_add_u32 s28, s28, 11796480
    s_mov_b32 s62, s28
    s_mov_b32 s63, s29
    v_lshlrev_b32 v5, 11, v1
    s_mov_b64 exec, 3
    s_mov_b32 s90, 0
L_hw_kvpoll0:
    buffer_load_dwordx2 v[6:7], v5, s[4:7], s63 offen sc1
    s_add_u32 s90, s90, 1
    s_cmp_gt_u32 s90, 200000
    s_cbranch_scc1 L_hw_kvpoll0_out
    s_waitcnt vmcnt(0)
    v_subrev_u32 v6, s86, v6
    v_xor_b32 v7, s72, v7
    v_or_b32 v7, v6, v7
    v_cmp_lt_u32 vcc, 7, v7
    s_cbranch_vccnz L_hw_kvpoll0
L_hw_kvpoll0_out:
    s_mov_b64 exec, -1
    s_add_u32 m0, s30, 0
    s_add_u32 s31, s62, 0
    buffer_load_dwordx4 v2, s[4:7], s31 offen sc1 lds
    buffer_load_dwordx4 v2, s[4:7], s31 offen offset:1024 sc1 lds
    s_mov_b32 exec_hi, 0
    buffer_load_dwordx4 v2, s[4:7], s31 offen offset:2048 sc1 lds
    s_mov_b32 exec_hi, -1
    s_add_u32 m0, s30, 2576
    s_add_u32 s31, s62, 81920
    buffer_load_dwordx4 v2, s[4:7], s31 offen sc1 lds
    buffer_load_dwordx4 v2, s[4:7], s31 offen offset:1024 sc1 lds
    s_mov_b32 exec_hi, 0
    buffer_load_dwordx4 v2, s[4:7], s31 offen offset:2048 sc1 lds
    s_mov_b32 exec_hi, -1
    s_add_u32 m0, s68, 0
    s_add_u32 s31, s62, 2560
    buffer_load_dwordx4 v2, s[4:7], s31 offen sc1 lds
    s_mov_b32 exec_hi, 0
    buffer_load_dwordx4 v2, s[4:7], s31 offen offset:1024 sc1 lds
    s_mov_b32 exec_hi, -1
    s_add_u32 m0, s68, 2848
    s_add_u32 s31, s62, 84480
    buffer_load_dwordx4 v2, s[4:7], s31 offen sc1 lds
    s_mov_b32 exec_hi, 0
    buffer_load_dwordx4 v2, s[4:7], s31 offen offset:1024 sc1 lds
    s_mov_b32 exec_hi, -1
    s_waitcnt vmcnt(4)
    v_mov_b32 v251, 1
    ds_write_b8 v249, v251 offset:88
    s_waitcnt vmcnt(0)
    v_mov_b32 v251, 1
    ds_write_b8 v249, v251 offset:92
    s_mov_b32 s61, 1
    s_branch L_hw_halo_done
L_hw_neg:
    v_add_u32 v5, s30, v2
    v_add_u32 v6, s68, v2
    v_mov_b32 v252, 0
    v_mov_b32 v254, 0
    ds_write_b128 v5, v[252:255] offset:0
    ds_write_b128 v6, v[252:255] offset:0
    ds_write_b128 v5, v[252:255] offset:1024
    ds_write_b128 v6, v[252:255] offset:1024
    ds_write_b128 v5, v[252:255] offset:1536
    ds_write_b128 v6, v[252:255] offset:1536
    ds_write_b128 v5, v[252:255] offset:2576
    ds_write_b128 v6, v[252:255] offset:2848
    ds_write_b128 v5, v[252:255] offset:3600
    ds_write_b128 v6, v[252:255] offset:3872
    ds_write_b128 v5, v[252:255] offset:4112
    ds_write_b128 v6, v[252:255] offset:4384
    v_mov_b32 v251, 1
    ds_write_b8 v249, v251 offset:88
    v_mov_b32 v251, 2
    ds_write_b8 v249, v251 offset:92
    s_mov_b32 s61, 0
L_hw_halo_done:
    s_mov_b32 s90, 0
L_spin_hw_10:
    ds_read_u8 v250, v248 offset:92
    s_add_u32 s90, s90, 1
    s_cmp_gt_u32 s90, 1600000
    s_cbranch_scc1 L_spin_hw_10_out
    s_sleep 1
    s_waitcnt lgkmcnt(0)
    v_cmp_gt_u32 vcc, 1, v250
    s_cbranch_vccnz L_spin_hw_10
L_spin_hw_10_out:
    s_waitcnt lgkmcnt(0)
    s_mov_b32 s90, 0
L_spin_hw_11:
    ds_read_u8 v250, v248 offset:68
    s_add_u32 s90, s90, 1
    s_cmp_gt_u32 s90, 1600000
    s_cbranch_scc1 L_spin_hw_11_out
    s_sleep 1
    s_waitcnt lgkmcnt(0)
    v_cmp_gt_u32 vcc, 11, v250
    s_cbranch_vccnz L_spin_hw_11
L_spin_hw_11_out:
    s_waitcnt lgkmcnt(0)
    s_lshl_b32 s26, s16, 2
    s_add_u32 s26, s26, s73
    s_mul_i32 s24, s26, 40960
    s_mul_i32 s25, s17, 2560
    s_add_u32 s24, s24, s25
    s_add_u32 s24, s24, 2621440
    s_mov_b32 exec_hi, 0xff
    buffer_load_dword v0, v4, s[4:7], s24 offen sc1
    s_mov_b32 exec_hi, -1
    s_mul_i32 s69, s26, 98304
    s_mul_i32 s25, s17, 6144
    s_add_u32 s69, s69, s25
    s_add_u32 s69, s69, 5242880
    s_mul_i32 s25, s73, 5120
    s_add_u32 s26, s75, s25
    s_add_u32 s27, s25, 71552
    s_mov_b32 m0, s27
    s_add_u32 s28, s26, 0
    buffer_load_dwordx4 v2, s[4:7], s28 offen offset:0 sc1 lds
    buffer_load_dwordx4 v2, s[4:7], s28 offen offset:1024 sc1 lds
    buffer_load_dwordx4 v2, s[4:7], s28 offen offset:2048 sc1 lds
    buffer_load_dwordx4 v2, s[4:7], s28 offen offset:3072 sc1 lds
    s_add_u32 m0, s27, 4096
    s_add_u32 s28, s28, 4096
    buffer_load_dwordx4 v2, s[4:7], s28 offen sc1 lds
    s_add_u32 s27, s25, 92032
    s_mov_b32 m0, s27
    s_add_u32 s28, s26, 20480
    buffer_load_dwordx4 v2, s[4:7], s28 offen offset:0 sc1 lds
    buffer_load_dwordx4 v2, s[4:7], s28 offen offset:1024 sc1 lds
    buffer_load_dwordx4 v2, s[4:7], s28 offen offset:2048 sc1 lds
    buffer_load_dwordx4 v2, s[4:7], s28 offen offset:3072 sc1 lds
    s_add_u32 m0, s27, 4096
    s_add_u32 s28, s28, 4096
    buffer_load_dwordx4 v2, s[4:7], s28 offen sc1 lds
    s_cmp_eq_u32 s61, 0
    s_cbranch_scc1 L_hw_nov34
    v_lshlrev_b32 v5, 11, v1
    s_mov_b64 exec, 3
    s_mov_b32 s90, 0
L_hw_kvpoll1:
    buffer_load_dwordx2 v[6:7], v5, s[4:7], s63 offen sc1
    s_add_u32 s90, s90, 1
    s_cmp_gt_u32 s90, 200000
    s_cbranch_scc1 L_hw_kvpoll1_out
    s_waitcnt vmcnt(0)
    v_subrev_u32 v6, s87, v6
    v_xor_b32 v7, s72, v7
    v_or_b32 v7, v6, v7
    v_cmp_lt_u32 vcc, 7, v7
    s_cbranch_vccnz L_hw_kvpoll1
L_hw_kvpoll1_out:
    s_mov_b64 exec, -1
    s_add_u32 m0, s68, 1536
    s_add_u32 s31, s62, 4096
    buffer_load_dwordx4 v2, s[4:7], s31 offen sc1 lds
    s_add_u32 m0, s68, 4384
    s_add_u32 s31, s62, 86016
    buffer_load_dwordx4 v2, s[4:7], s31 offen sc1 lds
L_hw_nov34:
    s_mul_i32 s25, s73, 5120
    s_add_u32 s26, s75, s25
    s_add_u32 s27, s25, 112512
    s_mov_b32 m0, s27
    s_add_u32 s28, s26, 40960
    buffer_load_dwordx4 v2, s[4:7], s28 offen offset:0 sc1 lds
    buffer_load_dwordx4 v2, s[4:7], s28 offen offset:1024 sc1 lds
    buffer_load_dwordx4 v2, s[4:7], s28 offen offset:2048 sc1 lds
    buffer_load_dwordx4 v2, s[4:7], s28 offen offset:3072 sc1 lds
    s_add_u32 m0, s27, 4096
    s_add_u32 s28, s28, 4096
    buffer_load_dwordx4 v2, s[4:7], s28 offen sc1 lds
    s_add_u32 s27, s25, 132992
    s_mov_b32 m0, s27
    s_add_u32 s28, s26, 61440
    buffer_load_dwordx4 v2, s[4:7], s28 offen offset:0 sc1 lds
    buffer_load_dwordx4 v2, s[4:7], s28 offen offset:1024 sc1 lds
    buffer_load_dwordx4 v2, s[4:7], s28 offen offset:2048 sc1 lds
    buffer_load_dwordx4 v2, s[4:7], s28 offen offset:3072 sc1 lds
    s_add_u32 m0, s27, 4096
    s_add_u32 s28, s28, 4096
    buffer_load_dwordx4 v2, s[4:7], s28 offen sc1 lds
    s_waitcnt vmcnt(10)
    v_mov_b32 v251, 2
    ds_write_b8 v249, v251 offset:92
    s_cmp_lg_u32 s23, 0
    s_cbranch_scc1 L_hw_now1r
    s_add_u32 s26, s70, 24576
    buffer_load_dwordx4 v[184:187], v2, s[4:7], s26 offen offset:0 sc1
    buffer_load_dwordx4 v[188:191], v2, s[4:7], s26 offen offset:1024 sc1
    buffer_load_dwordx4 v[192:195], v2, s[4:7], s26 offen offset:2048 sc1
    s_add_u32 s26, s70, 36864
    buffer_load_dwordx4 v[196:199], v2, s[4:7], s26 offen offset:0 sc1
    buffer_load_dwordx4 v[200:203], v2, s[4:7], s26 offen offset:1024 sc1
    buffer_load_dwordx4 v[204:207], v2, s[4:7], s26 offen offset:2048 sc1
    s_mul_i32 s26, s73, 5120
    s_add_u32 s26, s26, s77
    s_add_u32 s26, s26, 204800
    buffer_load_dwordx4 v[208:211], v2, s[4:7], s26 offen offset:0 sc1
    buffer_load_dwordx4 v[212:215], v2, s[4:7], s26 offen offset:1024 sc1
    buffer_load_dwordx4 v[216:219], v2, s[4:7], s26 offen offset:2048 sc1
    buffer_load_dwordx4 v[220:223], v2, s[4:7], s26 offen offset:3072 sc1
    s_add_u32 s26, s26, 4096
    buffer_load_dwordx4 v[224:227], v2, s[4:7], s26 offen offset:0 sc1
    s_mul_i32 s26, s73, 5120
    s_add_u32 s26, s26, s77
    s_add_u32 s26, s26, 225280
    buffer_load_dwordx4 v[228:231], v2, s[4:7], s26 offen offset:0 sc1
    buffer_load_dwordx4 v[232:235], v2, s[4:7], s26 offen offset:1024 sc1
    buffer_load_dwordx4 v[236:239], v2, s[4:7], s26 offen offset:2048 sc1
    buffer_load_dwordx4 v[240:243], v2, s[4:7], s26 offen offset:3072 sc1
    s_add_u32 s26, s26, 4096
    buffer_load_dwordx4 v[244:247], v2, s[4:7], s26 offen offset:0 sc1
L_hw_now1r:
    s_mov_b32 s90, 0
L_spin_hw_12:
    ds_read_u8 v250, v248 offset:96
    s_add_u32 s90, s90, 1
    s_cmp_gt_u32 s90, 1600000
    s_cbranch_scc1 L_spin_hw_12_out
    s_sleep 1
    s_waitcnt lgkmcnt(0)
    v_cmp_gt_u32 vcc, 1, v250
    s_cbranch_vccnz L_spin_hw_12
L_spin_hw_12_out:
    s_waitcnt lgkmcnt(0)
    s_lshl_b32 s25, s73, 9
    s_add_u32 m0, s25, 58752
    s_add_u32 s25, s25, s74
    s_add_u32 s25, s25, 4096
    s_mov_b32 exec_hi, 0
    buffer_load_dwordx4 v2, s[4:7], s25 offen sc1 lds
    s_mov_b32 exec_hi, -1
    s_mul_i32 s25, s73, 5120
    s_add_u32 s26, s75, s25
    s_mov_b32 s27, 153472
    s_cmp_eq_u32 s73, 1
    s_cselect_b32 s27, 158592, s27
    s_cmp_eq_u32 s73, 2
    s_cselect_b32 s27, 61312, s27
    s_cmp_eq_u32 s73, 3
    s_cselect_b32 s27, 66432, s27
    s_mov_b32 m0, s27
    s_add_u32 s28, s26, 81920
    buffer_load_dwordx4 v2, s[4:7], s28 offen offset:0 sc1 lds
    buffer_load_dwordx4 v2, s[4:7], s28 offen offset:1024 sc1 lds
    buffer_load_dwordx4 v2, s[4:7], s28 offen offset:2048 sc1 lds
    buffer_load_dwordx4 v2, s[4:7], s28 offen offset:3072 sc1 lds
    s_add_u32 m0, s27, 4096
    s_add_u32 s28, s28, 4096
    buffer_load_dwordx4 v2, s[4:7], s28 offen sc1 lds
    s_mul_i32 s25, s73, 3072
    s_add_u32 s26, s76, s25
    s_add_u32 s27, s25, 34176
    s_mov_b32 m0, s27
    s_add_u32 s28, s26, 0
    buffer_load_dwordx4 v2, s[4:7], s28 offen offset:0 sc1 lds
    buffer_load_dwordx4 v2, s[4:7], s28 offen offset:1024 sc1 lds
    buffer_load_dwordx4 v2, s[4:7], s28 offen offset:2048 sc1 lds
    s_add_u32 s27, s25, 46464
    s_mov_b32 m0, s27
    s_add_u32 s28, s26, 12288
    buffer_load_dwordx4 v2, s[4:7], s28 offen offset:0 sc1 lds
    buffer_load_dwordx4 v2, s[4:7], s28 offen offset:1024 sc1 lds
    buffer_load_dwordx4 v2, s[4:7], s28 offen offset:2048 sc1 lds
    s_waitcnt vmcnt(6)
    v_mov_b32 v251, 16
    ds_write_b8 v249, v251 offset:64
    s_waitcnt vmcnt(0)
    s_cmp_eq_u32 s23, 0
    s_cbranch_scc1 L_hw_noht
    s_add_u32 s24, s69, 0
    buffer_load_dword v0, v4, s[4:7], s24 offen sc1
    s_mov_b32 exec_hi, 0
    s_add_u32 s24, s69, 4096
    buffer_load_dword v0, v4, s[4:7], s24 offen sc1
    s_mov_b32 exec_hi, -1
L_hw_noht:
    s_waitcnt vmcnt(2)
    v_mov_b32 v251, 18
    ds_write_b8 v249, v251 offset:64
    s_mov_b32 s90, 0
L_spin_hw_13:
    ds_read_u8 v250, v248 offset:96
    s_add_u32 s90, s90, 1
    s_cmp_gt_u32 s90, 1600000
    s_cbranch_scc1 L_spin_hw_13_out
    s_sleep 1
    s_waitcnt lgkmcnt(0)
    v_cmp_gt_u32 vcc, 2, v250
    s_cbranch_vccnz L_spin_hw_13
L_spin_hw_13_out:
    s_waitcnt lgkmcnt(0)
    s_mov_b32 s90, 0
L_spin_hw_14:
    ds_read_u8 v250, v248 offset:68
    s_add_u32 s90, s90, 1
    s_cmp_gt_u32 s90, 1600000
    s_cbranch_scc1 L_spin_hw_14_out
    s_sleep 1
    s_waitcnt lgkmcnt(0)
    v_cmp_gt_u32 vcc, 12, v250
    s_cbranch_vccnz L_spin_hw_14
L_spin_hw_14_out:
    s_waitcnt lgkmcnt(0)
    s_mul_i32 s25, s73, 3072
    s_add_u32 s26, s76, s25
    s_add_u32 s27, s25, 20480
    s_mov_b32 m0, s27
    s_add_u32 s28, s26, 24576
    buffer_load_dwordx4 v2, s[4:7], s28 offen offset:0 sc1 lds
    buffer_load_dwordx4 v2, s[4:7], s28 offen offset:1024 sc1 lds
    buffer_load_dwordx4 v2, s[4:7], s28 offen offset:2048 sc1 lds
    s_waitcnt vmcnt(0)
    v_mov_b32 v251, 19
    ds_write_b8 v249, v251 offset:64
    s_mul_i32 s25, s73, 3072
    s_add_u32 s26, s76, s25
    s_add_u32 s27, s25, 71552
    s_mov_b32 m0, s27
    s_add_u32 s28, s26, 36864
    buffer_load_dwordx4 v2, s[4:7], s28 offen offset:0 sc1 lds
    buffer_load_dwordx4 v2, s[4:7], s28 offen offset:1024 sc1 lds
    buffer_load_dwordx4 v2, s[4:7], s28 offen offset:2048 sc1 lds
    ds_read_u8 v250, v248 offset:68
    s_waitcnt lgkmcnt(0)
    v_cmp_gt_u32 vcc, 13, v250
    s_cbranch_vccnz L_cw_hw_15
L_cw_hw_15_b:
    s_add_u32 s27, s25, 83840
    s_mov_b32 m0, s27
    s_add_u32 s28, s26, 49152
    buffer_load_dwordx4 v2, s[4:7], s28 offen offset:0 sc1 lds
    buffer_load_dwordx4 v2, s[4:7], s28 offen offset:1024 sc1 lds
    buffer_load_dwordx4 v2, s[4:7], s28 offen offset:2048 sc1 lds
    s_waitcnt vmcnt(3)
    v_mov_b32 v251, 20
    ds_write_b8 v249, v251 offset:64
    s_add_u32 s27, s25, 96128
    s_mov_b32 m0, s27
    s_add_u32 s28, s26, 61440
    buffer_load_dwordx4 v2, s[4:7], s28 offen offset:0 sc1 lds
    buffer_load_dwordx4 v2, s[4:7], s28 offen offset:1024 sc1 lds
    buffer_load_dwordx4 v2, s[4:7], s28 offen offset:2048 sc1 lds
    s_waitcnt vmcnt(3)
    v_mov_b32 v251, 21
    ds_write_b8 v249, v251 offset:64
    s_waitcnt vmcnt(0)
    v_mov_b32 v251, 22
    ds_write_b8 v249, v251 offset:64
    s_mov_b32 s90, 0
L_spin_hw_16:
    ds_read_u8 v250, v248 offset:68
    s_add_u32 s90, s90, 1
    s_cmp_gt_u32 s90, 1600000
    s_cbranch_scc1 L_spin_hw_16_out
    s_sleep 1
    s_waitcnt lgkmcnt(0)
    v_cmp_gt_u32 vcc, 14, v250
    s_cbranch_vccnz L_spin_hw_16
L_spin_hw_16_out:
    s_waitcnt lgkmcnt(0)
    s_mov_b32 s27, 108416
    s_cmp_eq_u32 s73, 1
    s_cselect_b32 s27, 111488, s27
    s_cmp_eq_u32 s73, 2
    s_cselect_b32 s27, 114560, s27
    s_cmp_eq_u32 s73, 3
    s_cselect_b32 s27, 117632, s27
    v_add_u32 v5, s27, v2
    ds_write_b128 v5, v[160:163] offset:0
    ds_write_b128 v5, v[164:167] offset:1024
    ds_write_b128 v5, v[168:171] offset:2048
    v_mov_b32 v251, 23
    ds_write_b8 v249, v251 offset:64
    s_waitcnt lgkmcnt(4)
    s_mov_b32 s27, 120704
    s_cmp_eq_u32 s73, 1
    s_cselect_b32 s27, 123776, s27
    s_cmp_eq_u32 s73, 2
    s_cselect_b32 s27, 126848, s27
    s_cmp_eq_u32 s73, 3
    s_cselect_b32 s27, 129920, s27
    v_add_u32 v5, s27, v2
    ds_write_b128 v5, v[172:175] offset:0
    ds_write_b128 v5, v[176:179] offset:1024
    ds_write_b128 v5, v[180:183] offset:2048
    v_mov_b32 v251, 24
    ds_write_b8 v249, v251 offset:64
    s_waitcnt lgkmcnt(4)
    s_mov_b32 s90, 0
L_spin_hw_17:
    ds_read_u8 v250, v248 offset:68
    s_add_u32 s90, s90, 1
    s_cmp_gt_u32 s90, 1600000
    s_cbranch_scc1 L_spin_hw_17_out
    s_sleep 1
    s_waitcnt lgkmcnt(0)
    v_cmp_gt_u32 vcc, 15, v250
    s_cbranch_vccnz L_spin_hw_17
L_spin_hw_17_out:
    s_waitcnt lgkmcnt(0)
    s_mov_b32 s27, 132992
    s_cmp_eq_u32 s73, 1
    s_cselect_b32 s27, 136064, s27
    s_cmp_eq_u32 s73, 2
    s_cselect_b32 s27, 139136, s27
    s_cmp_eq_u32 s73, 3
    s_cselect_b32 s27, 142208, s27
    v_add_u32 v5, s27, v2
    ds_write_b128 v5, v[184:187] offset:0
    ds_write_b128 v5, v[188:191] offset:1024
    ds_write_b128 v5, v[192:195] offset:2048
    v_mov_b32 v251, 25
    ds_write_b8 v249, v251 offset:64
    s_waitcnt lgkmcnt(4)
    s_mov_b32 s90, 0
L_spin_hw_18:
    ds_read_u8 v250, v248 offset:68
    s_add_u32 s90, s90, 1
    s_cmp_gt_u32 s90, 1600000
    s_cbranch_scc1 L_spin_hw_18_out
    s_sleep 1
    s_waitcnt lgkmcnt(0)
    v_cmp_gt_u32 vcc, 16, v250
    s_cbranch_vccnz L_spin_hw_18
L_spin_hw_18_out:
    s_waitcnt lgkmcnt(0)
    s_mov_b32 s27, 145280
    s_cmp_eq_u32 s73, 1
    s_cselect_b32 s27, 148352, s27
    s_cmp_eq_u32 s73, 2
    s_cselect_b32 s27, 151424, s27
    s_cmp_eq_u32 s73, 3
    s_cselect_b32 s27, 154496, s27
    v_add_u32 v5, s27, v2
    ds_write_b128 v5, v[196:199] offset:0
    ds_write_b128 v5, v[200:203] offset:1024
    ds_write_b128 v5, v[204:207] offset:2048
    v_mov_b32 v251, 26
    ds_write_b8 v249, v251 offset:64
    s_waitcnt lgkmcnt(4)
    s_mul_i32 s25, s73, 5120
    s_add_u32 s26, s77, s25
    s_mov_b32 s90, 0
L_spin_hw_19:
    ds_read_u8 v250, v248 offset:68
    s_add_u32 s90, s90, 1
    s_cmp_gt_u32 s90, 1600000
    s_cbranch_scc1 L_spin_hw_19_out
    s_sleep 1
    s_waitcnt lgkmcnt(0)
    v_cmp_gt_u32 vcc, 17, v250
    s_cbranch_vccnz L_spin_hw_19
L_spin_hw_19_out:
    s_waitcnt lgkmcnt(0)
    s_add_u32 s27, s25, 0
    s_mov_b32 m0, s27
    s_add_u32 s28, s26, 0
    buffer_load_dwordx4 v2, s[4:7], s28 offen offset:0 sc1 lds
    buffer_load_dwordx4 v2, s[4:7], s28 offen offset:1024 sc1 lds
    buffer_load_dwordx4 v2, s[4:7], s28 offen offset:2048 sc1 lds
    buffer_load_dwordx4 v2, s[4:7], s28 offen offset:3072 sc1 lds
    s_add_u32 m0, s27, 4096
    s_add_u32 s28, s28, 4096
    buffer_load_dwordx4 v2, s[4:7], s28 offen sc1 lds
    ds_read_u8 v250, v248 offset:68
    s_waitcnt lgkmcnt(0)
    v_cmp_gt_u32 vcc, 20, v250
    s_cbranch_vccnz L_cw_hw_20
L_cw_hw_20_b:
    s_mov_b32 s27, 40960
    s_cmp_eq_u32 s73, 1
    s_cselect_b32 s27, 46080, s27
    s_cmp_eq_u32 s73, 2
    s_cselect_b32 s27, 20480, s27
    s_cmp_eq_u32 s73, 3
    s_cselect_b32 s27, 25600, s27
    s_mov_b32 m0, s27
    s_add_u32 s28, s26, 20480
    buffer_load_dwordx4 v2, s[4:7], s28 offen offset:0 sc1 lds
    buffer_load_dwordx4 v2, s[4:7], s28 offen offset:1024 sc1 lds
    buffer_load_dwordx4 v2, s[4:7], s28 offen offset:2048 sc1 lds
    buffer_load_dwordx4 v2, s[4:7], s28 offen offset:3072 sc1 lds
    s_add_u32 m0, s27, 4096
    s_add_u32 s28, s28, 4096
    buffer_load_dwordx4 v2, s[4:7], s28 offen sc1 lds
    s_waitcnt vmcnt(5)
    v_mov_b32 v251, 28
    ds_write_b8 v249, v251 offset:64
    ds_read_u8 v250, v248 offset:68
    s_waitcnt lgkmcnt(0)
    v_cmp_gt_u32 vcc, 21, v250
    s_cbranch_vccnz L_cw_hw_21
L_cw_hw_21_b:
    s_mov_b32 s27, 30720
    s_cmp_eq_u32 s73, 1
    s_cselect_b32 s27, 35840, s27
    s_cmp_eq_u32 s73, 2
    s_cselect_b32 s27, 61440, s27
    s_cmp_eq_u32 s73, 3
    s_cselect_b32 s27, 66560, s27
    s_mov_b32 m0, s27
    s_add_u32 s28, s26, 40960
    buffer_load_dwordx4 v2, s[4:7], s28 offen offset:0 sc1 lds
    buffer_load_dwordx4 v2, s[4:7], s28 offen offset:1024 sc1 lds
    buffer_load_dwordx4 v2, s[4:7], s28 offen offset:2048 sc1 lds
    buffer_load_dwordx4 v2, s[4:7], s28 offen offset:3072 sc1 lds
    s_add_u32 m0, s27, 4096
    s_add_u32 s28, s28, 4096
    buffer_load_dwordx4 v2, s[4:7], s28 offen sc1 lds
    s_waitcnt vmcnt(5)
    v_mov_b32 v251, 29
    ds_write_b8 v249, v251 offset:64
    ds_read_u8 v250, v248 offset:68
    s_waitcnt lgkmcnt(0)
    v_cmp_gt_u32 vcc, 22, v250
    s_cbranch_vccnz L_cw_hw_22
L_cw_hw_22_b:
    s_add_u32 s27, s25, 71680
    s_mov_b32 m0, s27
    s_add_u32 s28, s26, 61440
    buffer_load_dwordx4 v2, s[4:7], s28 offen offset:0 sc1 lds
    buffer_load_dwordx4 v2, s[4:7], s28 offen offset:1024 sc1 lds
    buffer_load_dwordx4 v2, s[4:7], s28 offen offset:2048 sc1 lds
    buffer_load_dwordx4 v2, s[4:7], s28 offen offset:3072 sc1 lds
    s_add_u32 m0, s27, 4096
    s_add_u32 s28, s28, 4096
    buffer_load_dwordx4 v2, s[4:7], s28 offen sc1 lds
    s_waitcnt vmcnt(5)
    v_mov_b32 v251, 30
    ds_write_b8 v249, v251 offset:64
    ds_read_u8 v250, v248 offset:68
    s_waitcnt lgkmcnt(0)
    v_cmp_gt_u32 vcc, 24, v250
    s_cbranch_vccnz L_cw_hw_23
L_cw_hw_23_b:
    s_add_u32 s27, s25, 92160
    s_mov_b32 m0, s27
    s_add_u32 s28, s26, 81920
    buffer_load_dwordx4 v2, s[4:7], s28 offen offset:0 sc1 lds
    buffer_load_dwordx4 v2, s[4:7], s28 offen offset:1024 sc1 lds
    buffer_load_dwordx4 v2, s[4:7], s28 offen offset:2048 sc1 lds
    buffer_load_dwordx4 v2, s[4:7], s28 offen offset:3072 sc1 lds
    s_add_u32 m0, s27, 4096
    s_add_u32 s28, s28, 4096
    buffer_load_dwordx4 v2, s[4:7], s28 offen sc1 lds
    s_waitcnt vmcnt(5)
    v_mov_b32 v251, 31
    ds_write_b8 v249, v251 offset:64
    ds_read_u8 v250, v248 offset:68
    s_waitcnt lgkmcnt(0)
    v_cmp_gt_u32 vcc, 26, v250
    s_cbranch_vccnz L_cw_hw_24
L_cw_hw_24_b:
    s_add_u32 s27, s25, 112640
    s_mov_b32 m0, s27
    s_add_u32 s28, s26, 102400
    buffer_load_dwordx4 v2, s[4:7], s28 offen offset:0 sc1 lds
    buffer_load_dwordx4 v2, s[4:7], s28 offen offset:1024 sc1 lds
    buffer_load_dwordx4 v2, s[4:7], s28 offen offset:2048 sc1 lds
    buffer_load_dwordx4 v2, s[4:7], s28 offen offset:3072 sc1 lds
    s_add_u32 m0, s27, 4096
    s_add_u32 s28, s28, 4096
    buffer_load_dwordx4 v2, s[4:7], s28 offen sc1 lds
    s_waitcnt vmcnt(5)
    v_mov_b32 v251, 32
    ds_write_b8 v249, v251 offset:64
    ds_read_u8 v250, v248 offset:68
    s_waitcnt lgkmcnt(0)
    v_cmp_gt_u32 vcc, 27, v250
    s_cbranch_vccnz L_cw_hw_25
L_cw_hw_25_b:
    s_add_u32 s27, s25, 133120
    s_mov_b32 m0, s27
    s_add_u32 s28, s26, 122880
    buffer_load_dwordx4 v2, s[4:7], s28 offen offset:0 sc1 lds
    buffer_load_dwordx4 v2, s[4:7], s28 offen offset:1024 sc1 lds
    buffer_load_dwordx4 v2, s[4:7], s28 offen offset:2048 sc1 lds
    buffer_load_dwordx4 v2, s[4:7], s28 offen offset:3072 sc1 lds
    s_add_u32 m0, s27, 4096
    s_add_u32 s28, s28, 4096
    buffer_load_dwordx4 v2, s[4:7], s28 offen sc1 lds
    s_waitcnt vmcnt(5)
    v_mov_b32 v251, 33
    ds_write_b8 v249, v251 offset:64
    ds_read_u8 v250, v248 offset:68
    s_waitcnt lgkmcnt(0)
    v_cmp_gt_u32 vcc, 29, v250
    s_cbranch_vccnz L_cw_hw_26
L_cw_hw_26_b:
    s_mov_b32 s27, 51200
    s_cmp_eq_u32 s73, 1
    s_cselect_b32 s27, 56320, s27
    s_cmp_eq_u32 s73, 2
    s_cselect_b32 s27, 0, s27
    s_cmp_eq_u32 s73, 3
    s_cselect_b32 s27, 5120, s27
    s_mov_b32 m0, s27
    s_add_u32 s28, s26, 143360
    buffer_load_dwordx4 v2, s[4:7], s28 offen offset:0 sc1 lds
    buffer_load_dwordx4 v2, s[4:7], s28 offen offset:1024 sc1 lds
    buffer_load_dwordx4 v2, s[4:7], s28 offen offset:2048 sc1 lds
    buffer_load_dwordx4 v2, s[4:7], s28 offen offset:3072 sc1 lds
    s_add_u32 m0, s27, 4096
    s_add_u32 s28, s28, 4096
    buffer_load_dwordx4 v2, s[4:7], s28 offen sc1 lds
    s_waitcnt vmcnt(5)
    v_mov_b32 v251, 34
    ds_write_b8 v249, v251 offset:64
    ds_read_u8 v250, v248 offset:68
    s_waitcnt lgkmcnt(0)
    v_cmp_gt_u32 vcc, 30, v250
    s_cbranch_vccnz L_cw_hw_27
L_cw_hw_27_b:
    s_mov_b32 s27, 10240
    s_cmp_eq_u32 s73, 1
    s_cselect_b32 s27, 15360, s27
    s_cmp_eq_u32 s73, 2
    s_cselect_b32 s27, 40960, s27
    s_cmp_eq_u32 s73, 3
    s_cselect_b32 s27, 46080, s27
    s_mov_b32 m0, s27
    s_add_u32 s28, s26, 163840
    buffer_load_dwordx4 v2, s[4:7], s28 offen offset:0 sc1 lds
    buffer_load_dwordx4 v2, s[4:7], s28 offen offset:1024 sc1 lds
    buffer_load_dwordx4 v2, s[4:7], s28 offen offset:2048 sc1 lds
    buffer_load_dwordx4 v2, s[4:7], s28 offen offset:3072 sc1 lds
    s_add_u32 m0, s27, 4096
    s_add_u32 s28, s28, 4096
    buffer_load_dwordx4 v2, s[4:7], s28 offen sc1 lds
    s_waitcnt vmcnt(5)
    v_mov_b32 v251, 35
    ds_write_b8 v249, v251 offset:64
    ds_read_u8 v250, v248 offset:68
    s_waitcnt lgkmcnt(0)
    v_cmp_gt_u32 vcc, 31, v250
    s_cbranch_vccnz L_cw_hw_28
L_cw_hw_28_b:
    s_add_u32 s27, s25, 20480
    s_mov_b32 m0, s27
    s_add_u32 s28, s26, 184320
    buffer_load_dwordx4 v2, s[4:7], s28 offen offset:0 sc1 lds
    buffer_load_dwordx4 v2, s[4:7], s28 offen offset:1024 sc1 lds
    buffer_load_dwordx4 v2, s[4:7], s28 offen offset:2048 sc1 lds
    buffer_load_dwordx4 v2, s[4:7], s28 offen offset:3072 sc1 lds
    s_add_u32 m0, s27, 4096
    s_add_u32 s28, s28, 4096
    buffer_load_dwordx4 v2, s[4:7], s28 offen sc1 lds
    s_waitcnt vmcnt(5)
    v_mov_b32 v251, 36
    ds_write_b8 v249, v251 offset:64
    s_waitcnt vmcnt(0)
    v_mov_b32 v251, 37
    ds_write_b8 v249, v251 offset:64
    s_mov_b32 s90, 0
L_spin_hw_29:
    ds_read_u8 v250, v248 offset:68
    s_add_u32 s90, s90, 1
    s_cmp_gt_u32 s90, 1600000
    s_cbranch_scc1 L_spin_hw_29_out
    s_sleep 1
    s_waitcnt lgkmcnt(0)
    v_cmp_gt_u32 vcc, 32, v250
    s_cbranch_vccnz L_spin_hw_29
L_spin_hw_29_out:
    s_waitcnt lgkmcnt(0)
    s_mov_b32 s27, 61440
    s_cmp_eq_u32 s73, 1
    s_cselect_b32 s27, 66560, s27
    s_cmp_eq_u32 s73, 2
    s_cselect_b32 s27, 71680, s27
    s_cmp_eq_u32 s73, 3
    s_cselect_b32 s27, 76800, s27
    v_add_u32 v5, s27, v2
    ds_write_b128 v5, v[208:211] offset:0
    ds_write_b128 v5, v[212:215] offset:1024
    ds_write_b128 v5, v[216:219] offset:2048
    ds_write_b128 v5, v[220:223] offset:3072
    ds_write_b128 v5, v[224:227] offset:4096
    v_mov_b32 v251, 38
    ds_write_b8 v249, v251 offset:64
    s_waitcnt lgkmcnt(6)
    s_mov_b32 s90, 0
L_spin_hw_30:
    ds_read_u8 v250, v248 offset:68
    s_add_u32 s90, s90, 1
    s_cmp_gt_u32 s90, 1600000
    s_cbranch_scc1 L_spin_hw_30_out
    s_sleep 1
    s_waitcnt lgkmcnt(0)
    v_cmp_gt_u32 vcc, 33, v250
    s_cbranch_vccnz L_spin_hw_30
L_spin_hw_30_out:
    s_waitcnt lgkmcnt(0)
    s_mov_b32 s27, 81920
    s_cmp_eq_u32 s73, 1
    s_cselect_b32 s27, 87040, s27
    s_cmp_eq_u32 s73, 2
    s_cselect_b32 s27, 92160, s27
    s_cmp_eq_u32 s73, 3
    s_cselect_b32 s27, 97280, s27
    v_add_u32 v5, s27, v2
    ds_write_b128 v5, v[228:231] offset:0
    ds_write_b128 v5, v[232:235] offset:1024
    ds_write_b128 v5, v[236:239] offset:2048
    ds_write_b128 v5, v[240:243] offset:3072
    ds_write_b128 v5, v[244:247] offset:4096
    v_mov_b32 v251, 39
    ds_write_b8 v249, v251 offset:64
    s_waitcnt lgkmcnt(6)
    s_add_u32 s21, s21, 5242880
    s_add_u32 s23, s23, 1
    s_add_u32 s95, s95, 16
    v_add_u32 v248, 64, v248
    v_add_u32 v249, 64, v249
    s_add_u32 s85, s85, 1
    s_add_u32 s86, s86, 2
    s_add_u32 s87, s87, 2
    s_cmp_lt_u32 s23, 2
    s_cbranch_scc1 L_hw_layer1
    s_branch L_mega_fin
L_mega_fin:
L_mega_end:
    s_endpgm
L_slow_cw_1:
    v_mov_b32 v10, s81
    v_mov_b32 v11, s72
    s_waitcnt vmcnt(0)
    s_mov_b64 exec, 1
    buffer_store_dwordx2 v[10:11], off, s[4:7], s80 sc1
    s_mov_b64 exec, -1
    s_branch L_back_cw_2
L_js:
    v_mov_b32 v10, s85
    v_mov_b32 v11, s72
    s_waitcnt vmcnt(63)
    s_mov_b64 exec, 1
    buffer_store_dwordx2 v[10:11], off, s[4:7], s100 sc1
    s_mov_b64 exec, -1
    s_mov_b32 s101, 9999
    s_branch L_js_b
L_q_c0:
    s_mov_b32 s90, 0
L_spin_cold_1:
    ds_read_u8 v250, v248 offset:64
    s_add_u32 s90, s90, 1
    s_cmp_gt_u32 s90, 1600000
    s_cbranch_scc1 L_spin_cold_1_out
    s_waitcnt lgkmcnt(0)
    v_cmp_gt_u32 vcc, 1, v250
    s_cbranch_vccnz L_spin_cold_1
L_spin_cold_1_out:
    s_waitcnt lgkmcnt(0)
    s_branch L_q_c0_b
L_g_cw_4:
    s_mov_b32 s90, 0
L_spin_cold_2:
    ds_read_u8 v250, v248 offset:64
    s_add_u32 s90, s90, 1
    s_cmp_gt_u32 s90, 1600000
    s_cbranch_scc1 L_spin_cold_2_out
    s_waitcnt lgkmcnt(0)
    v_cmp_gt_u32 vcc, 2, v250
    s_cbranch_vccnz L_spin_cold_2
L_spin_cold_2_out:
    s_waitcnt lgkmcnt(0)
    s_branch L_g_cw_4_b
L_g_cw_5:
    s_mov_b32 s90, 0
L_spin_cold_3:
    ds_read_u8 v250, v248 offset:64
    s_add_u32 s90, s90, 1
    s_cmp_gt_u32 s90, 1600000
    s_cbranch_scc1 L_spin_cold_3_out
    s_waitcnt lgkmcnt(0)
    v_cmp_gt_u32 vcc, 3, v250
    s_cbranch_vccnz L_spin_cold_3
L_spin_cold_3_out:
    s_waitcnt lgkmcnt(0)
    s_branch L_g_cw_5_b
L_g_cw_6:
    s_mov_b32 s90, 0
L_spin_cold_4:
    ds_read_u8 v250, v248 offset:64
    s_add_u32 s90, s90, 1
    s_cmp_gt_u32 s90, 1600000
    s_cbranch_scc1 L_spin_cold_4_out
    s_waitcnt lgkmcnt(0)
    v_cmp_gt_u32 vcc, 4, v250
    s_cbranch_vccnz L_spin_cold_4
L_spin_cold_4_out:
    s_waitcnt lgkmcnt(0)
    s_branch L_g_cw_6_b
L_g_cw_7:
    s_mov_b32 s90, 0
L_spin_cold_5:
    ds_read_u8 v250, v248 offset:64
    s_add_u32 s90, s90, 1
    s_cmp_gt_u32 s90, 1600000
    s_cbranch_scc1 L_spin_cold_5_out
    s_waitcnt lgkmcnt(0)
    v_cmp_gt_u32 vcc, 5, v250
    s_cbranch_vccnz L_spin_cold_5
L_spin_cold_5_out:
    s_waitcnt lgkmcnt(0)
    s_branch L_g_cw_7_b
L_g_cw_8:
    s_mov_b32 s90, 0
L_spin_cold_6:
    ds_read_u8 v250, v248 offset:64
    s_add_u32 s90, s90, 1
    s_cmp_gt_u32 s90, 1600000
    s_cbranch_scc1 L_spin_cold_6_out
    s_waitcnt lgkmcnt(0)
    v_cmp_gt_u32 vcc, 6, v250
    s_cbranch_vccnz L_spin_cold_6
L_spin_cold_6_out:
    s_waitcnt lgkmcnt(0)
    s_branch L_g_cw_8_b
L_g_cw_9:
    s_mov_b32 s90, 0
L_spin_cold_7:
    ds_read_u8 v250, v248 offset:64
    s_add_u32 s90, s90, 1
    s_cmp_gt_u32 s90, 1600000
    s_cbranch_scc1 L_spin_cold_7_out
    s_waitcnt lgkmcnt(0)
    v_cmp_gt_u32 vcc, 7, v250
    s_cbranch_vccnz L_spin_cold_7
L_spin_cold_7_out:
    s_waitcnt lgkmcnt(0)
    s_branch L_g_cw_9_b
L_g_cw_10:
    s_mov_b32 s90, 0
L_spin_cold_8:
    ds_read_u8 v250, v248 offset:64
    s_add_u32 s90, s90, 1
    s_cmp_gt_u32 s90, 1600000
    s_cbranch_scc1 L_spin_cold_8_out
    s_waitcnt lgkmcnt(0)
    v_cmp_gt_u32 vcc, 8, v250
    s_cbranch_vccnz L_spin_cold_8
L_spin_cold_8_out:
    s_waitcnt lgkmcnt(0)
    s_branch L_g_cw_10_b
L_g_cw_11:
    s_mov_b32 s90, 0
L_spin_cold_9:
    ds_read_u8 v250, v248 offset:68
    s_add_u32 s90, s90, 1
    s_cmp_gt_u32 s90, 1600000
    s_cbranch_scc1 L_spin_cold_9_out
    s_waitcnt lgkmcnt(0)
    v_cmp_gt_u32 vcc, 6, v250
    s_cbranch_vccnz L_spin_cold_9
L_spin_cold_9_out:
    s_waitcnt lgkmcnt(0)
    s_branch L_g_cw_11_b
L_g_cw_12:
    s_mov_b32 s90, 0
L_spin_cold_10:
    ds_read_u8 v250, v248 offset:64
    s_add_u32 s90, s90, 1
    s_cmp_gt_u32 s90, 1600000
    s_cbranch_scc1 L_spin_cold_10_out
    s_waitcnt lgkmcnt(0)
    v_cmp_gt_u32 vcc, 9, v250
    s_cbranch_vccnz L_spin_cold_10
L_spin_cold_10_out:
    s_waitcnt lgkmcnt(0)
    s_branch L_g_cw_12_b
L_g_cw_13:
    s_mov_b32 s90, 0
L_spin_cold_11:
    ds_read_u8 v250, v248 offset:64
    s_add_u32 s90, s90, 1
    s_cmp_gt_u32 s90, 1600000
    s_cbranch_scc1 L_spin_cold_11_out
    s_waitcnt lgkmcnt(0)
    v_cmp_gt_u32 vcc, 10, v250
    s_cbranch_vccnz L_spin_cold_11
L_spin_cold_11_out:
    s_waitcnt lgkmcnt(0)
    s_branch L_g_cw_13_b
L_ag_cw_14:
    s_mov_b32 s90, 0
L_spin_cold_12:
    ds_read_u8 v250, v248 offset:84
    s_add_u32 s90, s90, 1
    s_cmp_gt_u32 s90, 1600000
    s_cbranch_scc1 L_spin_cold_12_out
    s_waitcnt lgkmcnt(0)
    v_cmp_gt_u32 vcc, 1, v250
    s_cbranch_vccnz L_spin_cold_12
L_spin_cold_12_out:
    s_waitcnt lgkmcnt(0)
    s_branch L_ag_cw_14_b
L_ag_cw_15:
    s_mov_b32 s90, 0
L_spin_cold_13:
    ds_read_u8 v250, v248 offset:88
    s_add_u32 s90, s90, 1
    s_cmp_gt_u32 s90, 1600000
    s_cbranch_scc1 L_spin_cold_13_out
    s_waitcnt lgkmcnt(0)
    v_cmp_gt_u32 vcc, 1, v250
    s_cbranch_vccnz L_spin_cold_13
L_spin_cold_13_out:
    s_waitcnt lgkmcnt(0)
    s_branch L_ag_cw_15_b
L_hv_cw_16:
    s_mov_b32 s90, 0
L_spin_cold_14:
    ds_read_u8 v250, v248 offset:92
    s_add_u32 s90, s90, 1
    s_cmp_gt_u32 s90, 1600000
    s_cbranch_scc1 L_spin_cold_14_out
    s_waitcnt lgkmcnt(0)
    v_cmp_gt_u32 vcc, 1, v250
    s_cbranch_vccnz L_spin_cold_14
L_spin_cold_14_out:
    s_waitcnt lgkmcnt(0)
    s_branch L_hv_cw_16_b
L_hv_cw_17:
    s_mov_b32 s90, 0
L_spin_cold_15:
    ds_read_u8 v250, v248 offset:92
    s_add_u32 s90, s90, 1
    s_cmp_gt_u32 s90, 1600000
    s_cbranch_scc1 L_spin_cold_15_out
    s_waitcnt lgkmcnt(0)
    v_cmp_gt_u32 vcc, 2, v250
    s_cbranch_vccnz L_spin_cold_15
L_spin_cold_15_out:
    s_waitcnt lgkmcnt(0)
    s_branch L_hv_cw_17_b
L_slow_cw_18:
    buffer_store_dwordx4 v[8:11], v2, s[4:7], s26 offen sc1
    s_branch L_back_cw_19
L_slow_cw_20:
    buffer_store_dwordx4 v[100:103], v2, s[4:7], s26 offen offset:1536 sc1
    s_mov_b32 exec_hi, 0
    buffer_store_dwordx4 v[12:15], v2, s[4:7], s26 offen offset:1024 sc1
    s_mov_b32 exec_hi, -1
    s_branch L_back_cw_21
L_slow_cw_22:
    v_mov_b32 v10, s81
    v_mov_b32 v11, s72
    s_waitcnt vmcnt(3)
    s_mov_b64 exec, 1
    buffer_store_dwordx2 v[10:11], off, s[4:7], s80 sc1
    s_mov_b64 exec, -1
    s_branch L_back_cw_23
L_lw_cw_25:
    s_mov_b32 s90, 0
L_spin_cold_16:
    ds_read_u8 v250, v248 offset:64
    s_add_u32 s90, s90, 1
    s_cmp_gt_u32 s90, 1600000
    s_cbranch_scc1 L_spin_cold_16_out
    s_waitcnt lgkmcnt(0)
    v_cmp_gt_u32 vcc, 12, v250
    s_cbranch_vccnz L_spin_cold_16
L_spin_cold_16_out:
    s_waitcnt lgkmcnt(0)
    s_branch L_lw_cw_25_b
L_lw_cw_26:
    s_mov_b32 s90, 0
L_spin_cold_17:
    ds_read_u8 v250, v248 offset:64
    s_add_u32 s90, s90, 1
    s_cmp_gt_u32 s90, 1600000
    s_cbranch_scc1 L_spin_cold_17_out
    s_waitcnt lgkmcnt(0)
    v_cmp_gt_u32 vcc, 13, v250
    s_cbranch_vccnz L_spin_cold_17
L_spin_cold_17_out:
    s_waitcnt lgkmcnt(0)
    s_branch L_lw_cw_26_b
L_lw_cw_27:
    s_mov_b32 s90, 0
L_spin_cold_18:
    ds_read_u8 v250, v248 offset:64
    s_add_u32 s90, s90, 1
    s_cmp_gt_u32 s90, 1600000
    s_cbranch_scc1 L_spin_cold_18_out
    s_waitcnt lgkmcnt(0)
    v_cmp_gt_u32 vcc, 14, v250
    s_cbranch_vccnz L_spin_cold_18
L_spin_cold_18_out:
    s_waitcnt lgkmcnt(0)
    s_branch L_lw_cw_27_b
L_lw_cw_28:
    s_mov_b32 s90, 0
L_spin_cold_19:
    ds_read_u8 v250, v248 offset:64
    s_add_u32 s90, s90, 1
    s_cmp_gt_u32 s90, 1600000
    s_cbranch_scc1 L_spin_cold_19_out
    s_waitcnt lgkmcnt(0)
    v_cmp_gt_u32 vcc, 15, v250
    s_cbranch_vccnz L_spin_cold_19
L_spin_cold_19_out:
    s_waitcnt lgkmcnt(0)
    s_branch L_lw_cw_28_b
L_lw_cw_29:
    s_mov_b32 s90, 0
L_spin_cold_20:
    ds_read_u8 v250, v248 offset:64
    s_add_u32 s90, s90, 1
    s_cmp_gt_u32 s90, 1600000
    s_cbranch_scc1 L_spin_cold_20_out
    s_waitcnt lgkmcnt(0)
    v_cmp_gt_u32 vcc, 16, v250
    s_cbranch_vccnz L_spin_cold_20
L_spin_cold_20_out:
    s_waitcnt lgkmcnt(0)
    s_branch L_lw_cw_29_b
L_xc_cw_30:
    s_mov_b32 s90, 0
L_spin_cold_21:
    ds_read_u8 v250, v248 offset:96
    s_add_u32 s90, s90, 1
    s_cmp_gt_u32 s90, 1600000
    s_cbranch_scc1 L_spin_cold_21_out
    s_waitcnt lgkmcnt(0)
    v_cmp_gt_u32 vcc, 2, v250
    s_cbranch_vccnz L_spin_cold_21
L_spin_cold_21_out:
    s_waitcnt lgkmcnt(0)
    s_branch L_xc_cw_30_b
L_slow_cw_32:
    buffer_store_dwordx4 v[48:51], v7, s[4:7], s32 offen sc1
    buffer_store_dwordx4 v[52:55], v7, s[4:7], s32 offen offset:2048 sc1
    buffer_store_dwordx2 v[56:57], v9, s[4:7], s33 offen sc1
    v_dot2_f32_bf16 v42, v48, v10, v42
    v_dot2_f32_bf16 v43, v48, v48, v43
    v_dot2_f32_bf16 v42, v49, v10, v42
    v_dot2_f32_bf16 v43, v49, v49, v43
    v_dot2_f32_bf16 v42, v50, v10, v42
    v_dot2_f32_bf16 v43, v50, v50, v43
    v_dot2_f32_bf16 v42, v51, v10, v42
    v_dot2_f32_bf16 v43, v51, v51, v43
    v_dot2_f32_bf16 v42, v52, v10, v42
    v_dot2_f32_bf16 v43, v52, v52, v43
    v_dot2_f32_bf16 v42, v53, v10, v42
    v_dot2_f32_bf16 v43, v53, v53, v43
    v_dot2_f32_bf16 v42, v54, v10, v42
    v_dot2_f32_bf16 v43, v54, v54, v43
    v_dot2_f32_bf16 v42, v55, v10, v42
    v_dot2_f32_bf16 v43, v55, v55, v43
    v_dot2_f32_bf16 v42, v56, v10, v42
    v_dot2_f32_bf16 v43, v56, v56, v43
    v_dot2_f32_bf16 v42, v57, v10, v42
    v_dot2_f32_bf16 v43, v57, v57, v43
    s_nop 2
    v_mov_b32 v10, v42
    v_mov_b32 v11, v43
    s_nop 1
    v_permlane32_swap_b32 v42, v10
    v_permlane32_swap_b32 v43, v11
    s_nop 0
    v_add_f32 v42, v42, v10
    v_add_f32 v43, v43, v11
    v_mov_b32 v10, v42
    v_mov_b32 v11, v43
    s_nop 1
    v_permlane16_swap_b32 v42, v10
    v_permlane16_swap_b32 v43, v11
    s_nop 0
    v_add_f32 v42, v42, v10
    v_add_f32 v43, v43, v11
    s_mov_b64 exec, 0xffff
    buffer_store_dwordx2 v[42:43], v2, s[4:7], s38 offen sc1
    s_mov_b64 exec, -1
    s_branch L_back_cw_33
L_slow_cw_34:
    v_mov_b32 v10, s81
    v_mov_b32 v11, s72
    s_waitcnt vmcnt(0)
    s_mov_b64 exec, 1
    buffer_store_dwordx2 v[10:11], off, s[4:7], s80 sc1
    s_mov_b64 exec, -1
    s_branch L_back_cw_35
L_1_c0:
    s_mov_b32 s90, 0
L_spin_cold_22:
    ds_read_u8 v250, v248 offset:64
    s_add_u32 s90, s90, 1
    s_cmp_gt_u32 s90, 1600000
    s_cbranch_scc1 L_spin_cold_22_out
    s_waitcnt lgkmcnt(0)
    v_cmp_gt_u32 vcc, 17, v250
    s_cbranch_vccnz L_spin_cold_22
L_spin_cold_22_out:
    s_waitcnt lgkmcnt(0)
    s_branch L_1_c0_b
L_g_cw_37:
    s_mov_b32 s90, 0
L_spin_cold_23:
    ds_read_u8 v250, v248 offset:64
    s_add_u32 s90, s90, 1
    s_cmp_gt_u32 s90, 1600000
    s_cbranch_scc1 L_spin_cold_23_out
    s_waitcnt lgkmcnt(0)
    v_cmp_gt_u32 vcc, 18, v250
    s_cbranch_vccnz L_spin_cold_23
L_spin_cold_23_out:
    s_waitcnt lgkmcnt(0)
    s_branch L_g_cw_37_b
L_g_cw_38:
    s_mov_b32 s90, 0
L_spin_cold_24:
    ds_read_u8 v250, v248 offset:64
    s_add_u32 s90, s90, 1
    s_cmp_gt_u32 s90, 1600000
    s_cbranch_scc1 L_spin_cold_24_out
    s_waitcnt lgkmcnt(0)
    v_cmp_gt_u32 vcc, 19, v250
    s_cbranch_vccnz L_spin_cold_24
L_spin_cold_24_out:
    s_waitcnt lgkmcnt(0)
    s_branch L_g_cw_38_b
L_g_cw_39:
    s_mov_b32 s90, 0
L_spin_cold_25:
    ds_read_u8 v250, v248 offset:64
    s_add_u32 s90, s90, 1
    s_cmp_gt_u32 s90, 1600000
    s_cbranch_scc1 L_spin_cold_25_out
    s_waitcnt lgkmcnt(0)
    v_cmp_gt_u32 vcc, 20, v250
    s_cbranch_vccnz L_spin_cold_25
L_spin_cold_25_out:
    s_waitcnt lgkmcnt(0)
    s_branch L_g_cw_39_b
L_g_cw_40:
    s_mov_b32 s90, 0
L_spin_cold_26:
    ds_read_u8 v250, v248 offset:64
    s_add_u32 s90, s90, 1
    s_cmp_gt_u32 s90, 1600000
    s_cbranch_scc1 L_spin_cold_26_out
    s_waitcnt lgkmcnt(0)
    v_cmp_gt_u32 vcc, 21, v250
    s_cbranch_vccnz L_spin_cold_26
L_spin_cold_26_out:
    s_waitcnt lgkmcnt(0)
    s_branch L_g_cw_40_b
L_g_cw_41:
    s_mov_b32 s90, 0
L_spin_cold_27:
    ds_read_u8 v250, v248 offset:64
    s_add_u32 s90, s90, 1
    s_cmp_gt_u32 s90, 1600000
    s_cbranch_scc1 L_spin_cold_27_out
    s_waitcnt lgkmcnt(0)
    v_cmp_gt_u32 vcc, 22, v250
    s_cbranch_vccnz L_spin_cold_27
L_spin_cold_27_out:
    s_waitcnt lgkmcnt(0)
    s_branch L_g_cw_41_b
L_g_cw_42:
    s_mov_b32 s90, 0
L_spin_cold_28:
    ds_read_u8 v250, v248 offset:64
    s_add_u32 s90, s90, 1
    s_cmp_gt_u32 s90, 1600000
    s_cbranch_scc1 L_spin_cold_28_out
    s_waitcnt lgkmcnt(0)
    v_cmp_gt_u32 vcc, 23, v250
    s_cbranch_vccnz L_spin_cold_28
L_spin_cold_28_out:
    s_waitcnt lgkmcnt(0)
    s_branch L_g_cw_42_b
L_g_cw_43:
    s_mov_b32 s90, 0
L_spin_cold_29:
    ds_read_u8 v250, v248 offset:64
    s_add_u32 s90, s90, 1
    s_cmp_gt_u32 s90, 1600000
    s_cbranch_scc1 L_spin_cold_29_out
    s_waitcnt lgkmcnt(0)
    v_cmp_gt_u32 vcc, 24, v250
    s_cbranch_vccnz L_spin_cold_29
L_spin_cold_29_out:
    s_waitcnt lgkmcnt(0)
    s_branch L_g_cw_43_b
L_slow_cw_44:
    buffer_store_dwordx4 v[48:51], v0, s[4:7], s28 offen offset:0 sc1
    s_branch L_back_cw_45
L_slow_cw_46:
    buffer_store_dwordx4 v[52:55], v0, s[4:7], s28 offen offset:256 sc1
    s_branch L_back_cw_47
L_slow_cw_48:
    buffer_store_dwordx4 v[64:67], v0, s[4:7], s28 offen offset:2048 sc1
    s_branch L_back_cw_49
L_slow_cw_50:
    buffer_store_dwordx4 v[68:71], v0, s[4:7], s28 offen offset:2304 sc1
    s_branch L_back_cw_51
L_g_cw_52:
    s_mov_b32 s90, 0
L_spin_cold_30:
    ds_read_u8 v250, v248 offset:64
    s_add_u32 s90, s90, 1
    s_cmp_gt_u32 s90, 1600000
    s_cbranch_scc1 L_spin_cold_30_out
    s_waitcnt lgkmcnt(0)
    v_cmp_gt_u32 vcc, 25, v250
    s_cbranch_vccnz L_spin_cold_30
L_spin_cold_30_out:
    s_waitcnt lgkmcnt(0)
    s_branch L_g_cw_52_b
L_slow_cw_53:
    v_mov_b32 v10, s86
    v_mov_b32 v11, s72
    s_waitcnt vmcnt(0)
    s_mov_b64 exec, 1
    buffer_store_dwordx2 v[10:11], off, s[4:7], s30 sc1
    s_mov_b64 exec, -1
    s_branch L_back_cw_54
L_g_cw_55:
    s_mov_b32 s90, 0
L_spin_cold_31:
    ds_read_u8 v250, v248 offset:64
    s_add_u32 s90, s90, 1
    s_cmp_gt_u32 s90, 1600000
    s_cbranch_scc1 L_spin_cold_31_out
    s_waitcnt lgkmcnt(0)
    v_cmp_gt_u32 vcc, 26, v250
    s_cbranch_vccnz L_spin_cold_31
L_spin_cold_31_out:
    s_waitcnt lgkmcnt(0)
    s_branch L_g_cw_55_b
L_fc_cw_56:
    v_lshlrev_b32 v250, 3, v1
    s_mov_b64 exec, 0xff
    s_mov_b32 s90, 0
L_poll_cold_32:
    buffer_load_dwordx2 v[10:11], v250, s[4:7], s63 offen sc1
    s_add_u32 s90, s90, 1
    s_cmp_gt_u32 s90, 200000
    s_cbranch_scc1 L_poll_cold_32_out
    s_waitcnt vmcnt(0)
    v_subrev_u32 v10, s86, v10
    v_xor_b32 v11, s72, v11
    v_or_b32 v11, v10, v11
    v_cmp_lt_u32 vcc, 7, v11
    s_cbranch_vccnz L_poll_cold_32
L_poll_cold_32_out:
    s_mov_b64 exec, -1
    s_branch L_fc_cw_56_b
L_slow_cw_57:
    buffer_store_dwordx4 v[56:59], v0, s[4:7], s29 offen offset:0 sc1
    s_branch L_back_cw_58
L_slow_cw_59:
    buffer_store_dwordx4 v[60:63], v0, s[4:7], s29 offen offset:256 sc1
    s_branch L_back_cw_60
L_lw_cw_61:
    s_mov_b32 s90, 0
L_spin_cold_33:
    ds_read_u8 v250, v248 offset:64
    s_add_u32 s90, s90, 1
    s_cmp_gt_u32 s90, 1600000
    s_cbranch_scc1 L_spin_cold_33_out
    s_waitcnt lgkmcnt(0)
    v_cmp_gt_u32 vcc, 28, v250
    s_cbranch_vccnz L_spin_cold_33
L_spin_cold_33_out:
    s_waitcnt lgkmcnt(0)
    s_branch L_lw_cw_61_b
L_lw_cw_62:
    s_mov_b32 s90, 0
L_spin_cold_34:
    ds_read_u8 v250, v248 offset:64
    s_add_u32 s90, s90, 1
    s_cmp_gt_u32 s90, 1600000
    s_cbranch_scc1 L_spin_cold_34_out
    s_waitcnt lgkmcnt(0)
    v_cmp_gt_u32 vcc, 29, v250
    s_cbranch_vccnz L_spin_cold_34
L_spin_cold_34_out:
    s_waitcnt lgkmcnt(0)
    s_branch L_lw_cw_62_b
L_lw_cw_63:
    s_mov_b32 s90, 0
L_spin_cold_35:
    ds_read_u8 v250, v248 offset:64
    s_add_u32 s90, s90, 1
    s_cmp_gt_u32 s90, 1600000
    s_cbranch_scc1 L_spin_cold_35_out
    s_waitcnt lgkmcnt(0)
    v_cmp_gt_u32 vcc, 30, v250
    s_cbranch_vccnz L_spin_cold_35
L_spin_cold_35_out:
    s_waitcnt lgkmcnt(0)
    s_branch L_lw_cw_63_b
L_slow_cw_64:
    v_mov_b32 v10, s87
    v_mov_b32 v11, s72
    s_waitcnt vmcnt(63)
    s_mov_b64 exec, 1
    buffer_store_dwordx2 v[10:11], off, s[4:7], s30 sc1
    s_mov_b64 exec, -1
    s_branch L_back_cw_65
L_lw_cw_66:
    s_mov_b32 s90, 0
L_spin_cold_36:
    ds_read_u8 v250, v248 offset:64
    s_add_u32 s90, s90, 1
    s_cmp_gt_u32 s90, 1600000
    s_cbranch_scc1 L_spin_cold_36_out
    s_waitcnt lgkmcnt(0)
    v_cmp_gt_u32 vcc, 31, v250
    s_cbranch_vccnz L_spin_cold_36
L_spin_cold_36_out:
    s_waitcnt lgkmcnt(0)
    s_branch L_lw_cw_66_b
L_lw_cw_67:
    s_mov_b32 s90, 0
L_spin_cold_37:
    ds_read_u8 v250, v248 offset:64
    s_add_u32 s90, s90, 1
    s_cmp_gt_u32 s90, 1600000
    s_cbranch_scc1 L_spin_cold_37_out
    s_waitcnt lgkmcnt(0)
    v_cmp_gt_u32 vcc, 32, v250
    s_cbranch_vccnz L_spin_cold_37
L_spin_cold_37_out:
    s_waitcnt lgkmcnt(0)
    s_branch L_lw_cw_67_b
L_lw_cw_68:
    s_mov_b32 s90, 0
L_spin_cold_38:
    ds_read_u8 v250, v248 offset:64
    s_add_u32 s90, s90, 1
    s_cmp_gt_u32 s90, 1600000
    s_cbranch_scc1 L_spin_cold_38_out
    s_waitcnt lgkmcnt(0)
    v_cmp_gt_u32 vcc, 33, v250
    s_cbranch_vccnz L_spin_cold_38
L_spin_cold_38_out:
    s_waitcnt lgkmcnt(0)
    s_branch L_lw_cw_68_b
L_lw_cw_69:
    s_mov_b32 s90, 0
L_spin_cold_39:
    ds_read_u8 v250, v248 offset:64
    s_add_u32 s90, s90, 1
    s_cmp_gt_u32 s90, 1600000
    s_cbranch_scc1 L_spin_cold_39_out
    s_waitcnt lgkmcnt(0)
    v_cmp_gt_u32 vcc, 34, v250
    s_cbranch_vccnz L_spin_cold_39
L_spin_cold_39_out:
    s_waitcnt lgkmcnt(0)
    s_branch L_lw_cw_69_b
L_fc_cw_70:
    v_lshlrev_b32 v250, 3, v1
    s_mov_b64 exec, 0xff
    s_mov_b32 s90, 0
L_poll_cold_40:
    buffer_load_dwordx2 v[10:11], v250, s[4:7], s63 offen sc1
    s_add_u32 s90, s90, 1
    s_cmp_gt_u32 s90, 200000
    s_cbranch_scc1 L_poll_cold_40_out
    s_waitcnt vmcnt(0)
    v_subrev_u32 v10, s87, v10
    v_xor_b32 v11, s72, v11
    v_or_b32 v11, v10, v11
    v_cmp_lt_u32 vcc, 7, v11
    s_cbranch_vccnz L_poll_cold_40
L_poll_cold_40_out:
    s_mov_b64 exec, -1
    s_branch L_fc_cw_70_b
L_lw_cw_71:
    s_mov_b32 s90, 0
L_spin_cold_41:
    ds_read_u8 v250, v248 offset:64
    s_add_u32 s90, s90, 1
    s_cmp_gt_u32 s90, 1600000
    s_cbranch_scc1 L_spin_cold_41_out
    s_waitcnt lgkmcnt(0)
    v_cmp_gt_u32 vcc, 35, v250
    s_cbranch_vccnz L_spin_cold_41
L_spin_cold_41_out:
    s_waitcnt lgkmcnt(0)
    s_branch L_lw_cw_71_b
L_lw_cw_72:
    s_mov_b32 s90, 0
L_spin_cold_42:
    ds_read_u8 v250, v248 offset:64
    s_add_u32 s90, s90, 1
    s_cmp_gt_u32 s90, 1600000
    s_cbranch_scc1 L_spin_cold_42_out
    s_waitcnt lgkmcnt(0)
    v_cmp_gt_u32 vcc, 36, v250
    s_cbranch_vccnz L_spin_cold_42
L_spin_cold_42_out:
    s_waitcnt lgkmcnt(0)
    s_branch L_lw_cw_72_b
L_lw_cw_73:
    s_mov_b32 s90, 0
L_spin_cold_43:
    ds_read_u8 v250, v248 offset:64
    s_add_u32 s90, s90, 1
    s_cmp_gt_u32 s90, 1600000
    s_cbranch_scc1 L_spin_cold_43_out
    s_waitcnt lgkmcnt(0)
    v_cmp_gt_u32 vcc, 37, v250
    s_cbranch_vccnz L_spin_cold_43
L_spin_cold_43_out:
    s_waitcnt lgkmcnt(0)
    s_branch L_lw_cw_73_b
L_lw_cw_74:
    s_mov_b32 s90, 0
L_spin_cold_44:
    ds_read_u8 v250, v248 offset:64
    s_add_u32 s90, s90, 1
    s_cmp_gt_u32 s90, 1600000
    s_cbranch_scc1 L_spin_cold_44_out
    s_waitcnt lgkmcnt(0)
    v_cmp_gt_u32 vcc, 38, v250
    s_cbranch_vccnz L_spin_cold_44
L_spin_cold_44_out:
    s_waitcnt lgkmcnt(0)
    s_branch L_lw_cw_74_b
L_lw_cw_75:
    s_mov_b32 s90, 0
L_spin_cold_45:
    ds_read_u8 v250, v248 offset:64
    s_add_u32 s90, s90, 1
    s_cmp_gt_u32 s90, 1600000
    s_cbranch_scc1 L_spin_cold_45_out
    s_waitcnt lgkmcnt(0)
    v_cmp_gt_u32 vcc, 39, v250
    s_cbranch_vccnz L_spin_cold_45
L_spin_cold_45_out:
    s_waitcnt lgkmcnt(0)
    s_branch L_lw_cw_75_b
L_xc_cw_76:
    s_mov_b32 s90, 0
L_spin_cold_46:
    ds_read_u8 v250, v248 offset:68
    s_add_u32 s90, s90, 1
    s_cmp_gt_u32 s90, 1600000
    s_cbranch_scc1 L_spin_cold_46_out
    s_waitcnt lgkmcnt(0)
    v_cmp_gt_u32 vcc, 35, v250
    s_cbranch_vccnz L_spin_cold_46
L_spin_cold_46_out:
    s_waitcnt lgkmcnt(0)
    s_branch L_xc_cw_76_b
L_final_cw_78:
    v_mul_u32_u24 v51, 1280, v51
    v_add_u32 v52, v52, v51
    v_add_u32 v53, v53, v51
    s_mul_i32 s30, s70, 40960
    s_add_u32 s62, s62, s30
    s_mul_i32 s30, s69, 20480
    s_add_u32 s62, s62, s30
    buffer_store_dwordx4 v[12:15], v52, s[8:11], s62 offen
    buffer_store_dwordx4 v[16:19], v52, s[8:11], s62 offen offset:64
    buffer_store_dwordx2 v[20:21], v53, s[8:11], s62 offen offset:128
    s_branch L_mega_fin
L_slow_cw_79:
    buffer_store_dwordx4 v[12:15], v7, s[4:7], s60 offen sc1
    buffer_store_dwordx4 v[16:19], v7, s[4:7], s60 offen offset:2048 sc1
    buffer_store_dwordx2 v[20:21], v49, s[4:7], s61 offen sc1
    v_dot2_f32_bf16 v42, v12, v10, v42
    v_dot2_f32_bf16 v43, v12, v12, v43
    v_dot2_f32_bf16 v42, v13, v10, v42
    v_dot2_f32_bf16 v43, v13, v13, v43
    v_dot2_f32_bf16 v42, v14, v10, v42
    v_dot2_f32_bf16 v43, v14, v14, v43
    v_dot2_f32_bf16 v42, v15, v10, v42
    v_dot2_f32_bf16 v43, v15, v15, v43
    v_dot2_f32_bf16 v42, v16, v10, v42
    v_dot2_f32_bf16 v43, v16, v16, v43
    v_dot2_f32_bf16 v42, v17, v10, v42
    v_dot2_f32_bf16 v43, v17, v17, v43
    v_dot2_f32_bf16 v42, v18, v10, v42
    v_dot2_f32_bf16 v43, v18, v18, v43
    v_dot2_f32_bf16 v42, v19, v10, v42
    v_dot2_f32_bf16 v43, v19, v19, v43
    v_dot2_f32_bf16 v42, v20, v10, v42
    v_dot2_f32_bf16 v43, v20, v20, v43
    v_dot2_f32_bf16 v42, v21, v10, v42
    v_dot2_f32_bf16 v43, v21, v21, v43
    s_nop 2
    v_mov_b32 v10, v42
    v_mov_b32 v11, v43
    s_nop 1
    v_permlane32_swap_b32 v42, v10
    v_permlane32_swap_b32 v43, v11
    s_nop 0
    v_add_f32 v42, v42, v10
    v_add_f32 v43, v43, v11
    v_mov_b32 v10, v42
    v_mov_b32 v11, v43
    s_nop 1
    v_permlane16_swap_b32 v42, v10
    v_permlane16_swap_b32 v43, v11
    s_nop 0
    v_add_f32 v42, v42, v10
    v_add_f32 v43, v43, v11
    s_mov_b64 exec, 0xffff
    buffer_store_dwordx2 v[42:43], v2, s[4:7], s64 offen sc1
    s_mov_b64 exec, -1
    s_branch L_back_cw_80
L_cw_hw_15:
    s_waitcnt vmcnt(0)
    v_mov_b32 v251, 20
    ds_write_b8 v249, v251 offset:64
    s_mov_b32 s90, 0
L_spin_cold_47:
    ds_read_u8 v250, v248 offset:68
    s_add_u32 s90, s90, 1
    s_cmp_gt_u32 s90, 1600000
    s_cbranch_scc1 L_spin_cold_47_out
    s_sleep 1
    s_waitcnt lgkmcnt(0)
    v_cmp_gt_u32 vcc, 13, v250
    s_cbranch_vccnz L_spin_cold_47
L_spin_cold_47_out:
    s_waitcnt lgkmcnt(0)
    s_branch L_cw_hw_15_b
L_cw_hw_20:
    s_waitcnt vmcnt(0)
    v_mov_b32 v251, 28
    ds_write_b8 v249, v251 offset:64
    s_mov_b32 s90, 0
L_spin_cold_48:
    ds_read_u8 v250, v248 offset:68
    s_add_u32 s90, s90, 1
    s_cmp_gt_u32 s90, 1600000
    s_cbranch_scc1 L_spin_cold_48_out
    s_sleep 1
    s_waitcnt lgkmcnt(0)
    v_cmp_gt_u32 vcc, 20, v250
    s_cbranch_vccnz L_spin_cold_48
L_spin_cold_48_out:
    s_waitcnt lgkmcnt(0)
    s_branch L_cw_hw_20_b
L_cw_hw_21:
    s_waitcnt vmcnt(0)
    v_mov_b32 v251, 29
    ds_write_b8 v249, v251 offset:64
    s_mov_b32 s90, 0
L_spin_cold_49:
    ds_read_u8 v250, v248 offset:68
    s_add_u32 s90, s90, 1
    s_cmp_gt_u32 s90, 1600000
    s_cbranch_scc1 L_spin_cold_49_out
    s_sleep 1
    s_waitcnt lgkmcnt(0)
    v_cmp_gt_u32 vcc, 21, v250
    s_cbranch_vccnz L_spin_cold_49
L_spin_cold_49_out:
    s_waitcnt lgkmcnt(0)
    s_branch L_cw_hw_21_b
L_cw_hw_22:
    s_waitcnt vmcnt(0)
    v_mov_b32 v251, 30
    ds_write_b8 v249, v251 offset:64
    s_mov_b32 s90, 0
L_spin_cold_50:
    ds_read_u8 v250, v248 offset:68
    s_add_u32 s90, s90, 1
    s_cmp_gt_u32 s90, 1600000
    s_cbranch_scc1 L_spin_cold_50_out
    s_sleep 1
    s_waitcnt lgkmcnt(0)
    v_cmp_gt_u32 vcc, 22, v250
    s_cbranch_vccnz L_spin_cold_50
L_spin_cold_50_out:
    s_waitcnt lgkmcnt(0)
    s_branch L_cw_hw_22_b
L_cw_hw_23:
    s_waitcnt vmcnt(0)
    v_mov_b32 v251, 31
    ds_write_b8 v249, v251 offset:64
    s_mov_b32 s90, 0
L_spin_cold_51:
    ds_read_u8 v250, v248 offset:68
    s_add_u32 s90, s90, 1
    s_cmp_gt_u32 s90, 1600000
    s_cbranch_scc1 L_spin_cold_51_out
    s_sleep 1
    s_waitcnt lgkmcnt(0)
    v_cmp_gt_u32 vcc, 24, v250
    s_cbranch_vccnz L_spin_cold_51
L_spin_cold_51_out:
    s_waitcnt lgkmcnt(0)
    s_branch L_cw_hw_23_b
L_cw_hw_24:
    s_waitcnt vmcnt(0)
    v_mov_b32 v251, 32
    ds_write_b8 v249, v251 offset:64
    s_mov_b32 s90, 0
L_spin_cold_52:
    ds_read_u8 v250, v248 offset:68
    s_add_u32 s90, s90, 1
    s_cmp_gt_u32 s90, 1600000
    s_cbranch_scc1 L_spin_cold_52_out
    s_sleep 1
    s_waitcnt lgkmcnt(0)
    v_cmp_gt_u32 vcc, 26, v250
    s_cbranch_vccnz L_spin_cold_52
L_spin_cold_52_out:
    s_waitcnt lgkmcnt(0)
    s_branch L_cw_hw_24_b
L_cw_hw_25:
    s_waitcnt vmcnt(0)
    v_mov_b32 v251, 33
    ds_write_b8 v249, v251 offset:64
    s_mov_b32 s90, 0
L_spin_cold_53:
    ds_read_u8 v250, v248 offset:68
    s_add_u32 s90, s90, 1
    s_cmp_gt_u32 s90, 1600000
    s_cbranch_scc1 L_spin_cold_53_out
    s_sleep 1
    s_waitcnt lgkmcnt(0)
    v_cmp_gt_u32 vcc, 27, v250
    s_cbranch_vccnz L_spin_cold_53
L_spin_cold_53_out:
    s_waitcnt lgkmcnt(0)
    s_branch L_cw_hw_25_b
L_cw_hw_26:
    s_waitcnt vmcnt(0)
    v_mov_b32 v251, 34
    ds_write_b8 v249, v251 offset:64
    s_mov_b32 s90, 0
L_spin_cold_54:
    ds_read_u8 v250, v248 offset:68
    s_add_u32 s90, s90, 1
    s_cmp_gt_u32 s90, 1600000
    s_cbranch_scc1 L_spin_cold_54_out
    s_sleep 1
    s_waitcnt lgkmcnt(0)
    v_cmp_gt_u32 vcc, 29, v250
    s_cbranch_vccnz L_spin_cold_54
L_spin_cold_54_out:
    s_waitcnt lgkmcnt(0)
    s_branch L_cw_hw_26_b
L_cw_hw_27:
    s_waitcnt vmcnt(0)
    v_mov_b32 v251, 35
    ds_write_b8 v249, v251 offset:64
    s_mov_b32 s90, 0
L_spin_cold_55:
    ds_read_u8 v250, v248 offset:68
    s_add_u32 s90, s90, 1
    s_cmp_gt_u32 s90, 1600000
    s_cbranch_scc1 L_spin_cold_55_out
    s_sleep 1
    s_waitcnt lgkmcnt(0)
    v_cmp_gt_u32 vcc, 30, v250
    s_cbranch_vccnz L_spin_cold_55
L_spin_cold_55_out:
    s_waitcnt lgkmcnt(0)
    s_branch L_cw_hw_27_b
L_cw_hw_28:
    s_waitcnt vmcnt(0)
    v_mov_b32 v251, 36
    ds_write_b8 v249, v251 offset:64
    s_mov_b32 s90, 0
L_spin_cold_56:
    ds_read_u8 v250, v248 offset:68
    s_add_u32 s90, s90, 1
    s_cmp_gt_u32 s90, 1600000
    s_cbranch_scc1 L_spin_cold_56_out
    s_sleep 1
    s_waitcnt lgkmcnt(0)
    v_cmp_gt_u32 vcc, 31, v250
    s_cbranch_vccnz L_spin_cold_56
L_spin_cold_56_out:
    s_waitcnt lgkmcnt(0)
    s_branch L_cw_hw_28_b
.p2align 6
L_att_tab:
.long 0x8580, 0x8c40, 0x8f80, 0x0
.long 0x8590, 0x8c50, 0x8f80, 0x0
.long 0x85a0, 0x8c60, 0x8f80, 0x0
.long 0x85b0, 0x8c70, 0x8f80, 0x0
.long 0x8600, 0x8bc0, 0x8f80, 0x0
.long 0x8610, 0x8bd0, 0x8f80, 0x0
.long 0x8620, 0x8be0, 0x8f80, 0x0
.long 0x8630, 0x8bf0, 0x8f80, 0x0
.long 0x85c0, 0x8c00, 0x8f80, 0x0
.long 0x85d0, 0x8c10, 0x8f80, 0x0
.long 0x85e0, 0x8c20, 0x8f80, 0x0
.long 0x85f0, 0x8c30, 0x8f80, 0x0
.long 0x8640, 0x8b80, 0x8f80, 0x0
.long 0x8650, 0x8b90, 0x8f80, 0x0
.long 0x8660, 0x8ba0, 0x8f80, 0x0
.long 0x8670, 0x8bb0, 0x8f80, 0x0
.long 0x8680, 0x8d40, 0x8f80, 0x0
.long 0x8690, 0x8d50, 0x8f80, 0x0
.long 0x86a0, 0x8d60, 0x8f80, 0x0
.long 0x86b0, 0x8d70, 0x8f80, 0x0
.long 0x8700, 0x8cc0, 0x8f80, 0x0
.long 0x8710, 0x8cd0, 0x8f80, 0x0
.long 0x8720, 0x8ce0, 0x8f80, 0x0
.long 0x8730, 0x8cf0, 0x8f80, 0x0
.long 0x86c0, 0x8d00, 0x8f80, 0x0
.long 0x86d0, 0x8d10, 0x8f80, 0x0
.long 0x86e0, 0x8d20, 0x8f80, 0x0
.long 0x86f0, 0x8d30, 0x8f80, 0x0
.long 0x8740, 0x8c80, 0x8f80, 0x0
.long 0x8750, 0x8c90, 0x8f80, 0x0
.long 0x8760, 0x8ca0, 0x8f80, 0x0
.long 0x8770, 0x8cb0, 0x8f80, 0x0
.long 0x87c0, 0x8d80, 0x8a00, 0x0
.long 0x87d0, 0x8d90, 0x8a10, 0x0
.long 0x87e0, 0x8da0, 0x8a20, 0x0
.long 0x87f0, 0x8db0, 0x8a30, 0x0
.long 0x8840, 0x8e00, 0x8980, 0x0
.long 0x8850, 0x8e10, 0x8990, 0x0
.long 0x8860, 0x8e20, 0x89a0, 0x0
.long 0x8870, 0x8e30, 0x89b0, 0x0
.long 0x8780, 0x8dc0, 0x8a40, 0x0
.long 0x8790, 0x8dd0, 0x8a50, 0x0
.long 0x87a0, 0x8de0, 0x8a60, 0x0
.long 0x87b0, 0x8df0, 0x8a70, 0x0
.long 0x8800, 0x8e40, 0x89c0, 0x0
.long 0x8810, 0x8e50, 0x89d0, 0x0
.long 0x8820, 0x8e60, 0x89e0, 0x0
.long 0x8830, 0x8e70, 0x89f0, 0x0
.long 0x88c0, 0x8e80, 0x8b00, 0x0
.long 0x88d0, 0x8e90, 0x8b10, 0x0
.long 0x88e0, 0x8ea0, 0x8b20, 0x0
.long 0x88f0, 0x8eb0, 0x8b30, 0x0
.long 0x8940, 0x8f00, 0x8a80, 0x0
.long 0x8950, 0x8f10, 0x8a90, 0x0
.long 0x8960, 0x8f20, 0x8aa0, 0x0
.long 0x8970, 0x8f30, 0x8ab0, 0x0
.long 0x8880, 0x8ec0, 0x8b40, 0x0
.long 0x8890, 0x8ed0, 0x8b50, 0x0
.long 0x88a0, 0x8ee0, 0x8b60, 0x0
.long 0x88b0, 0x8ef0, 0x8b70, 0x0
.long 0x8900, 0x8f40, 0x8ac0, 0x0
.long 0x8910, 0x8f50, 0x8ad0, 0x0
.long 0x8920, 0x8f60, 0x8ae0, 0x0
.long 0x8930, 0x8f70, 0x8af0, 0x0
.long 0x3f803f80, 0x3f803f80, 0x40, 0x0
.long 0x3f803f80, 0x3f803f80, 0x280, 0x2c0
.long 0x3f803f80, 0x3f803f80, 0x48, 0x8
.long 0x3f803f80, 0x3f803f80, 0x288, 0x2c8
.long 0x3f803f80, 0x3f803f80, 0x50, 0x10
.long 0x3f803f80, 0x3f803f80, 0x290, 0x2d0
.long 0x3f803f80, 0x3f803f80, 0x58, 0x18
.long 0x3f803f80, 0x3f803f80, 0x298, 0x2d8
.long 0x3f803f80, 0x3f803f80, 0x60, 0x20
.long 0x3f803f80, 0x3f803f80, 0x2a0, 0x2e0
.long 0x3f803f80, 0x3f803f80, 0x68, 0x28
.long 0x3f803f80, 0x3f803f80, 0x2a8, 0x2e8
.long 0x3f803f80, 0x3f803f80, 0x70, 0x30
.long 0x3f803f80, 0x3f803f80, 0x2b0, 0x2f0
.long 0x3f803f80, 0x3f803f80, 0x78, 0x38
.long 0x3f803f80, 0x3f803f80, 0x2b8, 0x2f8
.long 0x3f803f80, 0x3f803f80, 0x4c0, 0x480
.long 0x3f803f80, 0x3f803f80, 0xa00, 0xa00
.long 0x3f803f80, 0x3f803f80, 0xa00, 0xa00
.long 0x3f803f80, 0x3f803f80, 0xa00, 0xa00
.long 0x3f803f80, 0x3f803f80, 0x4d0, 0x490
.long 0x3f803f80, 0x3f803f80, 0xa00, 0xa00
.long 0x3f803f80, 0x3f803f80, 0xa00, 0xa00
.long 0x3f803f80, 0x3f803f80, 0xa00, 0xa00
.long 0x3f803f80, 0x3f803f80, 0x4e0, 0x4a0
.long 0x3f803f80, 0x3f803f80, 0xa00, 0xa00
.long 0x3f803f80, 0x3f803f80, 0xa00, 0xa00
.long 0x3f803f80, 0x3f803f80, 0xa00, 0xa00
.long 0x3f803f80, 0x3f803f80, 0x4f0, 0x4b0
.long 0x3f803f80, 0x3f803f80, 0xa00, 0xa00
.long 0x3f803f80, 0x3f803f80, 0xa00, 0xa00
.long 0x3f803f80, 0x3f803f80, 0xa00, 0xa00
.long 0x3f803f80, 0x3f803f80, 0xc0, 0x80
.long 0x3f803f80, 0x3f803f80, 0x200, 0x240
.long 0x3f803f80, 0x3f803f80, 0xc8, 0x88
.long 0x3f803f80, 0x3f803f80, 0x208, 0x248
.long 0x3f803f80, 0x3f803f80, 0xd0, 0x90
.long 0x3f803f80, 0x3f803f80, 0x210, 0x250
.long 0x3f803f80, 0x3f803f80, 0xd8, 0x98
.long 0x3f803f80, 0x3f803f80, 0x218, 0x258
.long 0x3f803f80, 0x3f803f80, 0xe0, 0xa0
.long 0x3f803f80, 0x3f803f80, 0x220, 0x260
.long 0x3f803f80, 0x3f803f80, 0xe8, 0xa8
.long 0x3f803f80, 0x3f803f80, 0x228, 0x268
.long 0x3f803f80, 0x3f803f80, 0xf0, 0xb0
.long 0x3f803f80, 0x3f803f80, 0x230, 0x270
.long 0x3f803f80, 0x3f803f80, 0xf8, 0xb8
.long 0x3f803f80, 0x3f803f80, 0x238, 0x278
.long 0x3f803f80, 0x3f803f80, 0x440, 0x400
.long 0x3f803f80, 0x3f803f80, 0xa00, 0xa00
.long 0x3f803f80, 0x3f803f80, 0xa00, 0xa00
.long 0x3f803f80, 0x3f803f80, 0xa00, 0xa00
.long 0x3f803f80, 0x3f803f80, 0x450, 0x410
.long 0x3f803f80, 0x3f803f80, 0xa00, 0xa00
.long 0x3f803f80, 0x3f803f80, 0xa00, 0xa00
.long 0x3f803f80, 0x3f803f80, 0xa00, 0xa00
.long 0x3f803f80, 0x3f803f80, 0x460, 0x420
.long 0x3f803f80, 0x3f803f80, 0xa00, 0xa00
.long 0x3f803f80, 0x3f803f80, 0xa00, 0xa00
.long 0x3f803f80, 0x3f803f80, 0xa00, 0xa00
.long 0x3f803f80, 0x3f803f80, 0x470, 0x430
.long 0x3f803f80, 0x3f803f80, 0xa00, 0xa00
.long 0x3f803f80, 0x3f803f80, 0xa00, 0xa00
.long 0x3f803f80, 0x3f803f80, 0xa00, 0xa00
.long 0x600, 0x640, 0x0, 0x0
.long 0x840, 0x800, 0x0, 0x0
.long 0x608, 0x648, 0x0, 0x0
.long 0x848, 0x808, 0x0, 0x0
.long 0x610, 0x650, 0x0, 0x0
.long 0x850, 0x810, 0x0, 0x0
.long 0x618, 0x658, 0x0, 0x0
.long 0x858, 0x818, 0x0, 0x0
.long 0x620, 0x660, 0x0, 0x0
.long 0x860, 0x820, 0x0, 0x0
.long 0x628, 0x668, 0x0, 0x0
.long 0x868, 0x828, 0x0, 0x0
.long 0x630, 0x670, 0x0, 0x0
.long 0x870, 0x830, 0x0, 0x0
.long 0x638, 0x678, 0x0, 0x0
.long 0x878, 0x838, 0x0, 0x0
.long 0x4c8, 0x488, 0x0, 0x0
.long 0xa00, 0xa00, 0x0, 0x0
.long 0xa00, 0xa00, 0x0, 0x0
.long 0xa00, 0xa00, 0x0, 0x0
.long 0x4d8, 0x498, 0x0, 0x0
.long 0xa00, 0xa00, 0x0, 0x0
.long 0xa00, 0xa00, 0x0, 0x0
.long 0xa00, 0xa00, 0x0, 0x0
.long 0x4e8, 0x4a8, 0x0, 0x0
.long 0xa00, 0xa00, 0x0, 0x0
.long 0xa00, 0xa00, 0x0, 0x0
.long 0xa00, 0xa00, 0x0, 0x0
.long 0x4f8, 0x4b8, 0x0, 0x0
.long 0xa00, 0xa00, 0x0, 0x0
.long 0xa00, 0xa00, 0x0, 0x0
.long 0xa00, 0xa00, 0x0, 0x0
.long 0x680, 0x6c0, 0x0, 0x0
.long 0x8c0, 0x880, 0x0, 0x0
.long 0x688, 0x6c8, 0x0, 0x0
.long 0x8c8, 0x888, 0x0, 0x0
.long 0x690, 0x6d0, 0x0, 0x0
.long 0x8d0, 0x890, 0x0, 0x0
.long 0x698, 0x6d8, 0x0, 0x0
.long 0x8d8, 0x898, 0x0, 0x0
.long 0x6a0, 0x6e0, 0x0, 0x0
.long 0x8e0, 0x8a0, 0x0, 0x0
.long 0x6a8, 0x6e8, 0x0, 0x0
.long 0x8e8, 0x8a8, 0x0, 0x0
.long 0x6b0, 0x6f0, 0x0, 0x0
.long 0x8f0, 0x8b0, 0x0, 0x0
.long 0x6b8, 0x6f8, 0x0, 0x0
.long 0x8f8, 0x8b8, 0x0, 0x0
.long 0x448, 0x408, 0x0, 0x0
.long 0xa00, 0xa00, 0x0, 0x0
.long 0xa00, 0xa00, 0x0, 0x0
.long 0xa00, 0xa00, 0x0, 0x0
.long 0x458, 0x418, 0x0, 0x0
.long 0xa00, 0xa00, 0x0, 0x0
.long 0xa00, 0xa00, 0x0, 0x0
.long 0xa00, 0xa00, 0x0, 0x0
.long 0x468, 0x428, 0x0, 0x0
.long 0xa00, 0xa00, 0x0, 0x0
.long 0xa00, 0xa00, 0x0, 0x0
.long 0xa00, 0xa00, 0x0, 0x0
.long 0x478, 0x438, 0x0, 0x0
.long 0xa00, 0xa00, 0x0, 0x0
.long 0xa00, 0xa00, 0x0, 0x0
.long 0xa00, 0xa00, 0x0, 0x0
.long 0xffff, 0x0, 0x0, 0x0
.long 0xffffffff, 0x0, 0x0, 0x0
.long 0xffffffff, 0xffff, 0x0, 0x0
.long 0xffffffff, 0xffffffff, 0x0, 0x0
.long 0xffffffff, 0xffffffff, 0xffff, 0x0
.long 0xffffffff, 0xffffffff, 0xffffffff, 0x0
.long 0xffffffff, 0xffffffff, 0xffffffff, 0xffff
.long 0xffffffff, 0xffffffff, 0xffffffff, 0xffffffff
.long 0xffffffff, 0xffffffff, 0xffffffff, 0xffffffff
.long 0xffffffff, 0xffffffff, 0xffffffff, 0xffffffff
.long 0xffffffff, 0xffffffff, 0xffffffff, 0xffffffff
.long 0xffffffff, 0xffffffff, 0xffffffff, 0xffffffff
.long 0xffffffff, 0xffffffff, 0xffffffff, 0xffffffff
.long 0xffffffff, 0xffffffff, 0xffffffff, 0xffffffff
.long 0xffffffff, 0xffffffff, 0xffffffff, 0xffffffff
.long 0xffffffff, 0xffffffff, 0xffffffff, 0xffffffff
.long 0xffffffff, 0xffffffff, 0xffffffff, 0xffffffff
.long 0xffffffff, 0xffffffff, 0xffffffff, 0xffffffff
.long 0xffffffff, 0xffffffff, 0xffffffff, 0xffffffff
.long 0xffffffff, 0xffffffff, 0xffffffff, 0xffffffff
.long 0xffffffff, 0xffffffff, 0xffffffff, 0xffffffff
.long 0xffffffff, 0xffffffff, 0xffffffff, 0xffffffff
.long 0xffffffff, 0xffffffff, 0xffffffff, 0xffffffff
.long 0xffffffff, 0xffffffff, 0xffffffff, 0xffffffff
.long 0xffffffff, 0xffffffff, 0xffffffff, 0xffffffff
.long 0xffffffff, 0xffffffff, 0xffffffff, 0xffffffff
.long 0xffffffff, 0xffffffff, 0xffffffff, 0xffffffff
.long 0xffffffff, 0xffffffff, 0xffffffff, 0xffffffff
.long 0xffffffff, 0xffffffff, 0xffffffff, 0xffffffff
.long 0xffffffff, 0xffffffff, 0xffffffff, 0xffffffff
.long 0xffffffff, 0xffffffff, 0xffffffff, 0xffffffff
.long 0xffffffff, 0xffffffff, 0xffffffff, 0xffffffff
.long 0x0, 0x0, 0x0, 0x0
.long 0x0, 0x0, 0x0, 0x0
.long 0x0, 0x0, 0x0, 0x0
.long 0x0, 0x0, 0x0, 0x0
.long 0x0, 0x0, 0x0, 0x0
.long 0x0, 0x0, 0x0, 0x0
.long 0x0, 0x0, 0x0, 0x0
.long 0x0, 0x0, 0x0, 0x0
.long 0xffff, 0x0, 0x0, 0x0
.long 0xffffffff, 0x0, 0x0, 0x0
.long 0xffffffff, 0xffff, 0x0, 0x0
.long 0xffffffff, 0xffffffff, 0x0, 0x0
.long 0xffffffff, 0xffffffff, 0xffff, 0x0
.long 0xffffffff, 0xffffffff, 0xffffffff, 0x0
.long 0xffffffff, 0xffffffff, 0xffffffff, 0xffff
.long 0xffffffff, 0xffffffff, 0xffffffff, 0xffffffff
.long 0xffffffff, 0xffffffff, 0xffffffff, 0xffffffff
.long 0xffffffff, 0xffffffff, 0xffffffff, 0xffffffff
.long 0xffffffff, 0xffffffff, 0xffffffff, 0xffffffff
.long 0xffffffff, 0xffffffff, 0xffffffff, 0xffffffff
.long 0xffffffff, 0xffffffff, 0xffffffff, 0xffffffff
.long 0xffffffff, 0xffffffff, 0xffffffff, 0xffffffff
.long 0xffffffff, 0xffffffff, 0xffffffff, 0xffffffff
.long 0xffffffff, 0xffffffff, 0xffffffff, 0xffffffff
.long 0xffffffff, 0xffffffff, 0xffffffff, 0xffffffff
.long 0xffffffff, 0xffffffff, 0xffffffff, 0xffffffff
.long 0xffffffff, 0xffffffff, 0xffffffff, 0xffffffff
.long 0xffffffff, 0xffffffff, 0xffffffff, 0xffffffff
.long 0xffffffff, 0xffffffff, 0xffffffff, 0xffffffff
.long 0xffffffff, 0xffffffff, 0xffffffff, 0xffffffff
.long 0xffffffff, 0xffffffff, 0xffffffff, 0xffffffff
.long 0xffffffff, 0xffffffff, 0xffffffff, 0xffffffff
.long 0x0, 0x0, 0x0, 0x0
.long 0x0, 0x0, 0x0, 0x0
.long 0x0, 0x0, 0x0, 0x0
.long 0x0, 0x0, 0x0, 0x0
.long 0x0, 0x0, 0x0, 0x0
.long 0x0, 0x0, 0x0, 0x0
.long 0x0, 0x0, 0x0, 0x0
.long 0x0, 0x0, 0x0, 0x0
.long 0x0, 0x0, 0x0, 0x0
.long 0x0, 0x0, 0x0, 0x0
.long 0x0, 0x0, 0x0, 0x0
.long 0x0, 0x0, 0x0, 0x0
.long 0x0, 0x0, 0x0, 0x0
.long 0x0, 0x0, 0x0, 0x0
.long 0x0, 0x0, 0x0, 0x0
.long 0x0, 0x0, 0x0, 0x0
.long 0xffff, 0x0, 0x0, 0x0
.long 0xffffffff, 0x0, 0x0, 0x0
.long 0xffffffff, 0xffff, 0x0, 0x0
.long 0xffffffff, 0xffffffff, 0x0, 0x0
.long 0xffffffff, 0xffffffff, 0xffff, 0x0
.long 0xffffffff, 0xffffffff, 0xffffffff, 0x0
.long 0xffffffff, 0xffffffff, 0xffffffff, 0xffff
.long 0xffffffff, 0xffffffff, 0xffffffff, 0xffffffff
.long 0xffffffff, 0xffffffff, 0xffffffff, 0xffffffff
.long 0xffffffff, 0xffffffff, 0xffffffff, 0xffffffff
.long 0xffffffff, 0xffffffff, 0xffffffff, 0xffffffff
.long 0xffffffff, 0xffffffff, 0xffffffff, 0xffffffff
.long 0xffffffff, 0xffffffff, 0xffffffff, 0xffffffff
.long 0xffffffff, 0xffffffff, 0xffffffff, 0xffffffff
.long 0xffffffff, 0xffffffff, 0xffffffff, 0xffffffff
.long 0xffffffff, 0xffffffff, 0xffffffff, 0xffffffff
.long 0x0, 0x0, 0x0, 0x0
.long 0x0, 0x0, 0x0, 0x0
.long 0x0, 0x0, 0x0, 0x0
.long 0x0, 0x0, 0x0, 0x0
.long 0x0, 0x0, 0x0, 0x0
.long 0x0, 0x0, 0x0, 0x0
.long 0x0, 0x0, 0x0, 0x0
.long 0x0, 0x0, 0x0, 0x0
.long 0x0, 0x0, 0x0, 0x0
.long 0x0, 0x0, 0x0, 0x0
.long 0x0, 0x0, 0x0, 0x0
.long 0x0, 0x0, 0x0, 0x0
.long 0x0, 0x0, 0x0, 0x0
.long 0x0, 0x0, 0x0, 0x0
.long 0x0, 0x0, 0x0, 0x0
.long 0x0, 0x0, 0x0, 0x0
.long 0x0, 0x0, 0x0, 0x0
.long 0x0, 0x0, 0x0, 0x0
.long 0x0, 0x0, 0x0, 0x0
.long 0x0, 0x0, 0x0, 0x0
.long 0x0, 0x0, 0x0, 0x0
.long 0x0, 0x0, 0x0, 0x0
.long 0x0, 0x0, 0x0, 0x0
.long 0x0, 0x0, 0x0, 0x0
.long 0xffff, 0x0, 0x0, 0x0
.long 0xffffffff, 0x0, 0x0, 0x0
.long 0xffffffff, 0xffff, 0x0, 0x0
.long 0xffffffff, 0xffffffff, 0x0, 0x0
.long 0xffffffff, 0xffffffff, 0xffff, 0x0
.long 0xffffffff, 0xffffffff, 0xffffffff, 0x0
.long 0xffffffff, 0xffffffff, 0xffffffff, 0xffff
.long 0xffffffff, 0xffffffff, 0xffffffff, 0xffffffff
.long 0xffffffff, 0xffffff00
.long 0xfffffffe, 0xfffffe00
.long 0xfffffffc, 0xfffffc00
.long 0xfffffff8, 0xfffff800
.long 0xfffffff0, 0xfffff000
.long 0xffffffe0, 0xffffe000
.long 0xffffffc0, 0xffffc000
.long 0xffffff80, 0xffff8000
.long 0xffff0000, 0xff000000
.long 0xfffe0000, 0xfe000000
.long 0xfffc0000, 0xfc000000
.long 0xfff80000, 0xf8000000
.long 0xfff00000, 0xf0000000
.long 0xffe00000, 0xe0000000
.long 0xffc00000, 0xc0000000
.long 0xff800000, 0x80000000
L_code_end:
.section .rodata,"a"
.p2align 6
.amdhsa_kernel interleave_layers__sliding_block__dense_activation_squared_relu__prompt_kernel
  .amdhsa_next_free_vgpr 256
  .amdhsa_next_free_sgpr 102
  .amdhsa_accum_offset 256
  .amdhsa_group_segment_fixed_size 0
  .amdhsa_kernarg_size 88
  .amdhsa_user_sgpr_count 2
  .amdhsa_user_sgpr_kernarg_segment_ptr 1
  .amdhsa_system_sgpr_workgroup_id_x 1
.end_amdhsa_kernel
```
